```python
import torch

def _softmax(x, axis=-1):
    return torch.softmax(x, dim=axis)
def _gelu(x):
    return torch.nn.functional.gelu(x, approximate="tanh")
def _silu(x):
    return torch.nn.functional.silu(x)
def _sigmoid(x):
    return torch.sigmoid(x)
def _layernorm(x, axis=-1, eps=1e-5):
    m = x.mean(dim=axis, keepdim=True)
    v = x.var(dim=axis, keepdim=True, unbiased=False)
    return (x - m) / torch.sqrt(v + eps)
def _scatter_add(tgt, idx, src, axis=0):
    return tgt.clone().index_add_(axis, idx, src)
def _segment_sum(src, seg, n):
    out = torch.zeros((n,) + src.shape[1:], dtype=src.dtype)
    return out.index_add_(0, seg, src)
def _pad(x, pw):
    flat = tuple(v for pair in reversed(pw) for v in pair)
    return torch.nn.functional.pad(x, flat)

kernel_name = 'gated_mix__linear_kernel_hedgehog__glu_gated_geglu__prompt'

def setup_inputs():

    _w = (lambda a: (lambda t: t.to(torch.bfloat16) if t.is_floating_point() else t)(torch.as_tensor(a)))
    def _A_setup():
        B, S, D, H = 1, 2048, 1024, 32
        Dh = D // H
        return {
            "x": _w((lambda *s: torch.randn(*s, dtype=torch.bfloat16) * 0.05)(B, S, D)),
            "wqkv": _w((lambda *s: torch.randn(*s, dtype=torch.bfloat16) * 0.8)(D, 3 * D)),
            "w_phi": _w((lambda *s: torch.randn(*s, dtype=torch.bfloat16) * 0.8)(H, Dh, Dh) * (Dh ** -0.5)),
            "wo": _w((lambda *s: torch.randn(*s, dtype=torch.bfloat16) * 0.05)(D, D)),
        }
    _A_in = _A_setup()

    def _B_setup():
        B, S, Dm, Df = 1, 2048, 1024, 3584
        return {
            "x": _w((lambda *s: torch.randn(*s, dtype=torch.bfloat16) * 0.05)(B, S, Dm)),
            "w_gate": _w((lambda *s: torch.randn(*s, dtype=torch.bfloat16) * 1.6)(Dm, Df) * (Dm ** -0.5)),
            "w_up": _w((lambda *s: torch.randn(*s, dtype=torch.bfloat16) * 1.6)(Dm, Df) * (Dm ** -0.5)),
            "w_down": _w((lambda *s: torch.randn(*s, dtype=torch.bfloat16) * 1.6)(Df, Dm) * (Df ** -0.5)),
        }
    _B_in = _B_setup()

    return {
        "A_x": _A_in["x"],
        "A_wqkv": _A_in["wqkv"],
        "A_w_phi": _A_in["w_phi"],
        "A_wo": _A_in["wo"],
        "B_x": _B_in["x"],
        "B_w_gate": _B_in["w_gate"],
        "B_w_up": _B_in["w_up"],
        "B_w_down": _B_in["w_down"],
        "gate_w": _w((lambda *s: torch.randn(*s, dtype=torch.bfloat16) * 0.05)(1024) * 16.0),
    }

def reference(A_x, A_wqkv, A_w_phi, A_wo, B_x, B_w_gate, B_w_up, B_w_down, gate_w):
    def _A_ref(x, wqkv, w_phi, wo):
        B, S, D = x.shape
        H = 32; Dh = D // H
        qkv = (lambda x, *d: x.permute(*d))((x @ wqkv).reshape(B, S, 3, H, Dh), 2, 0, 3, 1, 4)
        q, k, v = qkv[0], qkv[1], qkv[2]
        pq = torch.einsum("bhsd,hdf->bhsf", q, w_phi)
        pk = torch.einsum("bhsd,hdf->bhsf", k, w_phi)
        phi_q = torch.concatenate([_softmax(pq, axis=-1), _softmax(-pq, axis=-1)], axis=-1)
        phi_k = torch.concatenate([_softmax(pk, axis=-1), _softmax(-pk, axis=-1)], axis=-1)
        kv = torch.einsum("bhsf,bhsd->bhfd", phi_k, v)
        z  = torch.einsum("bhsf->bhf", phi_k)
        num = torch.einsum("bhqf,bhfd->bhqd", phi_q, kv)
        den = torch.einsum("bhqf,bhf->bhq", phi_q, z)[..., None] + 1e-6
        o = num / den
        return (lambda x, *d: x.permute(*d))(o, 0, 2, 1, 3).reshape(B, S, D) @ wo

    def _B_ref(x, w_gate, w_up, w_down):
        g = torch.einsum("bsd,df->bsf", x, w_gate)
        u = torch.einsum("bsd,df->bsf", x, w_up)
        h = _gelu(g) * u
        return torch.einsum("bsf,fd->bsd", h, w_down)

    x = A_x
    g = _sigmoid((x * gate_w).sum(-1, keepdims=True))
    a = _A_ref(x, A_wqkv, A_w_phi, A_wo)
    b = _B_ref(x, B_w_gate, B_w_up, B_w_down)
    return g * a + (1 - g) * b
```

```asm
; @launch kernel=fk_kernel grid=(256,1,1) block=(512,1,1) lds=163840
.amdgcn_target "amdgcn-amd-amdhsa--gfx950"
.text
.p2align 8
fk_kernel:
    s_cmp_ge_u32 s2, 256
    s_cbranch_scc1 K1_END
    s_load_dwordx16 s[4:19], s[0:1], 0
    s_load_dwordx8 s[20:27], s[0:1], 64
    v_lshrrev_b32 v1, 6, v0
    v_and_b32 v2, 63, v0
    v_readfirstlane_b32 s30, v1
    s_and_b32 s3, s2, 7
    s_lshr_b32 s33, s2, 3
    s_and_b32 s34, s33, 3
    s_lshl_b32 s3, s3, 2
    s_add_u32 s28, s3, s34
    s_lshr_b32 s29, s33, 2
    s_mov_b32 s90, 0
    s_cmp_lg_u32 s30, 7
    s_cbranch_scc1 K1_NCT
    s_getpc_b64 s[80:81]
K1_PC:
    v_min_u32 v9, 15, v2
    v_lshl_add_u32 v9, s33, 4, v9
    v_lshlrev_b32 v9, 7, v9
    v_min_u32 v9, K1_END-K1_PC, v9
    global_load_dword v179, v9, s[80:81]
K1_NCT:
    s_add_u32 s93, s30, s33
    s_and_b32 s93, s93, 3
    s_cmp_ge_u32 s30, 4
    s_cselect_b32 s93, s30, s93
    s_lshl_b32 s94, s93, 2
    s_lshr_b32 s94, 0x38376510, s94
    s_and_b32 s94, s94, 15
    s_lshl_b32 s94, s94, 3
    s_load_dwordx2 s[96:97], s[0:1], s94
    s_mov_b32 s99, 0x20000
    s_mov_b32 s91, s90
    s_mov_b32 s92, 15
    s_add_u32 s82, s33, 1
    s_bitcmp0_b32 s82, 1
    s_cselect_b32 s82, 2, 0
    s_andn2_b32 s83, s33, 1
    s_cmp_ge_u32 s93, 1
    s_cbranch_scc1 K1_T2
    s_mov_b32 s98, 0x400000
    s_lshl_b32 s80, s33, 6
    v_add_u32 v9, s80, v2
    v_lshlrev_b32 v178, 11, v9
    s_movk_i32 s95, 128
    s_branch K1_TJ
K1_T2:
    s_cmp_ge_u32 s93, 2
    s_cbranch_scc1 K1_T3
    s_mov_b32 s98, 0x600000
    s_mul_i32 s80, s33, 12
    v_add_u32 v9, s80, v2
    v_lshrrev_b32 v10, 7, v9
    v_bfe_u32 v11, v9, 1, 6
    v_and_b32 v12, 1, v9
    v_mul_u32_u24 v11, 6144, v11
    v_lshl_add_u32 v11, v10, 11, v11
    v_lshl_add_u32 v11, v12, 7, v11
    s_lshl_b32 s80, s3, 6
    v_add_u32 v178, s80, v11
    v_cmp_gt_u32 vcc, 12, v2
    v_mov_b32 v10, 0x7f000000
    s_nop 0
    v_cndmask_b32 v178, v10, v178, vcc
    s_mov_b32 s95, 0x60000
    s_branch K1_TJ
K1_T3:
    s_cmp_ge_u32 s93, 4
    s_cbranch_scc1 K1_T5
    s_mov_b32 s98, 0x700000
    v_cmp_le_u32 vcc, 7, v2
    s_nop 1
    v_cndmask_b32 v9, 0, 1, vcc
    v_mul_u32_u24 v10, 7, v9
    v_sub_u32 v10, v2, v10
    s_lshl_b32 s80, s33, 1
    v_add_u32 v9, s80, v9
    v_mul_u32_u24 v9, 7168, v9
    v_lshl_add_u32 v9, v10, 7, v9
    s_mul_i32 s80, s3, 224
    v_add_u32 v178, s80, v9
    v_cmp_gt_u32 vcc, 14, v2
    v_mov_b32 v10, 0x7f000000
    s_nop 0
    v_cndmask_b32 v178, v10, v178, vcc
    s_mov_b32 s95, 0x70000
    s_branch K1_TJ
K1_T5:
    s_mov_b32 s91, 0
    s_mov_b32 s92, 31
    v_lshlrev_b32 v9, 7, v2
    s_cmp_ge_u32 s93, 5
    s_cbranch_scc1 K1_T6
    s_mov_b32 s98, 0x700000
    s_andn2_b32 s80, s2, 8
    s_mul_i32 s80, s80, 28672
    v_lshrrev_b32 v11, 4, v2
    v_mul_u32_u24 v11, 0x37800, v11
    v_add3_u32 v178, s80, v9, v11
    s_lshl_b32 s82, s82, 4
    v_cmp_gt_u32 vcc, s82, v2
    v_mov_b32 v10, 0x7f000000
    s_nop 0
    v_cndmask_b32 v178, v10, v178, vcc
    s_movk_i32 s95, 2048
    s_branch K1_TJ
K1_T6:
    s_cmp_eq_u32 s93, 5
    s_cselect_b32 s98, 0x200000, 0
    s_cselect_b32 s80, s2, 0
    s_cselect_b32 s81, 5, 16
    s_lshl_b32 s80, s80, 13
    v_add_u32 v178, s80, v9
    v_cmp_gt_u32 vcc, s81, v2
    v_mov_b32 v10, 0x7f000000
    s_nop 0
    v_cndmask_b32 v178, v10, v178, vcc
    s_cmp_eq_u32 s93, 6
    s_cselect_b32 s98, 0x800, s98
    s_movk_i32 s95, 640
K1_TJ:
    s_mul_i32 s94, s91, s95
    s_waitcnt lgkmcnt(0)
    s_and_b32 s97, s97, 0xffff
    s_cmp_ge_u32 s93, 4
    s_cbranch_scc1 K1_TE
    buffer_load_dword v179, v178, s[96:99], s94 offen
    s_add_u32 s91, s91, 1
    s_and_b32 s91, s91, s92
    s_mul_i32 s94, s91, s95
    buffer_load_dword v179, v178, s[96:99], s94 offen
    s_add_u32 s91, s91, 1
    s_and_b32 s91, s91, s92
    s_mul_i32 s94, s91, s95
K1_TE:
    v_lshrrev_b32 v4, 4, v2
    v_lshrrev_b32 v9, 3, v2
    v_and_b32 v10, 7, v2
    v_xor_b32 v10, v10, v4
    v_lshlrev_b32 v9, 11, v9
    v_lshl_add_u32 v161, v10, 4, v9
    v_xor_b32 v162, 64, v161
    v_add_u32 v162, 0x4000, v162
    s_lshl_b32 s70, s30, 16
    s_add_u32 s71, s70, 0x8000
    s_lshl_b32 s72, s30, 12
    s_lshl_b32 s80, s29, 19
    s_mov_b32 s38, 0x80000
    s_mov_b32 s39, 0x20000
    v_mul_u32_u24 v9, 4682, v0
    v_bfe_u32 v5, v2, 2, 2
    v_lshrrev_b32 v9, 16, v9
    v_and_b32 v6, 3, v2
    v_mul_u32_u24 v10, 14, v9
    v_and_b32 v7, 1, v4
    v_sub_u32 v10, v0, v10
    s_bitcmp1_b32 s28, 0
    s_mov_b32 s34, 0x6325410
    s_cselect_b32 s34, 0x652143, s34
    v_and_b32 v12, 14, v10
    v_lshlrev_b32 v12, 1, v12
    v_bfe_u32 v12, s34, v12, 3
    v_and_b32 v10, 1, v10
    v_lshl_add_u32 v10, v12, 1, v10
    v_lshrrev_b32 v11, 1, v9
    v_xor_b32 v11, v11, v9
    v_and_b32 v11, 4, v11
    v_mul_u32_u24 v11, 3, v11
    v_xor_b32 v9, v9, v11
    v_mul_u32_u24 v9, 7168, v9
    v_lshl_add_u32 v163, v10, 4, v9
    v_lshrrev_b32 v8, 1, v4
    v_lshl_add_u32 v11, v8, 2, v5
    v_lshl_add_u32 v11, v7, 3, v11
    v_mul_u32_u24 v11, 6144, v11
    v_lshlrev_b32 v12, 1, v7
    v_xor_b32 v12, v12, v6
    v_lshl_add_u32 v164, v12, 4, v11
    s_mul_i32 s81, s28, 224
    s_lshl_b32 s82, s28, 6
    s_add_u32 s83, s82, 4096
    s_lshl_b32 s84, s30, 10
    s_add_u32 s56, s84, 32768
    s_add_u32 s84, s84, 45056
    s_and_b32 s32, s30, 3
    s_lshr_b32 s31, s30, 2
    s_mul_i32 s85, s32, 98304
    s_add_u32 s82, s82, s85
    s_lshl_b32 s85, s31, 11
    s_add_u32 s64, s82, s85
    s_cmp_eq_u32 s30, 7
    s_cselect_b64 vcc, -1, 0
    s_cselect_b32 s60, s83, s81
    s_mov_b32 s81, 229376
    s_cselect_b32 s81, 98304, s81
    s_cselect_b32 s82, 196608, 0
    s_mov_b32 s65, 458752
    s_cselect_b32 s65, 393216, s65
    s_cselect_b32 s52, 40960, s84
    s_movk_i32 s83, 7168
    s_cselect_b32 s83, 1024, s83
    s_lshl_b32 s42, s65, 4
    s_mov_b32 s46, s42
    s_mov_b32 s50, 0x600000
    s_mov_b32 s43, 0x20000
    s_mov_b32 s47, 0x20000
    s_mov_b32 s51, 0x20000
    v_cndmask_b32 v163, v163, v164, vcc
    s_add_u32 s61, s60, s81
    s_add_u32 s62, s60, s82
    s_add_u32 s63, s62, s81
    s_add_u32 s53, s52, s83
    s_add_u32 s54, s53, s83
    s_add_u32 s55, s54, s83
    s_add_u32 s36, s4, s80
    s_addc_u32 s37, s5, 0
    s_and_b32 s37, s37, 0xffff
    s_and_b32 s7, s7, 0xffff
    s_and_b32 s15, s15, 0xffff
    s_and_b32 s17, s17, 0xffff
    s_cmp_eq_u32 s30, 7
    s_cselect_b64 s[40:41], s[6:7], s[14:15]
    s_cselect_b64 s[44:45], s[6:7], s[16:17]
    s_mov_b64 s[48:49], s[6:7]
    v_and_b32 v3, 15, v2
    s_lshl_b32 s86, s32, 6
    v_add_u32 v9, s86, v3
    v_lshlrev_b32 v9, 7, v9
    v_lshrrev_b32 v10, 1, v3
    v_xor_b32 v10, v10, v4
    v_lshl_add_u32 v168, v10, 4, v9
    v_xor_b32 v169, 64, v168
    v_add_u32 v170, 0x12000, v168
    v_add_u32 v171, 0x12000, v169
    v_lshlrev_b32 v9, 4, v8
    v_lshl_add_u32 v9, v7, 2, v9
    v_add_u32 v9, v9, v5
    s_lshl_b32 s87, s31, 7
    s_add_u32 s87, s87, 45056
    v_mul_u32_u24 v10, 224, v9
    v_lshl_add_u32 v10, v6, 3, v10
    v_add_u32 v172, s87, v10
    v_add_u32 v173, 0x12000, v172
    v_lshlrev_b32 v10, 6, v9
    v_lshrrev_b32 v11, 1, v6
    v_lshlrev_b32 v12, 1, v7
    v_xor_b32 v11, v11, v12
    v_lshl_add_u32 v10, v11, 4, v10
    v_and_b32 v11, 1, v6
    v_lshl_add_u32 v10, v11, 3, v10
    v_add_u32 v174, 0x8000, v10
    v_xor_b32 v175, 32, v174
    v_add_u32 v176, 0x12000, v174
    v_add_u32 v177, 0x12000, v175
    v_mov_b32 v180, -1
    v_mov_b32 v181, -1
    v_mov_b32 v182, -1
    v_mov_b32 v183, -1
    s_and_b32 s86, s28, 7
    s_lshl_b32 s86, s86, 3
    s_add_u32 s86, s86, s29
    s_lshl_b32 s86, s86, 2
    s_lshr_b32 s87, s28, 3
    s_add_u32 s86, s86, s87
    s_lshl_b32 s86, s86, 3
    s_add_u32 s86, s86, s30
    s_lshl_b32 s86, s86, 13
    s_add_u32 s35, s86, 0x2400000
    v_pk_mov_b32 v[80:81], 0, 0
    v_pk_mov_b32 v[82:83], 0, 0
    v_pk_mov_b32 v[84:85], 0, 0
    v_pk_mov_b32 v[86:87], 0, 0
    v_pk_mov_b32 v[88:89], 0, 0
    v_pk_mov_b32 v[90:91], 0, 0
    v_pk_mov_b32 v[92:93], 0, 0
    v_pk_mov_b32 v[94:95], 0, 0
    v_pk_mov_b32 v[96:97], 0, 0
    v_pk_mov_b32 v[98:99], 0, 0
    v_pk_mov_b32 v[100:101], 0, 0
    v_pk_mov_b32 v[102:103], 0, 0
    v_pk_mov_b32 v[104:105], 0, 0
    v_pk_mov_b32 v[106:107], 0, 0
    v_pk_mov_b32 v[108:109], 0, 0
    v_pk_mov_b32 v[110:111], 0, 0
    v_pk_mov_b32 v[112:113], 0, 0
    v_pk_mov_b32 v[114:115], 0, 0
    v_pk_mov_b32 v[116:117], 0, 0
    v_pk_mov_b32 v[118:119], 0, 0
    v_pk_mov_b32 v[120:121], 0, 0
    v_pk_mov_b32 v[122:123], 0, 0
    v_pk_mov_b32 v[124:125], 0, 0
    v_pk_mov_b32 v[126:127], 0, 0
    v_pk_mov_b32 v[128:129], 0, 0
    v_pk_mov_b32 v[130:131], 0, 0
    v_pk_mov_b32 v[132:133], 0, 0
    v_pk_mov_b32 v[134:135], 0, 0
    v_pk_mov_b32 v[136:137], 0, 0
    v_pk_mov_b32 v[138:139], 0, 0
    v_pk_mov_b32 v[140:141], 0, 0
    v_pk_mov_b32 v[142:143], 0, 0
    v_pk_mov_b32 v[144:145], 0, 0
    v_pk_mov_b32 v[146:147], 0, 0
    v_pk_mov_b32 v[148:149], 0, 0
    v_pk_mov_b32 v[150:151], 0, 0
    v_pk_mov_b32 v[152:153], 0, 0
    v_pk_mov_b32 v[154:155], 0, 0
    v_pk_mov_b32 v[156:157], 0, 0
    v_pk_mov_b32 v[158:159], 0, 0
    s_cmp_ge_u32 s93, 4
    s_cbranch_scc1 K1_TE3
    s_waitcnt vmcnt(1)
K1_TE3:
    s_barrier
    s_add_u32 m0, s72, 0x0
    s_nop 0
    buffer_load_dwordx4 v161, s[36:39], s70 offen lds
    s_add_u32 m0, s72, 0x400
    s_nop 0
    buffer_load_dwordx4 v162, s[36:39], s70 offen lds
    s_add_u32 m0, s72, 0x800
    s_nop 0
    buffer_load_dwordx4 v161, s[36:39], s71 offen lds
    s_add_u32 m0, s72, 0xc00
    s_nop 0
    buffer_load_dwordx4 v162, s[36:39], s71 offen lds
    s_add_u32 m0, s52, 0x0
    s_nop 0
    buffer_load_dwordx4 v163, s[40:43], s60 offen lds
    s_add_u32 m0, s53, 0x0
    s_nop 0
    buffer_load_dwordx4 v163, s[40:43], s61 offen lds
    s_add_u32 m0, s54, 0x0
    s_nop 0
    buffer_load_dwordx4 v163, s[44:47], s62 offen lds
    s_add_u32 m0, s55, 0x0
    s_nop 0
    buffer_load_dwordx4 v163, s[44:47], s63 offen lds
    s_add_u32 m0, s56, 0x0
    s_nop 0
    buffer_load_dwordx4 v164, s[48:51], s64 offen lds
    s_add_u32 s70, s70, 128
    s_add_u32 s71, s71, 128
    s_add_u32 s60, s60, s65
    s_add_u32 s61, s61, s65
    s_add_u32 s62, s62, s65
    s_add_u32 s63, s63, s65
    s_add_u32 s64, s64, 0x60000
    v_lshlrev_b32 v160, 4, v2
    s_mov_b32 s76, s26
    s_and_b32 s77, s27, 0xffff
    s_mov_b32 s78, 0x4400000
    s_mov_b32 s79, 0x20000
    s_cmp_lt_u32 s2, 64
    s_cselect_b32 s84, s30, 0
    s_cmp_lg_u32 s84, 7
    s_cselect_b32 s74, 0x7f000000, 0
    s_cbranch_scc1 K1_NOZ
    v_mov_b32 v20, 0
    v_mov_b32 v21, 0
    v_lshlrev_b32 v22, 3, v2
    s_lshl_b32 s84, s2, 9
    s_add_u32 s84, s84, 0x1e00000
    buffer_store_dwordx2 v[20:21], v22, s[76:79], s84 offen sc1
K1_NOZ:
    s_cmp_ge_u32 s30, 2
    s_cbranch_scc1 K1_NOPHI
    s_mov_b32 s80, s8
    s_and_b32 s81, s9, 0xffff
    s_mov_b32 s82, 0x10000
    s_mov_b32 s83, 0x20000
    s_lshl_b32 s84, s28, 11
    s_lshl_b32 s85, s30, 10
    s_add_u32 s84, s84, s85
    s_add_u32 m0, s85, 0x24000
    s_nop 0
    buffer_load_dwordx4 v160, s[80:83], s84 offen lds
K1_NOPHI:
    s_cmp_ge_u32 s93, 4
    s_cbranch_scc1 K1_TE2
    buffer_load_dword v179, v178, s[96:99], s94 offen
    s_add_u32 s91, s91, 1
    s_and_b32 s91, s91, s92
    s_mul_i32 s94, s91, s95
K1_TE2:
    s_barrier
    s_add_u32 m0, s72, 0x12000
    s_nop 0
    buffer_load_dwordx4 v161, s[36:39], s70 offen lds
    s_add_u32 m0, s72, 0x12400
    s_nop 0
    buffer_load_dwordx4 v162, s[36:39], s70 offen lds
    s_add_u32 m0, s72, 0x12800
    s_nop 0
    buffer_load_dwordx4 v161, s[36:39], s71 offen lds
    s_add_u32 m0, s72, 0x12c00
    s_nop 0
    buffer_load_dwordx4 v162, s[36:39], s71 offen lds
    s_mov_b32 s84, s24
    s_and_b32 s85, s25, 0xffff
    s_mov_b32 s86, 0x100
    s_mov_b32 s87, 0x20000
    s_lshl_b32 s88, s2, 2
    s_add_u32 s88, s88, s74
    v_lshlrev_b32 v165, 23, v2
    v_add_u32 v165, s88, v165
    v_mov_b32 v166, 1
    s_waitcnt vmcnt(4)
    s_barrier
    s_cmp_eq_u32 s31, 1
    s_cbranch_scc1 K1_H1
    ds_read_b128 a[0:3], v168 offset:0
    ds_read_b128 a[16:19], v169 offset:0
    ds_read_b64_tr_b16 a[32:33], v172 offset:0
    ds_read_b64_tr_b16 a[34:35], v172 offset:1792
    ds_read_b64_tr_b16 a[36:37], v172 offset:7168
    ds_read_b64_tr_b16 a[38:39], v172 offset:8960
    ds_read_b64_tr_b16 a[40:41], v172 offset:32
    ds_read_b64_tr_b16 a[42:43], v172 offset:1824
    ds_read_b64_tr_b16 a[44:45], v172 offset:7200
    ds_read_b64_tr_b16 a[46:47], v172 offset:8992
    ds_read_b128 a[4:7], v168 offset:2048
    ds_read_b128 a[20:23], v169 offset:2048
    ds_read_b128 a[8:11], v168 offset:4096
    ds_read_b128 a[24:27], v169 offset:4096
    ds_read_b128 a[12:15], v168 offset:6144
    ds_read_b64_tr_b16 a[48:49], v172 offset:64
    ds_read_b64_tr_b16 a[50:51], v172 offset:1856
    ds_read_b64_tr_b16 a[52:53], v172 offset:7232
    ds_read_b64_tr_b16 a[54:55], v172 offset:9024
    ds_read_b64_tr_b16 a[64:65], v172 offset:14336
    s_waitcnt lgkmcnt(0)
    s_mov_b32 s74, 7
    s_waitcnt lgkmcnt(7)
    v_mfma_f32_16x16x32_bf16 v[0:3], a[32:35], a[0:3], 0
    ds_read_b128 a[28:31], v169 offset:6144
    s_add_u32 m0, s52, 0x12000
    v_mfma_f32_16x16x32_bf16 v[0:3], a[36:39], a[16:19], v[0:3]
    buffer_load_dwordx4 v163, s[40:43], s60 offen lds
    v_mfma_f32_16x16x32_bf16 v[16:19], a[44:47], a[16:19], 0
    ds_read_b64_tr_b16 a[66:67], v172 offset:16128
    v_mfma_f32_16x16x32_bf16 v[16:19], a[40:43], a[0:3], v[16:19]
    ds_read_b64_tr_b16 a[68:69], v172 offset:21504
    s_waitcnt lgkmcnt(7)
    v_mfma_f32_16x16x32_bf16 v[20:23], a[40:43], a[4:7], 0
    ds_read_b64_tr_b16 a[70:71], v172 offset:23296
    s_add_u32 m0, s53, 0x12000
    v_mfma_f32_16x16x32_bf16 v[20:23], a[44:47], a[20:23], v[20:23]
    buffer_load_dwordx4 v163, s[40:43], s61 offen lds
    v_mfma_f32_16x16x32_bf16 v[4:7], a[36:39], a[20:23], 0
    ds_read_b64_tr_b16 a[56:57], v172 offset:96
    v_mfma_f32_16x16x32_bf16 v[4:7], a[32:35], a[4:7], v[4:7]
    ds_read_b64_tr_b16 a[58:59], v172 offset:1888
    s_waitcnt lgkmcnt(8)
    v_mfma_f32_16x16x32_bf16 v[8:11], a[32:35], a[8:11], 0
    ds_read_b64_tr_b16 a[60:61], v172 offset:7264
    s_add_u32 m0, s54, 0x12000
    v_mfma_f32_16x16x32_bf16 v[8:11], a[36:39], a[24:27], v[8:11]
    buffer_load_dwordx4 v163, s[44:47], s62 offen lds
    v_mfma_f32_16x16x32_bf16 v[24:27], a[44:47], a[24:27], 0
    ds_read_b64_tr_b16 a[62:63], v172 offset:9056
    v_mfma_f32_16x16x32_bf16 v[24:27], a[40:43], a[8:11], v[24:27]
    s_waitcnt lgkmcnt(7)
    v_mfma_f32_16x16x32_bf16 v[28:31], a[40:43], a[12:15], 0
    s_add_u32 m0, s55, 0x12000
    v_mfma_f32_16x16x32_bf16 v[28:31], a[44:47], a[28:31], v[28:31]
    buffer_load_dwordx4 v163, s[44:47], s63 offen lds
    v_mfma_f32_16x16x32_bf16 v[12:15], a[36:39], a[28:31], 0
    ds_read_b64_tr_b16 a[40:41], v172 offset:14400
    v_mfma_f32_16x16x32_bf16 v[12:15], a[32:35], a[12:15], v[12:15]
    ds_read_b64_tr_b16 a[42:43], v172 offset:16192
    v_mfma_f32_16x16x32_bf16 v[44:47], a[48:51], a[12:15], 0
    ds_read_b64_tr_b16 a[44:45], v172 offset:21568
    s_add_u32 m0, s56, 0x12000
    v_mfma_f32_16x16x32_bf16 v[44:47], a[52:55], a[28:31], v[44:47]
    buffer_load_dwordx4 v164, s[48:51], s64 offen lds
    v_mfma_f32_16x16x32_bf16 v[40:43], a[52:55], a[24:27], 0
    ds_read_b64_tr_b16 a[46:47], v172 offset:23360
    v_mfma_f32_16x16x32_bf16 v[40:43], a[48:51], a[8:11], v[40:43]
    ds_read_b64_tr_b16 a[32:33], v172 offset:14368
    v_mfma_f32_16x16x32_bf16 v[36:39], a[48:51], a[4:7], 0
    ds_read_b64_tr_b16 a[34:35], v172 offset:16160
    v_mfma_f32_16x16x32_bf16 v[36:39], a[52:55], a[20:23], v[36:39]
    ds_read_b64_tr_b16 a[36:37], v172 offset:21536
    v_mfma_f32_16x16x32_bf16 v[32:35], a[52:55], a[16:19], 0
    ds_read_b64_tr_b16 a[38:39], v172 offset:23328
    v_mfma_f32_16x16x32_bf16 v[32:35], a[48:51], a[0:3], v[32:35]
    ds_read_b64_tr_b16 a[48:49], v172 offset:14432
    s_waitcnt lgkmcnt(9)
    v_mfma_f32_16x16x32_bf16 v[48:51], a[56:59], a[0:3], 0
    ds_read_b64_tr_b16 a[50:51], v172 offset:16224
    v_mfma_f32_16x16x32_bf16 v[48:51], a[60:63], a[16:19], v[48:51]
    ds_read_b64_tr_b16 a[52:53], v172 offset:21600
    v_mfma_f32_16x16x32_bf16 v[52:55], a[60:63], a[20:23], 0
    ds_read_b64_tr_b16 a[54:55], v172 offset:23392
    v_mfma_f32_16x16x32_bf16 v[52:55], a[56:59], a[4:7], v[52:55]
    v_mfma_f32_16x16x32_bf16 v[56:59], a[56:59], a[8:11], 0
    v_mfma_f32_16x16x32_bf16 v[56:59], a[60:63], a[24:27], v[56:59]
    v_mfma_f32_16x16x32_bf16 v[60:63], a[60:63], a[28:31], 0
    v_mfma_f32_16x16x32_bf16 v[60:63], a[56:59], a[12:15], v[60:63]
    ds_read_b64_tr_b16 a[56:57], v174 offset:0
    v_mfma_f32_16x16x32_bf16 v[76:79], a[64:67], a[12:15], 0
    ds_read_b64_tr_b16 a[58:59], v174 offset:512
    v_mfma_f32_16x16x32_bf16 v[76:79], a[68:71], a[28:31], v[76:79]
    ds_read_b64_tr_b16 a[60:61], v174 offset:2048
    v_mfma_f32_16x16x32_bf16 v[72:75], a[68:71], a[24:27], 0
    ds_read_b64_tr_b16 a[62:63], v174 offset:2560
    v_mfma_f32_16x16x32_bf16 v[72:75], a[64:67], a[8:11], v[72:75]
    v_mfma_f32_16x16x32_bf16 v[68:71], a[64:67], a[4:7], 0
    v_mfma_f32_16x16x32_bf16 v[68:71], a[68:71], a[20:23], v[68:71]
    v_mfma_f32_16x16x32_bf16 v[64:67], a[68:71], a[16:19], 0
    v_mfma_f32_16x16x32_bf16 v[64:67], a[64:67], a[0:3], v[64:67]
    ds_read_b64_tr_b16 a[64:65], v175 offset:0
    s_add_u32 s70, s70, 128
    s_add_u32 s71, s71, 128
    s_add_u32 s60, s60, s65
    s_add_u32 s61, s61, s65
    s_add_u32 s62, s62, s65
    s_add_u32 s63, s63, s65
    s_add_u32 s64, s64, 0x60000
    buffer_load_dword v179, v178, s[96:99], s94 offen
    s_add_u32 s91, s91, 1
    s_and_b32 s91, s91, s92
    s_mul_i32 s94, s91, s95
    s_branch K1_MID0
.p2align 6
K1_LOOP0:
    s_waitcnt lgkmcnt(7)
    v_mfma_f32_16x16x32_bf16 v[0:3], a[32:35], a[0:3], v[0:3]
    ds_read_b128 a[28:31], v169 offset:6144
    v_mfma_f32_16x16x32_bf16 v[0:3], a[36:39], a[16:19], v[0:3]
    ds_read_b64_tr_b16 a[66:67], v172 offset:16128
    v_mfma_f32_16x16x32_bf16 v[16:19], a[44:47], a[16:19], v[16:19]
    ds_read_b64_tr_b16 a[68:69], v172 offset:21504
    v_mfma_f32_16x16x32_bf16 v[16:19], a[40:43], a[0:3], v[16:19]
    ds_read_b64_tr_b16 a[70:71], v172 offset:23296
    s_waitcnt lgkmcnt(8)
    v_mfma_f32_16x16x32_bf16 v[20:23], a[40:43], a[4:7], v[20:23]
    ds_read_b64_tr_b16 a[56:57], v172 offset:96
    v_mfma_f32_16x16x32_bf16 v[20:23], a[44:47], a[20:23], v[20:23]
    ds_read_b64_tr_b16 a[58:59], v172 offset:1888
    v_mfma_f32_16x16x32_bf16 v[4:7], a[36:39], a[20:23], v[4:7]
    ds_read_b64_tr_b16 a[60:61], v172 offset:7264
    v_mfma_f32_16x16x32_bf16 v[4:7], a[32:35], a[4:7], v[4:7]
    ds_read_b64_tr_b16 a[62:63], v172 offset:9056
    s_waitcnt lgkmcnt(10)
    v_mfma_f32_16x16x32_bf16 v[8:11], a[32:35], a[8:11], v[8:11]
    v_mfma_f32_16x16x32_bf16 v[8:11], a[36:39], a[24:27], v[8:11]
    v_mfma_f32_16x16x32_bf16 v[24:27], a[44:47], a[24:27], v[24:27]
    v_mfma_f32_16x16x32_bf16 v[24:27], a[40:43], a[8:11], v[24:27]
    s_waitcnt lgkmcnt(7)
    v_mfma_f32_16x16x32_bf16 v[28:31], a[40:43], a[12:15], v[28:31]
    v_mfma_f32_16x16x32_bf16 v[28:31], a[44:47], a[28:31], v[28:31]
    ds_read_b64_tr_b16 a[40:41], v172 offset:14400
    v_mfma_f32_16x16x32_bf16 v[12:15], a[36:39], a[28:31], v[12:15]
    ds_read_b64_tr_b16 a[42:43], v172 offset:16192
    v_mfma_f32_16x16x32_bf16 v[12:15], a[32:35], a[12:15], v[12:15]
    ds_read_b64_tr_b16 a[44:45], v172 offset:21568
    v_mfma_f32_16x16x32_bf16 v[44:47], a[48:51], a[12:15], v[44:47]
    ds_read_b64_tr_b16 a[46:47], v172 offset:23360
    v_mfma_f32_16x16x32_bf16 v[44:47], a[52:55], a[28:31], v[44:47]
    ds_read_b64_tr_b16 a[32:33], v172 offset:14368
    v_mfma_f32_16x16x32_bf16 v[40:43], a[52:55], a[24:27], v[40:43]
    ds_read_b64_tr_b16 a[34:35], v172 offset:16160
    v_mfma_f32_16x16x32_bf16 v[40:43], a[48:51], a[8:11], v[40:43]
    ds_read_b64_tr_b16 a[36:37], v172 offset:21536
    v_mfma_f32_16x16x32_bf16 v[36:39], a[48:51], a[4:7], v[36:39]
    ds_read_b64_tr_b16 a[38:39], v172 offset:23328
    v_mfma_f32_16x16x32_bf16 v[36:39], a[52:55], a[20:23], v[36:39]
    v_mfma_f32_16x16x32_bf16 v[32:35], a[52:55], a[16:19], v[32:35]
    v_mfma_f32_16x16x32_bf16 v[32:35], a[48:51], a[0:3], v[32:35]
    ds_read_b64_tr_b16 a[48:49], v172 offset:14432
    buffer_load_dword v179, v178, s[96:99], s94 offen
    s_add_u32 s91, s91, 1
    s_and_b32 s91, s91, s92
    s_mul_i32 s94, s91, s95
    s_waitcnt lgkmcnt(9)
    v_mfma_f32_16x16x32_bf16 v[48:51], a[56:59], a[0:3], v[48:51]
    ds_read_b64_tr_b16 a[50:51], v172 offset:16224
    v_mfma_f32_16x16x32_bf16 v[48:51], a[60:63], a[16:19], v[48:51]
    ds_read_b64_tr_b16 a[52:53], v172 offset:21600
    v_mfma_f32_16x16x32_bf16 v[52:55], a[60:63], a[20:23], v[52:55]
    ds_read_b64_tr_b16 a[54:55], v172 offset:23392
    v_mfma_f32_16x16x32_bf16 v[52:55], a[56:59], a[4:7], v[52:55]
    v_mfma_f32_16x16x32_bf16 v[56:59], a[56:59], a[8:11], v[56:59]
    v_mfma_f32_16x16x32_bf16 v[56:59], a[60:63], a[24:27], v[56:59]
    v_mfma_f32_16x16x32_bf16 v[60:63], a[60:63], a[28:31], v[60:63]
    v_mfma_f32_16x16x32_bf16 v[60:63], a[56:59], a[12:15], v[60:63]
    ds_read_b64_tr_b16 a[56:57], v174 offset:0
    v_mfma_f32_16x16x32_bf16 v[76:79], a[64:67], a[12:15], v[76:79]
    ds_read_b64_tr_b16 a[58:59], v174 offset:512
    v_mfma_f32_16x16x32_bf16 v[76:79], a[68:71], a[28:31], v[76:79]
    ds_read_b64_tr_b16 a[60:61], v174 offset:2048
    v_mfma_f32_16x16x32_bf16 v[72:75], a[68:71], a[24:27], v[72:75]
    ds_read_b64_tr_b16 a[62:63], v174 offset:2560
    v_mfma_f32_16x16x32_bf16 v[72:75], a[64:67], a[8:11], v[72:75]
    v_mfma_f32_16x16x32_bf16 v[68:71], a[64:67], a[4:7], v[68:71]
    v_mfma_f32_16x16x32_bf16 v[68:71], a[68:71], a[20:23], v[68:71]
    v_mfma_f32_16x16x32_bf16 v[64:67], a[68:71], a[16:19], v[64:67]
    v_mfma_f32_16x16x32_bf16 v[64:67], a[64:67], a[0:3], v[64:67]
    ds_read_b64_tr_b16 a[64:65], v175 offset:0
K1_MID0:
    s_waitcnt lgkmcnt(9)
    v_mfma_f32_16x16x32_bf16 v[80:83], a[32:35], a[0:3], v[80:83]
    ds_read_b64_tr_b16 a[66:67], v175 offset:512
    v_mfma_f32_16x16x32_bf16 v[80:83], a[36:39], a[16:19], v[80:83]
    ds_read_b64_tr_b16 a[68:69], v175 offset:2048
    v_mfma_f32_16x16x32_bf16 v[84:87], a[36:39], a[20:23], v[84:87]
    ds_read_b64_tr_b16 a[70:71], v175 offset:2560
    v_mfma_f32_16x16x32_bf16 v[84:87], a[32:35], a[4:7], v[84:87]
    v_mfma_f32_16x16x32_bf16 v[88:91], a[32:35], a[8:11], v[88:91]
    v_mfma_f32_16x16x32_bf16 v[88:91], a[36:39], a[24:27], v[88:91]
    v_mfma_f32_16x16x32_bf16 v[92:95], a[36:39], a[28:31], v[92:95]
    v_mfma_f32_16x16x32_bf16 v[92:95], a[32:35], a[12:15], v[92:95]
    s_waitcnt vmcnt(1) lgkmcnt(0)
    s_barrier
    s_setprio 2
    ds_read_b64_tr_b16 a[32:33], v173 offset:0
    v_mfma_f32_16x16x32_bf16 v[108:111], a[40:43], a[12:15], v[108:111]
    ds_read_b64_tr_b16 a[34:35], v173 offset:1792
    s_add_u32 m0, s72, 0x0
    v_mfma_f32_16x16x32_bf16 v[108:111], a[44:47], a[28:31], v[108:111]
    buffer_load_dwordx4 v161, s[36:39], s70 offen lds
    v_mfma_f32_16x16x32_bf16 v[104:107], a[44:47], a[24:27], v[104:107]
    ds_read_b64_tr_b16 a[36:37], v173 offset:7168
    s_add_u32 m0, s72, 0x400
    v_mfma_f32_16x16x32_bf16 v[104:107], a[40:43], a[8:11], v[104:107]
    buffer_load_dwordx4 v162, s[36:39], s70 offen lds
    v_mfma_f32_16x16x32_bf16 v[100:103], a[40:43], a[4:7], v[100:103]
    ds_read_b64_tr_b16 a[38:39], v173 offset:8960
    s_add_u32 m0, s72, 0x800
    v_mfma_f32_16x16x32_bf16 v[100:103], a[44:47], a[20:23], v[100:103]
    buffer_load_dwordx4 v161, s[36:39], s71 offen lds
    v_mfma_f32_16x16x32_bf16 v[96:99], a[44:47], a[16:19], v[96:99]
    v_mfma_f32_16x16x32_bf16 v[96:99], a[40:43], a[0:3], v[96:99]
    ds_read_b64_tr_b16 a[40:41], v173 offset:32
    v_mfma_f32_16x16x32_bf16 v[112:115], a[48:51], a[0:3], v[112:115]
    ds_read_b64_tr_b16 a[42:43], v173 offset:1824
    s_add_u32 m0, s72, 0xc00
    v_mfma_f32_16x16x32_bf16 v[112:115], a[52:55], a[16:19], v[112:115]
    buffer_load_dwordx4 v162, s[36:39], s71 offen lds
    v_mfma_f32_16x16x32_bf16 v[116:119], a[52:55], a[20:23], v[116:119]
    ds_read_b64_tr_b16 a[44:45], v173 offset:7200
    v_mfma_f32_16x16x32_bf16 v[116:119], a[48:51], a[4:7], v[116:119]
    ds_read_b64_tr_b16 a[46:47], v173 offset:8992
    v_mfma_f32_16x16x32_bf16 v[120:123], a[48:51], a[8:11], v[120:123]
    s_add_u32 m0, s52, 0x0
    v_mfma_f32_16x16x32_bf16 v[120:123], a[52:55], a[24:27], v[120:123]
    buffer_load_dwordx4 v163, s[40:43], s60 offen lds
    v_mfma_f32_16x16x32_bf16 v[124:127], a[52:55], a[28:31], v[124:127]
    v_mfma_f32_16x16x32_bf16 v[124:127], a[48:51], a[12:15], v[124:127]
    ds_read_b64_tr_b16 a[48:49], v173 offset:64
    v_mfma_f32_16x16x32_bf16 v[140:143], a[56:59], a[12:15], v[140:143]
    ds_read_b64_tr_b16 a[50:51], v173 offset:1856
    s_add_u32 m0, s53, 0x0
    v_mfma_f32_16x16x32_bf16 v[140:143], a[60:63], a[28:31], v[140:143]
    buffer_load_dwordx4 v163, s[40:43], s61 offen lds
    v_mfma_f32_16x16x32_bf16 v[156:159], a[68:71], a[28:31], v[156:159]
    ds_read_b64_tr_b16 a[52:53], v173 offset:7232
    v_mfma_f32_16x16x32_bf16 v[156:159], a[64:67], a[12:15], v[156:159]
    ds_read_b128 a[12:15], v170 offset:6144
    v_mfma_f32_16x16x32_bf16 v[152:155], a[64:67], a[8:11], v[152:155]
    ds_read_b128 a[28:31], v171 offset:6144
    s_add_u32 m0, s54, 0x0
    v_mfma_f32_16x16x32_bf16 v[152:155], a[68:71], a[24:27], v[152:155]
    buffer_load_dwordx4 v163, s[44:47], s62 offen lds
    v_mfma_f32_16x16x32_bf16 v[136:139], a[60:63], a[24:27], v[136:139]
    ds_read_b64_tr_b16 a[54:55], v173 offset:9024
    v_mfma_f32_16x16x32_bf16 v[136:139], a[56:59], a[8:11], v[136:139]
    ds_read_b128 a[8:11], v170 offset:4096
    v_mfma_f32_16x16x32_bf16 v[132:135], a[56:59], a[4:7], v[132:135]
    ds_read_b128 a[24:27], v171 offset:4096
    s_add_u32 m0, s55, 0x0
    v_mfma_f32_16x16x32_bf16 v[132:135], a[60:63], a[20:23], v[132:135]
    buffer_load_dwordx4 v163, s[44:47], s63 offen lds
    v_mfma_f32_16x16x32_bf16 v[148:151], a[68:71], a[20:23], v[148:151]
    v_mfma_f32_16x16x32_bf16 v[148:151], a[64:67], a[4:7], v[148:151]
    ds_read_b128 a[4:7], v170 offset:2048
    v_mfma_f32_16x16x32_bf16 v[144:147], a[64:67], a[0:3], v[144:147]
    ds_read_b128 a[20:23], v171 offset:2048
    s_add_u32 m0, s56, 0x0
    v_mfma_f32_16x16x32_bf16 v[144:147], a[68:71], a[16:19], v[144:147]
    buffer_load_dwordx4 v164, s[48:51], s64 offen lds
    v_mfma_f32_16x16x32_bf16 v[128:131], a[60:63], a[16:19], v[128:131]
    ds_read_b64_tr_b16 a[64:65], v173 offset:14336
    v_mfma_f32_16x16x32_bf16 v[128:131], a[56:59], a[0:3], v[128:131]
    ds_read_b128 a[0:3], v170 offset:0
    s_setprio 0
    s_add_u32 s70, s70, 128
    s_add_u32 s71, s71, 128
    s_add_u32 s60, s60, s65
    s_add_u32 s61, s61, s65
    s_add_u32 s62, s62, s65
    s_add_u32 s63, s63, s65
    s_add_u32 s64, s64, 0x60000
    s_waitcnt lgkmcnt(7)
    v_mfma_f32_16x16x32_bf16 v[12:15], a[32:35], a[12:15], v[12:15]
    ds_read_b128 a[16:19], v171 offset:0
    v_mfma_f32_16x16x32_bf16 v[12:15], a[36:39], a[28:31], v[12:15]
    ds_read_b64_tr_b16 a[66:67], v173 offset:16128
    v_mfma_f32_16x16x32_bf16 v[28:31], a[44:47], a[28:31], v[28:31]
    ds_read_b64_tr_b16 a[68:69], v173 offset:21504
    v_mfma_f32_16x16x32_bf16 v[28:31], a[40:43], a[12:15], v[28:31]
    ds_read_b64_tr_b16 a[70:71], v173 offset:23296
    s_waitcnt lgkmcnt(8)
    v_mfma_f32_16x16x32_bf16 v[24:27], a[40:43], a[8:11], v[24:27]
    ds_read_b64_tr_b16 a[56:57], v173 offset:96
    v_mfma_f32_16x16x32_bf16 v[24:27], a[44:47], a[24:27], v[24:27]
    ds_read_b64_tr_b16 a[58:59], v173 offset:1888
    v_mfma_f32_16x16x32_bf16 v[8:11], a[36:39], a[24:27], v[8:11]
    ds_read_b64_tr_b16 a[60:61], v173 offset:7264
    v_mfma_f32_16x16x32_bf16 v[8:11], a[32:35], a[8:11], v[8:11]
    ds_read_b64_tr_b16 a[62:63], v173 offset:9056
    s_waitcnt lgkmcnt(10)
    v_mfma_f32_16x16x32_bf16 v[4:7], a[32:35], a[4:7], v[4:7]
    v_mfma_f32_16x16x32_bf16 v[4:7], a[36:39], a[20:23], v[4:7]
    v_mfma_f32_16x16x32_bf16 v[20:23], a[44:47], a[20:23], v[20:23]
    v_mfma_f32_16x16x32_bf16 v[20:23], a[40:43], a[4:7], v[20:23]
    s_waitcnt lgkmcnt(7)
    v_mfma_f32_16x16x32_bf16 v[16:19], a[40:43], a[0:3], v[16:19]
    v_mfma_f32_16x16x32_bf16 v[16:19], a[44:47], a[16:19], v[16:19]
    ds_read_b64_tr_b16 a[40:41], v173 offset:14400
    v_mfma_f32_16x16x32_bf16 v[0:3], a[36:39], a[16:19], v[0:3]
    ds_read_b64_tr_b16 a[42:43], v173 offset:16192
    v_mfma_f32_16x16x32_bf16 v[0:3], a[32:35], a[0:3], v[0:3]
    ds_read_b64_tr_b16 a[44:45], v173 offset:21568
    v_mfma_f32_16x16x32_bf16 v[32:35], a[48:51], a[0:3], v[32:35]
    ds_read_b64_tr_b16 a[46:47], v173 offset:23360
    v_mfma_f32_16x16x32_bf16 v[32:35], a[52:55], a[16:19], v[32:35]
    ds_read_b64_tr_b16 a[32:33], v173 offset:14368
    v_mfma_f32_16x16x32_bf16 v[36:39], a[52:55], a[20:23], v[36:39]
    ds_read_b64_tr_b16 a[34:35], v173 offset:16160
    v_mfma_f32_16x16x32_bf16 v[36:39], a[48:51], a[4:7], v[36:39]
    ds_read_b64_tr_b16 a[36:37], v173 offset:21536
    v_mfma_f32_16x16x32_bf16 v[40:43], a[48:51], a[8:11], v[40:43]
    ds_read_b64_tr_b16 a[38:39], v173 offset:23328
    v_mfma_f32_16x16x32_bf16 v[40:43], a[52:55], a[24:27], v[40:43]
    v_mfma_f32_16x16x32_bf16 v[44:47], a[52:55], a[28:31], v[44:47]
    v_mfma_f32_16x16x32_bf16 v[44:47], a[48:51], a[12:15], v[44:47]
    ds_read_b64_tr_b16 a[48:49], v173 offset:14432
    buffer_load_dword v179, v178, s[96:99], s94 offen
    s_add_u32 s91, s91, 1
    s_and_b32 s91, s91, s92
    s_mul_i32 s94, s91, s95
    s_waitcnt lgkmcnt(9)
    v_mfma_f32_16x16x32_bf16 v[60:63], a[56:59], a[12:15], v[60:63]
    ds_read_b64_tr_b16 a[50:51], v173 offset:16224
    v_mfma_f32_16x16x32_bf16 v[60:63], a[60:63], a[28:31], v[60:63]
    ds_read_b64_tr_b16 a[52:53], v173 offset:21600
    v_mfma_f32_16x16x32_bf16 v[56:59], a[60:63], a[24:27], v[56:59]
    ds_read_b64_tr_b16 a[54:55], v173 offset:23392
    v_mfma_f32_16x16x32_bf16 v[56:59], a[56:59], a[8:11], v[56:59]
    v_mfma_f32_16x16x32_bf16 v[52:55], a[56:59], a[4:7], v[52:55]
    v_mfma_f32_16x16x32_bf16 v[52:55], a[60:63], a[20:23], v[52:55]
    v_mfma_f32_16x16x32_bf16 v[48:51], a[60:63], a[16:19], v[48:51]
    v_mfma_f32_16x16x32_bf16 v[48:51], a[56:59], a[0:3], v[48:51]
    ds_read_b64_tr_b16 a[56:57], v176 offset:0
    v_mfma_f32_16x16x32_bf16 v[64:67], a[64:67], a[0:3], v[64:67]
    ds_read_b64_tr_b16 a[58:59], v176 offset:512
    v_mfma_f32_16x16x32_bf16 v[64:67], a[68:71], a[16:19], v[64:67]
    ds_read_b64_tr_b16 a[60:61], v176 offset:2048
    v_mfma_f32_16x16x32_bf16 v[68:71], a[68:71], a[20:23], v[68:71]
    ds_read_b64_tr_b16 a[62:63], v176 offset:2560
    v_mfma_f32_16x16x32_bf16 v[68:71], a[64:67], a[4:7], v[68:71]
    buffer_store_dwordx4 v[180:183], v160, s[76:79], s35 offen sc1
    s_add_u32 s35, s35, 0x400
    v_mfma_f32_16x16x32_bf16 v[72:75], a[64:67], a[8:11], v[72:75]
    v_mfma_f32_16x16x32_bf16 v[72:75], a[68:71], a[24:27], v[72:75]
    v_mfma_f32_16x16x32_bf16 v[76:79], a[68:71], a[28:31], v[76:79]
    v_mfma_f32_16x16x32_bf16 v[76:79], a[64:67], a[12:15], v[76:79]
    ds_read_b64_tr_b16 a[64:65], v177 offset:0
    s_waitcnt lgkmcnt(9)
    v_mfma_f32_16x16x32_bf16 v[92:95], a[32:35], a[12:15], v[92:95]
    ds_read_b64_tr_b16 a[66:67], v177 offset:512
    v_mfma_f32_16x16x32_bf16 v[92:95], a[36:39], a[28:31], v[92:95]
    ds_read_b64_tr_b16 a[68:69], v177 offset:2048
    v_mfma_f32_16x16x32_bf16 v[88:91], a[36:39], a[24:27], v[88:91]
    ds_read_b64_tr_b16 a[70:71], v177 offset:2560
    v_mfma_f32_16x16x32_bf16 v[88:91], a[32:35], a[8:11], v[88:91]
    v_mfma_f32_16x16x32_bf16 v[84:87], a[32:35], a[4:7], v[84:87]
    v_mfma_f32_16x16x32_bf16 v[84:87], a[36:39], a[20:23], v[84:87]
    v_mfma_f32_16x16x32_bf16 v[80:83], a[36:39], a[16:19], v[80:83]
    v_mfma_f32_16x16x32_bf16 v[80:83], a[32:35], a[0:3], v[80:83]
    s_waitcnt vmcnt(2) lgkmcnt(0)
    s_barrier
    s_setprio 2
    ds_read_b64_tr_b16 a[32:33], v172 offset:0
    v_mfma_f32_16x16x32_bf16 v[96:99], a[40:43], a[0:3], v[96:99]
    ds_read_b64_tr_b16 a[34:35], v172 offset:1792
    s_add_u32 m0, s72, 0x12000
    v_mfma_f32_16x16x32_bf16 v[96:99], a[44:47], a[16:19], v[96:99]
    buffer_load_dwordx4 v161, s[36:39], s70 offen lds
    v_mfma_f32_16x16x32_bf16 v[100:103], a[44:47], a[20:23], v[100:103]
    ds_read_b64_tr_b16 a[36:37], v172 offset:7168
    s_add_u32 m0, s72, 0x12400
    v_mfma_f32_16x16x32_bf16 v[100:103], a[40:43], a[4:7], v[100:103]
    buffer_load_dwordx4 v162, s[36:39], s70 offen lds
    v_mfma_f32_16x16x32_bf16 v[104:107], a[40:43], a[8:11], v[104:107]
    ds_read_b64_tr_b16 a[38:39], v172 offset:8960
    s_add_u32 m0, s72, 0x12800
    v_mfma_f32_16x16x32_bf16 v[104:107], a[44:47], a[24:27], v[104:107]
    buffer_load_dwordx4 v161, s[36:39], s71 offen lds
    v_mfma_f32_16x16x32_bf16 v[108:111], a[44:47], a[28:31], v[108:111]
    v_mfma_f32_16x16x32_bf16 v[108:111], a[40:43], a[12:15], v[108:111]
    ds_read_b64_tr_b16 a[40:41], v172 offset:32
    v_mfma_f32_16x16x32_bf16 v[124:127], a[48:51], a[12:15], v[124:127]
    ds_read_b64_tr_b16 a[42:43], v172 offset:1824
    s_add_u32 m0, s72, 0x12c00
    v_mfma_f32_16x16x32_bf16 v[124:127], a[52:55], a[28:31], v[124:127]
    buffer_load_dwordx4 v162, s[36:39], s71 offen lds
    v_mfma_f32_16x16x32_bf16 v[120:123], a[52:55], a[24:27], v[120:123]
    ds_read_b64_tr_b16 a[44:45], v172 offset:7200
    v_mfma_f32_16x16x32_bf16 v[120:123], a[48:51], a[8:11], v[120:123]
    ds_read_b64_tr_b16 a[46:47], v172 offset:8992
    v_mfma_f32_16x16x32_bf16 v[116:119], a[48:51], a[4:7], v[116:119]
    s_add_u32 m0, s52, 0x12000
    v_mfma_f32_16x16x32_bf16 v[116:119], a[52:55], a[20:23], v[116:119]
    buffer_load_dwordx4 v163, s[40:43], s60 offen lds
    v_mfma_f32_16x16x32_bf16 v[112:115], a[52:55], a[16:19], v[112:115]
    v_mfma_f32_16x16x32_bf16 v[112:115], a[48:51], a[0:3], v[112:115]
    ds_read_b64_tr_b16 a[48:49], v172 offset:64
    v_mfma_f32_16x16x32_bf16 v[128:131], a[56:59], a[0:3], v[128:131]
    ds_read_b64_tr_b16 a[50:51], v172 offset:1856
    s_add_u32 m0, s53, 0x12000
    v_mfma_f32_16x16x32_bf16 v[128:131], a[60:63], a[16:19], v[128:131]
    buffer_load_dwordx4 v163, s[40:43], s61 offen lds
    v_mfma_f32_16x16x32_bf16 v[144:147], a[68:71], a[16:19], v[144:147]
    ds_read_b64_tr_b16 a[52:53], v172 offset:7232
    v_mfma_f32_16x16x32_bf16 v[144:147], a[64:67], a[0:3], v[144:147]
    ds_read_b128 a[0:3], v168 offset:0
    v_mfma_f32_16x16x32_bf16 v[148:151], a[64:67], a[4:7], v[148:151]
    ds_read_b128 a[16:19], v169 offset:0
    s_add_u32 m0, s54, 0x12000
    v_mfma_f32_16x16x32_bf16 v[148:151], a[68:71], a[20:23], v[148:151]
    buffer_load_dwordx4 v163, s[44:47], s62 offen lds
    v_mfma_f32_16x16x32_bf16 v[132:135], a[60:63], a[20:23], v[132:135]
    ds_read_b64_tr_b16 a[54:55], v172 offset:9024
    v_mfma_f32_16x16x32_bf16 v[132:135], a[56:59], a[4:7], v[132:135]
    ds_read_b128 a[4:7], v168 offset:2048
    v_mfma_f32_16x16x32_bf16 v[136:139], a[56:59], a[8:11], v[136:139]
    ds_read_b128 a[20:23], v169 offset:2048
    s_add_u32 m0, s55, 0x12000
    v_mfma_f32_16x16x32_bf16 v[136:139], a[60:63], a[24:27], v[136:139]
    buffer_load_dwordx4 v163, s[44:47], s63 offen lds
    v_mfma_f32_16x16x32_bf16 v[152:155], a[68:71], a[24:27], v[152:155]
    v_mfma_f32_16x16x32_bf16 v[152:155], a[64:67], a[8:11], v[152:155]
    ds_read_b128 a[8:11], v168 offset:4096
    v_mfma_f32_16x16x32_bf16 v[156:159], a[64:67], a[12:15], v[156:159]
    ds_read_b128 a[24:27], v169 offset:4096
    s_add_u32 m0, s56, 0x12000
    v_mfma_f32_16x16x32_bf16 v[156:159], a[68:71], a[28:31], v[156:159]
    buffer_load_dwordx4 v164, s[48:51], s64 offen lds
    v_mfma_f32_16x16x32_bf16 v[140:143], a[60:63], a[28:31], v[140:143]
    ds_read_b64_tr_b16 a[64:65], v172 offset:14336
    v_mfma_f32_16x16x32_bf16 v[140:143], a[56:59], a[12:15], v[140:143]
    ds_read_b128 a[12:15], v168 offset:6144
    s_setprio 0
    s_add_u32 s70, s70, 128
    s_add_u32 s71, s71, 128
    s_add_u32 s60, s60, s65
    s_add_u32 s61, s61, s65
    s_add_u32 s62, s62, s65
    s_add_u32 s63, s63, s65
    s_add_u32 s64, s64, 0x60000
    s_sub_u32 s74, s74, 1
    s_cmp_lg_u32 s74, 0
    s_cbranch_scc1 K1_LOOP0
    s_waitcnt lgkmcnt(7)
    v_mfma_f32_16x16x32_bf16 v[0:3], a[32:35], a[0:3], v[0:3]
    ds_read_b128 a[28:31], v169 offset:6144
    s_lshr_b32 s86, s28, 1
    s_mul_i32 s86, s86, 7
    s_and_b32 s89, s28, 1
    s_lshl_b32 s87, s29, 4
    v_mfma_f32_16x16x32_bf16 v[0:3], a[36:39], a[16:19], v[0:3]
    ds_read_b64_tr_b16 a[66:67], v172 offset:16128
    s_lshl_b32 s88, s32, 2
    s_add_u32 s87, s87, s88
    s_lshl_b32 s87, s87, 10
    s_mul_i32 s84, s89, 5
    v_mfma_f32_16x16x32_bf16 v[16:19], a[44:47], a[16:19], v[16:19]
    ds_read_b64_tr_b16 a[68:69], v172 offset:21504
    s_add_u32 s84, s84, s86
    s_lshl_b32 s84, s84, 17
    s_add_u32 s84, s84, s87
    s_lshl_b32 s85, s89, 1
    v_mfma_f32_16x16x32_bf16 v[16:19], a[40:43], a[0:3], v[16:19]
    ds_read_b64_tr_b16 a[70:71], v172 offset:23296
    s_add_u32 s85, s85, s86
    s_add_u32 s85, s85, 2
    s_lshl_b32 s85, s85, 17
    s_add_u32 s85, s85, s87
    s_waitcnt lgkmcnt(8)
    v_mfma_f32_16x16x32_bf16 v[20:23], a[40:43], a[4:7], v[20:23]
    ds_read_b64_tr_b16 a[56:57], v172 offset:96
    s_lshl_b32 s88, s28, 3
    s_add_u32 s88, s88, s29
    s_lshl_b32 s88, s88, 7
    s_lshr_b32 s86, s32, 1
    v_mfma_f32_16x16x32_bf16 v[20:23], a[44:47], a[20:23], v[20:23]
    ds_read_b64_tr_b16 a[58:59], v172 offset:1888
    s_lshl_b32 s86, s86, 6
    s_add_u32 s88, s88, s86
    s_and_b32 s86, s32, 1
    s_lshl_b32 s86, s86, 3
    v_mfma_f32_16x16x32_bf16 v[4:7], a[36:39], a[20:23], v[4:7]
    ds_read_b64_tr_b16 a[60:61], v172 offset:7264
    s_add_u32 s88, s88, s86
    s_add_u32 s88, s88, 0x1c00000
    s_mov_b32 s40, s18
    s_and_b32 s41, s19, 0xffff
    v_mfma_f32_16x16x32_bf16 v[4:7], a[32:35], a[4:7], v[4:7]
    ds_read_b64_tr_b16 a[62:63], v172 offset:9056
    s_mov_b32 s42, 0x700000
    s_mov_b32 s43, 0x20000
    s_mov_b32 s44, s10
    s_and_b32 s45, s11, 0xffff
    s_waitcnt lgkmcnt(10)
    v_mfma_f32_16x16x32_bf16 v[8:11], a[32:35], a[8:11], v[8:11]
    s_mov_b32 s46, 0x200000
    s_mov_b32 s47, 0x20000
    s_mov_b32 s48, s22
    s_and_b32 s49, s23, 0xffff
    v_mfma_f32_16x16x32_bf16 v[8:11], a[36:39], a[24:27], v[8:11]
    s_mov_b32 s50, 0x400000
    s_mov_b32 s51, 0x20000
    s_mov_b32 s52, s24
    s_and_b32 s53, s25, 0xffff
    v_mfma_f32_16x16x32_bf16 v[24:27], a[44:47], a[24:27], v[24:27]
    s_mov_b32 s54, 0x100
    s_mov_b32 s55, 0x20000
    s_lshr_b32 s56, s28, 3
    s_and_b32 s3, s28, 7
    v_mfma_f32_16x16x32_bf16 v[24:27], a[40:43], a[8:11], v[24:27]
    s_mov_b32 s57, s29
    s_lshr_b32 s34, s28, 2
    s_lshl_b32 s58, s3, 4
    s_lshl_b32 s86, s30, 1
    s_waitcnt lgkmcnt(7)
    v_mfma_f32_16x16x32_bf16 v[28:31], a[40:43], a[12:15], v[28:31]
    s_add_u32 s58, s58, s86
    s_lshl_b32 s89, s29, 4
    s_add_u32 s89, s89, s86
    s_lshl_b32 s86, s89, 6
    v_mfma_f32_16x16x32_bf16 v[28:31], a[44:47], a[28:31], v[28:31]
    ds_read_b64_tr_b16 a[40:41], v172 offset:14400
    s_add_u32 s75, s86, 0x1d00000
    s_lshl_b32 s89, s89, 10
    s_lshl_b32 s35, s28, 17
    s_add_u32 s35, s35, s89
    v_mfma_f32_16x16x32_bf16 v[12:15], a[36:39], a[28:31], v[12:15]
    ds_read_b64_tr_b16 a[42:43], v172 offset:16192
    s_add_u32 s35, s35, 0xe00000
    s_lshl_b32 s33, s58, 9
    s_mul_i32 s86, s34, 14
    s_xor_b32 s89, s34, 1
    v_mfma_f32_16x16x32_bf16 v[12:15], a[32:35], a[12:15], v[12:15]
    ds_read_b64_tr_b16 a[44:45], v172 offset:21568
    s_mul_i32 s89, s89, 14
    s_lshl_b32 s96, s58, 10
    s_lshl_b32 s97, s30, 14
    s_lshl_b32 s10, s86, 17
    v_mfma_f32_16x16x32_bf16 v[44:47], a[48:51], a[12:15], v[44:47]
    ds_read_b64_tr_b16 a[46:47], v172 offset:23360
    s_add_u32 s59, s10, s96
    s_lshl_b32 s11, s89, 17
    s_add_u32 s60, s11, s96
    s_lshl_b32 s61, s86, 16
    v_mfma_f32_16x16x32_bf16 v[44:47], a[52:55], a[28:31], v[44:47]
    ds_read_b64_tr_b16 a[32:33], v172 offset:14368
    s_add_u32 s61, s61, s97
    s_lshl_b32 s62, s89, 16
    s_add_u32 s62, s62, s97
    s_lshl_b32 s63, s56, 20
    v_mfma_f32_16x16x32_bf16 v[40:43], a[52:55], a[24:27], v[40:43]
    ds_read_b64_tr_b16 a[34:35], v172 offset:16160
    s_add_u32 s18, s63, 0xe00000
    s_add_u32 s63, s18, s96
    s_lshl_b32 s19, s3, 14
    s_lshl_b32 s96, s57, 11
    v_mfma_f32_16x16x32_bf16 v[40:43], a[48:51], a[8:11], v[40:43]
    ds_read_b64_tr_b16 a[36:37], v172 offset:21536
    s_add_u32 s19, s19, s96
    s_lshl_b32 s22, s3, 13
    s_and_b32 s96, s96, 0x1800
    s_add_u32 s22, s22, s96
    v_mfma_f32_16x16x32_bf16 v[36:39], a[48:51], a[4:7], v[36:39]
    ds_read_b64_tr_b16 a[38:39], v172 offset:23328
    s_lshr_b32 s96, s57, 2
    s_lshl_b32 s96, s96, 16
    s_add_u32 s22, s22, s96
    s_lshl_b32 s64, s56, 19
    v_mfma_f32_16x16x32_bf16 v[36:39], a[52:55], a[20:23], v[36:39]
    s_add_u32 s64, s64, s97
    s_lshl_b32 s65, s30, 11
    s_lshl_b32 s86, s34, 2
    s_add_u32 s86, s86, 0x1e00000
    v_mfma_f32_16x16x32_bf16 v[32:35], a[52:55], a[16:19], v[32:35]
    s_lshl_b32 s67, s3, 7
    s_add_u32 s67, s67, s86
    s_lshl_b32 s66, s29, 7
    s_add_u32 s66, s66, s86
    v_mfma_f32_16x16x32_bf16 v[32:35], a[48:51], a[0:3], v[32:35]
    ds_read_b64_tr_b16 a[48:49], v172 offset:14432
    s_lshl_b32 s68, s28, 7
    s_add_u32 s68, s68, 0x1e00400
    s_lshl_b32 s86, s3, 2
    s_add_u32 s86, s86, s56
    s_waitcnt lgkmcnt(9)
    v_mfma_f32_16x16x32_bf16 v[48:51], a[56:59], a[0:3], v[48:51]
    ds_read_b64_tr_b16 a[50:51], v172 offset:16224
    s_lshl_b32 s86, s86, 7
    s_add_u32 s69, s86, 0x1e01400
    s_lshl_b32 s86, s3, 3
    s_add_u32 s86, s86, s57
    v_mfma_f32_16x16x32_bf16 v[48:51], a[60:63], a[16:19], v[48:51]
    ds_read_b64_tr_b16 a[52:53], v172 offset:21600
    s_lshl_b32 s89, s86, 7
    s_lshl_b32 s96, s30, 2
    s_add_u32 s89, s89, s96
    s_add_u32 s70, s89, 0x1e02400
    v_mfma_f32_16x16x32_bf16 v[52:55], a[60:63], a[20:23], v[52:55]
    ds_read_b64_tr_b16 a[54:55], v172 offset:23392
    s_lshl_b32 s86, s86, 18
    s_lshl_b32 s89, s30, 13
    s_add_u32 s86, s86, s89
    s_add_u32 s71, s86, 0x2400000
    v_mfma_f32_16x16x32_bf16 v[52:55], a[56:59], a[4:7], v[52:55]
    s_lshl_b32 s86, s28, 15
    s_lshl_b32 s89, s30, 9
    s_add_u32 s86, s86, s89
    s_add_u32 s72, s86, 0x1a00000
    v_mfma_f32_16x16x32_bf16 v[56:59], a[56:59], a[8:11], v[56:59]
    s_lshl_b32 s86, s28, 10
    s_add_u32 s73, s86, 0x1c00000
    s_lshl_b32 s86, s58, 6
    s_add_u32 s74, s86, 0x1d00000
    v_mfma_f32_16x16x32_bf16 v[56:59], a[60:63], a[24:27], v[56:59]
    s_lshl_b32 s86, s56, 2
    s_add_u32 s86, s86, 0x1e00400
    s_lshl_b32 s67, s3, 7
    s_add_u32 s67, s67, s86
    v_mfma_f32_16x16x32_bf16 v[60:63], a[60:63], a[28:31], v[60:63]
    s_lshl_b32 s68, s29, 7
    s_add_u32 s68, s68, s86
    s_lshl_b32 s70, s31, 18
    s_lshl_b32 s86, s56, 16
    v_mfma_f32_16x16x32_bf16 v[60:63], a[56:59], a[12:15], v[60:63]
    ds_read_b64_tr_b16 a[56:57], v174 offset:0
    s_add_u32 s86, s86, 0x1800
    s_add_u32 s35, s86, s71
    s_lshl_b32 s89, s3, 18
    s_add_u32 s86, s86, s89
    v_mfma_f32_16x16x32_bf16 v[76:79], a[64:67], a[12:15], v[76:79]
    ds_read_b64_tr_b16 a[58:59], v174 offset:512
    s_lshl_b32 s89, s30, 13
    s_add_u32 s86, s86, s89
    s_add_u32 s63, s86, 0x2400000
    s_mov_b32 s90, 0xbdd2d3e8
    v_mfma_f32_16x16x32_bf16 v[76:79], a[68:71], a[28:31], v[76:79]
    ds_read_b64_tr_b16 a[60:61], v174 offset:2048
    s_mov_b32 s91, 0xbdd2d3e8
    s_mov_b32 s92, 1.0
    s_mov_b32 s93, 1.0
    s_mov_b32 s94, 0x3fb8aa3b
    v_mfma_f32_16x16x32_bf16 v[72:75], a[68:71], a[24:27], v[72:75]
    ds_read_b64_tr_b16 a[62:63], v174 offset:2560
    s_mov_b32 s95, 0x3fb8aa3b
    s_mov_b32 s96, 0xbfb8aa3b
    s_mov_b32 s97, 0xbfb8aa3b
    v_lshrrev_b32 v162, 4, v160
    v_mfma_f32_16x16x32_bf16 v[72:75], a[64:67], a[8:11], v[72:75]
    v_lshrrev_b32 v165, 4, v162
    v_bfe_u32 v166, v162, 1, 3
    v_xor_b32 v166, v166, v165
    v_lshlrev_b32 v166, 5, v166
    v_mfma_f32_16x16x32_bf16 v[68:71], a[64:67], a[4:7], v[68:71]
    v_and_b32 v167, 1, v162
    v_lshl_add_u32 v166, v167, 4, v166
    v_lshl_add_u32 v166, v165, 11, v166
    s_lshl_b32 s86, s57, 8
    v_mfma_f32_16x16x32_bf16 v[68:71], a[68:71], a[20:23], v[68:71]
    v_add_u32 v163, s86, v166
    v_xor_b32 v164, 128, v163
    v_add_u32 v164, 0x2000, v164
    v_mfma_f32_16x16x32_bf16 v[64:67], a[68:71], a[16:19], v[64:67]
    v_mfma_f32_16x16x32_bf16 v[64:67], a[64:67], a[0:3], v[64:67]
    ds_read_b64_tr_b16 a[64:65], v175 offset:0
    s_waitcnt lgkmcnt(9)
    v_mfma_f32_16x16x32_bf16 v[80:83], a[32:35], a[0:3], v[80:83]
    ds_read_b64_tr_b16 a[66:67], v175 offset:512
    v_mfma_f32_16x16x32_bf16 v[80:83], a[36:39], a[16:19], v[80:83]
    ds_read_b64_tr_b16 a[68:69], v175 offset:2048
    v_mfma_f32_16x16x32_bf16 v[84:87], a[36:39], a[20:23], v[84:87]
    ds_read_b64_tr_b16 a[70:71], v175 offset:2560
    v_mfma_f32_16x16x32_bf16 v[84:87], a[32:35], a[4:7], v[84:87]
    v_mfma_f32_16x16x32_bf16 v[88:91], a[32:35], a[8:11], v[88:91]
    v_mfma_f32_16x16x32_bf16 v[88:91], a[36:39], a[24:27], v[88:91]
    v_mfma_f32_16x16x32_bf16 v[92:95], a[36:39], a[28:31], v[92:95]
    v_mfma_f32_16x16x32_bf16 v[92:95], a[32:35], a[12:15], v[92:95]
    s_waitcnt vmcnt(0) lgkmcnt(0)
    s_barrier
    ds_read_b64_tr_b16 a[32:33], v173 offset:0
    v_mfma_f32_16x16x32_bf16 v[108:111], a[40:43], a[12:15], v[108:111]
    ds_read_b64_tr_b16 a[34:35], v173 offset:1792
    v_mov_b32 v165, 0x10080
    v_mov_b32 v166, 0
    v_mov_b32 v167, 0
    ds_write_b64 v165, v[166:167]
    v_mfma_f32_16x16x32_bf16 v[108:111], a[44:47], a[28:31], v[108:111]
    ds_read_b64_tr_b16 a[36:37], v173 offset:32
    s_add_u32 s23, s61, 0x0
    s_add_u32 m0, s65, 0
    s_nop 0
    buffer_load_dwordx4 v163, s[40:43], s23 offen lds
    v_mfma_f32_16x16x32_bf16 v[104:107], a[44:47], a[24:27], v[104:107]
    ds_read_b64_tr_b16 a[38:39], v173 offset:1824
    v_mfma_f32_16x16x32_bf16 v[104:107], a[40:43], a[8:11], v[104:107]
    v_mfma_f32_16x16x32_bf16 v[100:103], a[40:43], a[4:7], v[100:103]
    s_add_u32 m0, s65, 1024
    s_nop 0
    buffer_load_dwordx4 v164, s[40:43], s23 offen lds
    v_mfma_f32_16x16x32_bf16 v[100:103], a[44:47], a[20:23], v[100:103]
    v_mfma_f32_16x16x32_bf16 v[96:99], a[44:47], a[16:19], v[96:99]
    v_mfma_f32_16x16x32_bf16 v[96:99], a[40:43], a[0:3], v[96:99]
    ds_read_b64_tr_b16 a[40:41], v173 offset:64
    v_mfma_f32_16x16x32_bf16 v[112:115], a[48:51], a[0:3], v[112:115]
    ds_read_b64_tr_b16 a[42:43], v173 offset:1856
    s_add_u32 s23, s61, 0x50000
    s_add_u32 m0, s65, 16384
    s_nop 0
    buffer_load_dwordx4 v163, s[40:43], s23 offen lds
    v_mfma_f32_16x16x32_bf16 v[112:115], a[52:55], a[16:19], v[112:115]
    ds_read_b64_tr_b16 a[44:45], v173 offset:96
    v_mfma_f32_16x16x32_bf16 v[116:119], a[52:55], a[20:23], v[116:119]
    ds_read_b64_tr_b16 a[46:47], v173 offset:1888
    v_mfma_f32_16x16x32_bf16 v[116:119], a[48:51], a[4:7], v[116:119]
    v_mfma_f32_16x16x32_bf16 v[120:123], a[48:51], a[8:11], v[120:123]
    s_add_u32 m0, s65, 17408
    s_nop 0
    buffer_load_dwordx4 v164, s[40:43], s23 offen lds
    v_mfma_f32_16x16x32_bf16 v[120:123], a[52:55], a[24:27], v[120:123]
    v_mfma_f32_16x16x32_bf16 v[124:127], a[52:55], a[28:31], v[124:127]
    v_mfma_f32_16x16x32_bf16 v[124:127], a[48:51], a[12:15], v[124:127]
    ds_read_b64_tr_b16 a[48:49], v173 offset:14336
    v_mfma_f32_16x16x32_bf16 v[140:143], a[56:59], a[12:15], v[140:143]
    ds_read_b64_tr_b16 a[50:51], v173 offset:16128
    s_add_u32 s23, s61, 0x70000
    s_add_u32 m0, s65, 32768
    s_nop 0
    buffer_load_dwordx4 v163, s[40:43], s23 offen lds
    v_mfma_f32_16x16x32_bf16 v[140:143], a[60:63], a[28:31], v[140:143]
    ds_read_b64_tr_b16 a[52:53], v173 offset:14368
    v_mfma_f32_16x16x32_bf16 v[156:159], a[68:71], a[28:31], v[156:159]
    ds_read_b64_tr_b16 a[54:55], v173 offset:16160
    v_mfma_f32_16x16x32_bf16 v[156:159], a[64:67], a[12:15], v[156:159]
    ds_read_b128 a[12:15], v170 offset:6144
    v_mfma_f32_16x16x32_bf16 v[152:155], a[64:67], a[8:11], v[152:155]
    s_add_u32 m0, s65, 33792
    s_nop 0
    buffer_load_dwordx4 v164, s[40:43], s23 offen lds
    v_mfma_f32_16x16x32_bf16 v[152:155], a[68:71], a[24:27], v[152:155]
    v_mfma_f32_16x16x32_bf16 v[136:139], a[60:63], a[24:27], v[136:139]
    v_mfma_f32_16x16x32_bf16 v[136:139], a[56:59], a[8:11], v[136:139]
    ds_read_b128 a[8:11], v170 offset:4096
    v_mfma_f32_16x16x32_bf16 v[132:135], a[56:59], a[4:7], v[132:135]
    s_add_u32 s23, s61, 0xc0000
    s_add_u32 m0, s65, 49152
    s_nop 0
    buffer_load_dwordx4 v163, s[40:43], s23 offen lds
    v_mfma_f32_16x16x32_bf16 v[132:135], a[60:63], a[20:23], v[132:135]
    v_mfma_f32_16x16x32_bf16 v[148:151], a[68:71], a[20:23], v[148:151]
    v_mfma_f32_16x16x32_bf16 v[148:151], a[64:67], a[4:7], v[148:151]
    ds_read_b128 a[4:7], v170 offset:2048
    v_mfma_f32_16x16x32_bf16 v[144:147], a[64:67], a[0:3], v[144:147]
    s_add_u32 m0, s65, 50176
    s_nop 0
    buffer_load_dwordx4 v164, s[40:43], s23 offen lds
    v_mfma_f32_16x16x32_bf16 v[144:147], a[68:71], a[16:19], v[144:147]
    ds_read_b64_tr_b16 a[64:65], v176 offset:0
    buffer_store_dwordx4 v[180:183], v160, s[76:79], s35 offen offset:1024 sc1
    v_mfma_f32_16x16x32_bf16 v[128:131], a[60:63], a[16:19], v[128:131]
    ds_read_b64_tr_b16 a[66:67], v176 offset:512
    s_andn2_b32 s86, s88, 127
    v_and_b32 v165, 0x70, v160
    buffer_store_dwordx4 v[180:183], v165, s[76:79], s86 offen sc1
    v_mfma_f32_16x16x32_bf16 v[128:131], a[56:59], a[0:3], v[128:131]
    ds_read_b128 a[0:3], v170 offset:0
    s_waitcnt lgkmcnt(0)
    v_mfma_f32_16x16x32_bf16 v[0:3], a[32:35], a[0:3], v[0:3]
    ds_read_b64_tr_b16 a[68:69], v177 offset:0
    v_lshrrev_b32 v162, 2, v160
    buffer_load_dword v161, v162, s[52:55], 0 offen sc1
    v_mfma_f32_16x16x32_bf16 v[4:7], a[32:35], a[4:7], v[4:7]
    ds_read_b64_tr_b16 a[70:71], v177 offset:512
    v_mov_b32 v178, 0xc0135761
    v_mov_b32 v179, 0xc0135761
    v_bfe_u32 v180, v160, 4, 4
    v_lshrrev_b32 v181, 8, v160
    v_mfma_f32_16x16x32_bf16 v[8:11], a[32:35], a[8:11], v[8:11]
    ds_read_b64_tr_b16 a[56:57], v173 offset:14400
    v_lshrrev_b32 v182, 6, v160
    v_bfe_u32 v183, v160, 4, 2
    v_mfma_f32_16x16x32_bf16 v[12:15], a[32:35], a[12:15], v[12:15]
    ds_read_b64_tr_b16 a[58:59], v173 offset:16192
    v_mfma_f32_16x16x32_bf16 v[16:19], a[36:39], a[0:3], v[16:19]
    ds_read_b64_tr_b16 a[60:61], v173 offset:14432
    v_mfma_f32_16x16x32_bf16 v[20:23], a[36:39], a[4:7], v[20:23]
    ds_read_b64_tr_b16 a[62:63], v173 offset:16224
    v_mfma_f32_16x16x32_bf16 v[24:27], a[36:39], a[8:11], v[24:27]
    ds_read_b128 a[16:19], v171 offset:0
    v_mfma_f32_16x16x32_bf16 v[28:31], a[36:39], a[12:15], v[28:31]
    ds_read_b128 a[20:23], v171 offset:2048
    v_mfma_f32_16x16x32_bf16 v[64:67], a[48:51], a[0:3], v[64:67]
    ds_read_b128 a[24:27], v171 offset:4096
    v_mfma_f32_16x16x32_bf16 v[68:71], a[48:51], a[4:7], v[68:71]
    ds_read_b128 a[28:31], v171 offset:6144
    v_mfma_f32_16x16x32_bf16 v[72:75], a[48:51], a[8:11], v[72:75]
    ds_read_b64_tr_b16 a[32:33], v173 offset:7168
    v_mfma_f32_16x16x32_bf16 v[76:79], a[48:51], a[12:15], v[76:79]
    ds_read_b64_tr_b16 a[34:35], v173 offset:8960
    v_mfma_f32_16x16x32_bf16 v[80:83], a[52:55], a[0:3], v[80:83]
    ds_read_b64_tr_b16 a[36:37], v173 offset:7200
    v_mfma_f32_16x16x32_bf16 v[84:87], a[52:55], a[4:7], v[84:87]
    ds_read_b64_tr_b16 a[38:39], v173 offset:8992
    v_mfma_f32_16x16x32_bf16 v[88:91], a[52:55], a[8:11], v[88:91]
    ds_read_b64_tr_b16 a[48:49], v173 offset:21504
    v_mfma_f32_16x16x32_bf16 v[92:95], a[52:55], a[12:15], v[92:95]
    ds_read_b64_tr_b16 a[50:51], v173 offset:23296
    s_waitcnt lgkmcnt(4)
    v_mfma_f32_16x16x32_bf16 v[0:3], a[32:35], a[16:19], v[0:3]
    ds_read_b64_tr_b16 a[52:53], v173 offset:21536
    v_mfma_f32_16x16x32_bf16 v[4:7], a[32:35], a[20:23], v[4:7]
    ds_read_b64_tr_b16 a[54:55], v173 offset:23328
    v_mfma_f32_16x16x32_bf16 v[8:11], a[32:35], a[24:27], v[8:11]
    v_mfma_f32_16x16x32_bf16 v[12:15], a[32:35], a[28:31], v[12:15]
    s_waitcnt lgkmcnt(4)
    v_mfma_f32_16x16x32_bf16 v[16:19], a[36:39], a[16:19], v[16:19]
    v_mfma_f32_16x16x32_bf16 v[20:23], a[36:39], a[20:23], v[20:23]
    v_mfma_f32_16x16x32_bf16 v[24:27], a[36:39], a[24:27], v[24:27]
    v_mfma_f32_16x16x32_bf16 v[28:31], a[36:39], a[28:31], v[28:31]
    s_waitcnt lgkmcnt(2)
    v_mfma_f32_16x16x32_bf16 v[64:67], a[48:51], a[16:19], v[64:67]
    v_lshlrev_b32 v172, 6, v182
    v_lshl_add_u32 v172, v183, 3, v172
    v_add_u32 v172, 0x24000, v172
    ds_read_b64_tr_b16 a[32:33], v172 offset:0
    v_mfma_f32_16x16x32_bf16 v[68:71], a[48:51], a[20:23], v[68:71]
    ds_read_b64_tr_b16 a[34:35], v172 offset:1024
    v_mfma_f32_16x16x32_bf16 v[72:75], a[48:51], a[24:27], v[72:75]
    ds_read_b64_tr_b16 a[36:37], v172 offset:32
    v_mfma_f32_16x16x32_bf16 v[76:79], a[48:51], a[28:31], v[76:79]
    ds_read_b64_tr_b16 a[38:39], v172 offset:1056
    s_waitcnt lgkmcnt(4)
    v_mfma_f32_16x16x32_bf16 v[80:83], a[52:55], a[16:19], v[80:83]
    v_mfma_f32_16x16x32_bf16 v[84:87], a[52:55], a[20:23], v[84:87]
    v_mfma_f32_16x16x32_bf16 v[88:91], a[52:55], a[24:27], v[88:91]
    v_mfma_f32_16x16x32_bf16 v[92:95], a[52:55], a[28:31], v[92:95]
    v_mfma_f32_16x16x32_bf16 v[32:35], a[40:43], a[0:3], v[32:35]
    v_mul_f32 v162, v0, v0
    v_mul_f32 v166, v16, v16
    v_mul_f32 v163, v1, v1
    v_mul_f32 v167, v17, v17
    v_mfma_f32_16x16x32_bf16 v[36:39], a[40:43], a[4:7], v[36:39]
    v_mul_f32 v164, v2, v2
    v_mul_f32 v168, v18, v18
    v_mul_f32 v165, v3, v3
    v_mul_f32 v169, v19, v19
    v_mfma_f32_16x16x32_bf16 v[40:43], a[40:43], a[8:11], v[40:43]
    v_fma_f32 v162, v162, s90, v178
    v_fma_f32 v166, v166, s90, v178
    v_fma_f32 v163, v163, s90, v178
    v_fma_f32 v167, v167, s90, v178
    v_mfma_f32_16x16x32_bf16 v[44:47], a[40:43], a[12:15], v[44:47]
    v_fma_f32 v164, v164, s90, v178
    v_fma_f32 v168, v168, s90, v178
    v_fma_f32 v165, v165, s90, v178
    v_fma_f32 v169, v169, s90, v178
    v_mfma_f32_16x16x32_bf16 v[48:51], a[44:47], a[0:3], v[48:51]
    ds_read_b64_tr_b16 a[40:41], v173 offset:7232
    v_mul_f32 v162, v162, v0
    v_mul_f32 v166, v166, v16
    v_mul_f32 v163, v163, v1
    v_mul_f32 v167, v167, v17
    v_mfma_f32_16x16x32_bf16 v[52:55], a[44:47], a[4:7], v[52:55]
    ds_read_b64_tr_b16 a[42:43], v173 offset:9024
    v_mul_f32 v164, v164, v2
    v_mul_f32 v168, v168, v18
    v_mul_f32 v165, v165, v3
    v_mul_f32 v169, v169, v19
    v_mfma_f32_16x16x32_bf16 v[56:59], a[44:47], a[8:11], v[56:59]
    v_exp_f32 v162, v162
    v_exp_f32 v166, v166
    v_exp_f32 v163, v163
    v_exp_f32 v167, v167
    v_mfma_f32_16x16x32_bf16 v[60:63], a[44:47], a[12:15], v[60:63]
    v_exp_f32 v164, v164
    v_exp_f32 v168, v168
    v_exp_f32 v165, v165
    v_exp_f32 v169, v169
    v_mfma_f32_16x16x32_bf16 v[96:99], a[56:59], a[0:3], v[96:99]
    ds_read_b64_tr_b16 a[44:45], v173 offset:7264
    v_mul_f32 v64, v64, v0
    v_mul_f32 v80, v80, v16
    v_mul_f32 v65, v65, v1
    v_mul_f32 v81, v81, v17
    v_mfma_f32_16x16x32_bf16 v[100:103], a[56:59], a[4:7], v[100:103]
    ds_read_b64_tr_b16 a[46:47], v173 offset:9056
    v_mul_f32 v66, v66, v2
    v_mul_f32 v82, v82, v18
    v_mul_f32 v67, v67, v3
    v_mul_f32 v83, v83, v19
    v_mfma_f32_16x16x32_bf16 v[104:107], a[56:59], a[8:11], v[104:107]
    v_add_f32 v162, 1.0, v162
    v_add_f32 v166, 1.0, v166
    v_add_f32 v163, 1.0, v163
    v_add_f32 v167, 1.0, v167
    v_mfma_f32_16x16x32_bf16 v[108:111], a[56:59], a[12:15], v[108:111]
    v_add_f32 v164, 1.0, v164
    v_add_f32 v168, 1.0, v168
    v_add_f32 v165, 1.0, v165
    v_add_f32 v169, 1.0, v169
    v_mfma_f32_16x16x32_bf16 v[112:115], a[60:63], a[0:3], v[112:115]
    ds_read_b64_tr_b16 a[56:57], v173 offset:21568
    v_rcp_f32 v162, v162
    v_rcp_f32 v166, v166
    v_rcp_f32 v163, v163
    v_rcp_f32 v167, v167
    v_mfma_f32_16x16x32_bf16 v[116:119], a[60:63], a[4:7], v[116:119]
    ds_read_b64_tr_b16 a[58:59], v173 offset:23360
    v_rcp_f32 v164, v164
    v_rcp_f32 v168, v168
    v_rcp_f32 v165, v165
    v_rcp_f32 v169, v169
    v_mfma_f32_16x16x32_bf16 v[120:123], a[60:63], a[8:11], v[120:123]
    v_mul_f32 v64, v64, v162
    v_mul_f32 v80, v80, v166
    v_mul_f32 v65, v65, v163
    v_mul_f32 v81, v81, v167
    v_mfma_f32_16x16x32_bf16 v[124:127], a[60:63], a[12:15], v[124:127]
    v_mul_f32 v66, v66, v164
    v_mul_f32 v82, v82, v168
    v_mul_f32 v67, v67, v165
    v_mul_f32 v83, v83, v169
    v_mfma_f32_16x16x32_bf16 v[128:131], a[64:67], a[0:3], v[128:131]
    ds_read_b64_tr_b16 a[60:61], v173 offset:21600
    v_cvt_pk_bf16_f32 v0, v64, v65
    v_cvt_pk_bf16_f32 v2, v80, v81
    v_cvt_pk_bf16_f32 v1, v66, v67
    v_cvt_pk_bf16_f32 v3, v82, v83
    v_mfma_f32_16x16x32_bf16 v[132:135], a[64:67], a[4:7], v[132:135]
    ds_read_b64_tr_b16 a[62:63], v173 offset:23392
    buffer_store_dwordx4 v[0:3], v160, s[76:79], s84 offen offset:0 sc1
    v_mul_f32 v162, v4, v4
    v_mul_f32 v166, v20, v20
    v_mul_f32 v163, v5, v5
    v_mfma_f32_16x16x32_bf16 v[136:139], a[64:67], a[8:11], v[136:139]
    v_mul_f32 v167, v21, v21
    v_mul_f32 v164, v6, v6
    v_mul_f32 v168, v22, v22
    v_mul_f32 v165, v7, v7
    v_mfma_f32_16x16x32_bf16 v[140:143], a[64:67], a[12:15], v[140:143]
    v_mul_f32 v169, v23, v23
    v_fma_f32 v162, v162, s90, v178
    v_fma_f32 v166, v166, s90, v178
    v_fma_f32 v163, v163, s90, v178
    v_mfma_f32_16x16x32_bf16 v[144:147], a[68:71], a[0:3], v[144:147]
    ds_read_b64_tr_b16 a[64:65], v176 offset:2048
    v_fma_f32 v167, v167, s90, v178
    v_fma_f32 v164, v164, s90, v178
    v_fma_f32 v168, v168, s90, v178
    v_fma_f32 v165, v165, s90, v178
    v_mfma_f32_16x16x32_bf16 v[148:151], a[68:71], a[4:7], v[148:151]
    ds_read_b64_tr_b16 a[66:67], v176 offset:2560
    v_fma_f32 v169, v169, s90, v178
    v_mul_f32 v162, v162, v4
    v_mul_f32 v166, v166, v20
    v_mul_f32 v163, v163, v5
    v_mfma_f32_16x16x32_bf16 v[152:155], a[68:71], a[8:11], v[152:155]
    v_mul_f32 v167, v167, v21
    v_mul_f32 v164, v164, v6
    v_mul_f32 v168, v168, v22
    v_mul_f32 v165, v165, v7
    v_mfma_f32_16x16x32_bf16 v[156:159], a[68:71], a[12:15], v[156:159]
    v_mul_f32 v169, v169, v23
    v_exp_f32 v162, v162
    v_exp_f32 v166, v166
    v_exp_f32 v163, v163
    s_waitcnt lgkmcnt(8)
    v_mfma_f32_16x16x32_bf16 v[32:35], a[40:43], a[16:19], v[32:35]
    ds_read_b64_tr_b16 a[68:69], v177 offset:2048
    s_mov_b32 s80, s20
    s_and_b32 s81, s21, 0xffff
    s_mov_b32 s82, 0x800
    s_mov_b32 s83, 0x20000
    v_mfma_f32_16x16x32_bf16 v[36:39], a[40:43], a[20:23], v[36:39]
    ds_read_b64_tr_b16 a[70:71], v177 offset:2560
    s_lshl_b32 s89, s28, 3
    s_add_u32 s89, s89, s30
    s_lshl_b32 s86, s89, 11
    v_lshlrev_b32 v172, 1, v160
    v_mfma_f32_16x16x32_bf16 v[40:43], a[40:43], a[24:27], v[40:43]
    buffer_load_dwordx4 a[0:3], v172, s[36:39], s86 offen
    v_exp_f32 v167, v167
    v_exp_f32 v164, v164
    v_exp_f32 v168, v168
    v_mfma_f32_16x16x32_bf16 v[44:47], a[40:43], a[28:31], v[44:47]
    buffer_load_dwordx4 a[4:7], v172, s[36:39], s86 offen offset:16
    v_exp_f32 v165, v165
    v_exp_f32 v169, v169
    v_mul_f32 v68, v68, v4
    s_waitcnt lgkmcnt(8)
    v_mfma_f32_16x16x32_bf16 v[48:51], a[44:47], a[16:19], v[48:51]
    buffer_load_dwordx4 a[8:11], v172, s[80:83], 0 offen
    v_mul_f32 v84, v84, v20
    v_mul_f32 v69, v69, v5
    v_mul_f32 v85, v85, v21
    v_mfma_f32_16x16x32_bf16 v[52:55], a[44:47], a[20:23], v[52:55]
    buffer_load_dwordx4 a[12:15], v172, s[80:83], 0 offen offset:16
    v_mul_f32 v70, v70, v6
    v_mul_f32 v86, v86, v22
    v_mul_f32 v71, v71, v7
    v_mfma_f32_16x16x32_bf16 v[56:59], a[44:47], a[24:27], v[56:59]
    s_lshl_b32 s86, s29, 8
    s_add_u32 s86, s86, s89
    s_lshl_b32 s86, s86, 2
    s_add_u32 s87, s86, 0x1d00000
    v_mfma_f32_16x16x32_bf16 v[60:63], a[44:47], a[28:31], v[60:63]
    v_mul_f32 v87, v87, v23
    v_add_f32 v162, 1.0, v162
    v_add_f32 v166, 1.0, v166
    v_add_f32 v163, 1.0, v163
    s_waitcnt lgkmcnt(6)
    v_mfma_f32_16x16x32_bf16 v[96:99], a[56:59], a[16:19], v[96:99]
    v_add_f32 v167, 1.0, v167
    v_add_f32 v164, 1.0, v164
    v_add_f32 v168, 1.0, v168
    v_add_f32 v165, 1.0, v165
    v_mfma_f32_16x16x32_bf16 v[100:103], a[56:59], a[20:23], v[100:103]
    v_add_f32 v169, 1.0, v169
    v_rcp_f32 v162, v162
    v_rcp_f32 v166, v166
    v_rcp_f32 v163, v163
    v_mfma_f32_16x16x32_bf16 v[104:107], a[56:59], a[24:27], v[104:107]
    v_rcp_f32 v167, v167
    v_rcp_f32 v164, v164
    v_rcp_f32 v168, v168
    v_rcp_f32 v165, v165
    v_mfma_f32_16x16x32_bf16 v[108:111], a[56:59], a[28:31], v[108:111]
    v_rcp_f32 v169, v169
    v_mul_f32 v68, v68, v162
    v_mul_f32 v84, v84, v166
    v_mul_f32 v69, v69, v163
    s_waitcnt lgkmcnt(4)
    v_mfma_f32_16x16x32_bf16 v[112:115], a[60:63], a[16:19], v[112:115]
    v_mul_f32 v85, v85, v167
    v_mul_f32 v70, v70, v164
    v_mul_f32 v86, v86, v168
    v_mul_f32 v71, v71, v165
    v_mfma_f32_16x16x32_bf16 v[116:119], a[60:63], a[20:23], v[116:119]
    v_mul_f32 v87, v87, v169
    v_cvt_pk_bf16_f32 v4, v68, v69
    v_cvt_pk_bf16_f32 v6, v84, v85
    v_cvt_pk_bf16_f32 v5, v70, v71
    v_mfma_f32_16x16x32_bf16 v[120:123], a[60:63], a[24:27], v[120:123]
    v_cvt_pk_bf16_f32 v7, v86, v87
    buffer_store_dwordx4 v[4:7], v160, s[76:79], s84 offen offset:1024 sc1
    v_mul_f32 v162, v8, v8
    v_mul_f32 v166, v24, v24
    v_mfma_f32_16x16x32_bf16 v[124:127], a[60:63], a[28:31], v[124:127]
    v_mul_f32 v163, v9, v9
    v_mul_f32 v167, v25, v25
    v_mul_f32 v164, v10, v10
    v_mul_f32 v168, v26, v26
    s_waitcnt lgkmcnt(2)
    v_mfma_f32_16x16x32_bf16 v[128:131], a[64:67], a[16:19], v[128:131]
    v_mul_f32 v165, v11, v11
    v_mul_f32 v169, v27, v27
    v_fma_f32 v162, v162, s90, v178
    v_fma_f32 v166, v166, s90, v178
    v_mfma_f32_16x16x32_bf16 v[132:135], a[64:67], a[20:23], v[132:135]
    v_fma_f32 v163, v163, s90, v178
    v_fma_f32 v167, v167, s90, v178
    v_fma_f32 v164, v164, s90, v178
    v_fma_f32 v168, v168, s90, v178
    v_mfma_f32_16x16x32_bf16 v[136:139], a[64:67], a[24:27], v[136:139]
    v_fma_f32 v165, v165, s90, v178
    v_fma_f32 v169, v169, s90, v178
    v_mul_f32 v162, v162, v8
    v_mul_f32 v166, v166, v24
    v_mfma_f32_16x16x32_bf16 v[140:143], a[64:67], a[28:31], v[140:143]
    v_mul_f32 v163, v163, v9
    v_mul_f32 v167, v167, v25
    v_mul_f32 v164, v164, v10
    v_mul_f32 v168, v168, v26
    s_waitcnt lgkmcnt(0)
    v_mfma_f32_16x16x32_bf16 v[144:147], a[68:71], a[16:19], v[144:147]
    v_mul_f32 v165, v165, v11
    v_mul_f32 v169, v169, v27
    v_exp_f32 v162, v162
    v_exp_f32 v166, v166
    v_mfma_f32_16x16x32_bf16 v[148:151], a[68:71], a[20:23], v[148:151]
    v_exp_f32 v163, v163
    v_exp_f32 v167, v167
    v_exp_f32 v164, v164
    v_exp_f32 v168, v168
    v_mfma_f32_16x16x32_bf16 v[152:155], a[68:71], a[24:27], v[152:155]
    v_exp_f32 v165, v165
    v_exp_f32 v169, v169
    v_mul_f32 v72, v72, v8
    v_mul_f32 v88, v88, v24
    v_mfma_f32_16x16x32_bf16 v[156:159], a[68:71], a[28:31], v[156:159]
    v_mul_f32 v73, v73, v9
    v_mul_f32 v89, v89, v25
    v_mul_f32 v74, v74, v10
    v_mul_f32 v90, v90, v26
    v_mul_f32 v75, v75, v11
    v_mul_f32 v91, v91, v27
    v_add_f32 v162, 1.0, v162
    v_add_f32 v166, 1.0, v166
    v_add_f32 v163, 1.0, v163
    v_add_f32 v167, 1.0, v167
    v_add_f32 v164, 1.0, v164
    v_add_f32 v168, 1.0, v168
    v_add_f32 v165, 1.0, v165
    v_add_f32 v169, 1.0, v169
    v_rcp_f32 v162, v162
    v_rcp_f32 v166, v166
    v_rcp_f32 v163, v163
    v_rcp_f32 v167, v167
    v_rcp_f32 v164, v164
    v_rcp_f32 v168, v168
    v_rcp_f32 v165, v165
    v_rcp_f32 v169, v169
    v_mul_f32 v72, v72, v162
    v_mul_f32 v88, v88, v166
    v_mul_f32 v73, v73, v163
    v_mul_f32 v89, v89, v167
    v_mul_f32 v74, v74, v164
    v_mul_f32 v90, v90, v168
    v_mul_f32 v75, v75, v165
    v_mul_f32 v91, v91, v169
    v_cvt_pk_bf16_f32 v8, v72, v73
    v_cvt_pk_bf16_f32 v10, v88, v89
    v_cvt_pk_bf16_f32 v9, v74, v75
    v_cvt_pk_bf16_f32 v11, v90, v91
    buffer_store_dwordx4 v[8:11], v160, s[76:79], s84 offen offset:2048 sc1
    s_waitcnt lgkmcnt(0)
    s_setprio 2
    s_lshl_b32 s86, s32, 13
    s_add_u32 s86, s86, 0x20000
    v_add_u32 v170, s86, v160
    s_barrier
    v_pk_mul_f32 v[162:163], v[12:13], v[12:13]
    v_pk_mul_f32 v[166:167], v[28:29], v[28:29]
    v_pk_mul_f32 v[164:165], v[14:15], v[14:15]
    v_pk_mul_f32 v[168:169], v[30:31], v[30:31]
    v_pk_fma_f32 v[162:163], v[162:163], s[90:91], v[178:179]
    v_pk_fma_f32 v[166:167], v[166:167], s[90:91], v[178:179]
    v_pk_fma_f32 v[164:165], v[164:165], s[90:91], v[178:179]
    v_pk_fma_f32 v[168:169], v[168:169], s[90:91], v[178:179]
    v_pk_mul_f32 v[162:163], v[162:163], v[12:13]
    v_pk_mul_f32 v[166:167], v[166:167], v[28:29]
    v_pk_mul_f32 v[164:165], v[164:165], v[14:15]
    v_pk_mul_f32 v[168:169], v[168:169], v[30:31]
    v_exp_f32 v162, v162
    v_exp_f32 v166, v166
    v_exp_f32 v163, v163
    v_exp_f32 v167, v167
    v_exp_f32 v164, v164
    v_exp_f32 v168, v168
    v_exp_f32 v165, v165
    v_exp_f32 v169, v169
    v_pk_mul_f32 v[76:77], v[76:77], v[12:13]
    v_pk_mul_f32 v[92:93], v[92:93], v[28:29]
    v_pk_mul_f32 v[78:79], v[78:79], v[14:15]
    v_pk_mul_f32 v[94:95], v[94:95], v[30:31]
    v_pk_add_f32 v[162:163], v[162:163], s[92:93]
    v_pk_add_f32 v[166:167], v[166:167], s[92:93]
    v_pk_add_f32 v[164:165], v[164:165], s[92:93]
    v_pk_add_f32 v[168:169], v[168:169], s[92:93]
    v_rcp_f32 v162, v162
    v_rcp_f32 v166, v166
    v_rcp_f32 v163, v163
    v_rcp_f32 v167, v167
    v_rcp_f32 v164, v164
    v_rcp_f32 v168, v168
    v_rcp_f32 v165, v165
    v_rcp_f32 v169, v169
    v_pk_mul_f32 v[76:77], v[76:77], v[162:163]
    v_pk_mul_f32 v[92:93], v[92:93], v[166:167]
    v_pk_mul_f32 v[78:79], v[78:79], v[164:165]
    v_pk_mul_f32 v[94:95], v[94:95], v[168:169]
    v_cvt_pk_bf16_f32 v12, v76, v77
    v_cvt_pk_bf16_f32 v14, v92, v93
    v_cvt_pk_bf16_f32 v13, v78, v79
    v_cvt_pk_bf16_f32 v15, v94, v95
    buffer_store_dwordx4 v[12:15], v160, s[76:79], s84 offen offset:3072 sc1
    v_pk_mul_f32 v[162:163], v[32:33], v[32:33]
    v_pk_mul_f32 v[166:167], v[48:49], v[48:49]
    v_pk_mul_f32 v[164:165], v[34:35], v[34:35]
    v_pk_mul_f32 v[168:169], v[50:51], v[50:51]
    v_pk_fma_f32 v[162:163], v[162:163], s[90:91], v[178:179]
    v_pk_fma_f32 v[166:167], v[166:167], s[90:91], v[178:179]
    v_pk_fma_f32 v[164:165], v[164:165], s[90:91], v[178:179]
    v_pk_fma_f32 v[168:169], v[168:169], s[90:91], v[178:179]
    v_pk_mul_f32 v[162:163], v[162:163], v[32:33]
    v_pk_mul_f32 v[166:167], v[166:167], v[48:49]
    v_pk_mul_f32 v[164:165], v[164:165], v[34:35]
    v_pk_mul_f32 v[168:169], v[168:169], v[50:51]
    v_exp_f32 v162, v162
    v_exp_f32 v166, v166
    v_exp_f32 v163, v163
    v_exp_f32 v167, v167
    v_exp_f32 v164, v164
    v_exp_f32 v168, v168
    v_exp_f32 v165, v165
    v_exp_f32 v169, v169
    v_pk_mul_f32 v[96:97], v[96:97], v[32:33]
    v_pk_mul_f32 v[112:113], v[112:113], v[48:49]
    v_pk_mul_f32 v[98:99], v[98:99], v[34:35]
    v_pk_mul_f32 v[114:115], v[114:115], v[50:51]
    v_pk_add_f32 v[162:163], v[162:163], s[92:93]
    v_pk_add_f32 v[166:167], v[166:167], s[92:93]
    v_pk_add_f32 v[164:165], v[164:165], s[92:93]
    v_pk_add_f32 v[168:169], v[168:169], s[92:93]
    v_rcp_f32 v162, v162
    v_rcp_f32 v166, v166
    v_rcp_f32 v163, v163
    v_rcp_f32 v167, v167
    v_rcp_f32 v164, v164
    v_rcp_f32 v168, v168
    v_rcp_f32 v165, v165
    v_rcp_f32 v169, v169
    v_pk_mul_f32 v[96:97], v[96:97], v[162:163]
    v_pk_mul_f32 v[112:113], v[112:113], v[166:167]
    v_pk_mul_f32 v[98:99], v[98:99], v[164:165]
    v_pk_mul_f32 v[114:115], v[114:115], v[168:169]
    v_cvt_pk_bf16_f32 v32, v96, v97
    v_cvt_pk_bf16_f32 v34, v112, v113
    v_cvt_pk_bf16_f32 v33, v98, v99
    v_cvt_pk_bf16_f32 v35, v114, v115
    buffer_store_dwordx4 v[32:35], v160, s[76:79], s85 offen offset:0 sc1
    v_pk_mul_f32 v[162:163], v[36:37], v[36:37]
    v_pk_mul_f32 v[166:167], v[52:53], v[52:53]
    v_pk_mul_f32 v[164:165], v[38:39], v[38:39]
    v_pk_mul_f32 v[168:169], v[54:55], v[54:55]
    v_pk_fma_f32 v[162:163], v[162:163], s[90:91], v[178:179]
    v_pk_fma_f32 v[166:167], v[166:167], s[90:91], v[178:179]
    v_pk_fma_f32 v[164:165], v[164:165], s[90:91], v[178:179]
    v_pk_fma_f32 v[168:169], v[168:169], s[90:91], v[178:179]
    v_pk_mul_f32 v[162:163], v[162:163], v[36:37]
    v_pk_mul_f32 v[166:167], v[166:167], v[52:53]
    v_pk_mul_f32 v[164:165], v[164:165], v[38:39]
    v_pk_mul_f32 v[168:169], v[168:169], v[54:55]
    v_exp_f32 v162, v162
    v_exp_f32 v166, v166
    v_exp_f32 v163, v163
    v_exp_f32 v167, v167
    v_exp_f32 v164, v164
    v_exp_f32 v168, v168
    v_exp_f32 v165, v165
    v_exp_f32 v169, v169
    v_pk_mul_f32 v[100:101], v[100:101], v[36:37]
    v_pk_mul_f32 v[116:117], v[116:117], v[52:53]
    v_pk_mul_f32 v[102:103], v[102:103], v[38:39]
    v_pk_mul_f32 v[118:119], v[118:119], v[54:55]
    v_pk_add_f32 v[162:163], v[162:163], s[92:93]
    v_pk_add_f32 v[166:167], v[166:167], s[92:93]
    v_pk_add_f32 v[164:165], v[164:165], s[92:93]
    v_pk_add_f32 v[168:169], v[168:169], s[92:93]
    v_rcp_f32 v162, v162
    v_rcp_f32 v166, v166
    v_rcp_f32 v163, v163
    v_rcp_f32 v167, v167
    v_rcp_f32 v164, v164
    v_rcp_f32 v168, v168
    v_rcp_f32 v165, v165
    v_rcp_f32 v169, v169
    v_pk_mul_f32 v[100:101], v[100:101], v[162:163]
    v_pk_mul_f32 v[116:117], v[116:117], v[166:167]
    v_pk_mul_f32 v[102:103], v[102:103], v[164:165]
    v_pk_mul_f32 v[118:119], v[118:119], v[168:169]
    v_cvt_pk_bf16_f32 v36, v100, v101
    v_cvt_pk_bf16_f32 v38, v116, v117
    v_cvt_pk_bf16_f32 v37, v102, v103
    v_cvt_pk_bf16_f32 v39, v118, v119
    buffer_store_dwordx4 v[36:39], v160, s[76:79], s85 offen offset:1024 sc1
    s_waitcnt vmcnt(2)
    v_cmp_le_u32 vcc, 1, v161
    s_nop 1
    s_cmp_eq_u64 vcc, -1
    s_cbranch_scc1 K1_IN0_OK
    s_mov_b32 s99, 0x10000
K1_IN0_SPIN:
    s_sleep 2
    v_lshrrev_b32 v166, 2, v160
    buffer_load_dword v161, v166, s[52:55], 0 offen sc1
    s_waitcnt vmcnt(0)
    v_cmp_le_u32 vcc, 1, v161
    s_nop 1
    s_cmp_eq_u64 vcc, -1
    s_cbranch_scc1 K1_IN0_OK
    s_sub_u32 s99, s99, 1
    s_cmp_lg_u32 s99, 0
    s_cbranch_scc1 K1_IN0_SPIN
K1_IN0_OK:
    v_mov_b32 v166, 0x10084
    v_mov_b32 v167, 1
    s_mov_b64 exec, 1
    ds_add_rtn_u32 v168, v166, v167
    v_mov_b32 v166, 0
    s_waitcnt lgkmcnt(0)
    v_readfirstlane_b32 s86, v168
    s_nop 1
    s_cmp_lg_u32 s86, 7
    s_cbranch_scc1 K1_HS01
    buffer_atomic_add v167, v166, s[76:79], s68 offen sc1
K1_HS01:
    s_mov_b64 exec, -1
    v_accvgpr_read_b32 v162, a0
    v_accvgpr_read_b32 v166, a8
    v_accvgpr_read_b32 v163, a1
    v_accvgpr_read_b32 v167, a9
    v_accvgpr_read_b32 v164, a2
    v_accvgpr_read_b32 v168, a10
    v_accvgpr_read_b32 v165, a3
    v_accvgpr_read_b32 v169, a11
    v_dot2_f32_bf16 v172, v162, v166, 0
    v_dot2_f32_bf16 v172, v163, v167, v172
    v_dot2_f32_bf16 v172, v164, v168, v172
    v_dot2_f32_bf16 v172, v165, v169, v172
    s_nop 3
    v_accvgpr_read_b32 v162, a4
    v_accvgpr_read_b32 v166, a12
    v_accvgpr_read_b32 v163, a5
    v_accvgpr_read_b32 v167, a13
    v_accvgpr_read_b32 v164, a6
    v_accvgpr_read_b32 v168, a14
    v_accvgpr_read_b32 v165, a7
    v_accvgpr_read_b32 v169, a15
    v_dot2_f32_bf16 v173, v162, v166, 0
    v_dot2_f32_bf16 v173, v163, v167, v173
    v_dot2_f32_bf16 v173, v164, v168, v173
    v_dot2_f32_bf16 v173, v165, v169, v173
    s_nop 3
    v_add_f32 v172, v172, v173
    s_nop 1
    v_add_f32_dpp v172, v172, v172 quad_perm:[1,0,3,2] row_mask:0xf bank_mask:0xf
    s_nop 1
    v_add_f32_dpp v172, v172, v172 quad_perm:[2,3,0,1] row_mask:0xf bank_mask:0xf
    s_nop 1
    v_add_f32_dpp v172, v172, v172 row_half_mirror row_mask:0xf bank_mask:0xf
    s_nop 1
    v_add_f32_dpp v172, v172, v172 row_mirror row_mask:0xf bank_mask:0xf
    v_mov_b32 v173, v172
    s_nop 1
    v_permlane16_swap_b32 v172, v173
    v_add_f32 v172, v172, v173
    v_mov_b32 v173, v172
    s_nop 1
    v_permlane32_swap_b32 v172, v173
    v_add_f32 v172, v172, v173
    v_mul_f32 v172, 0xbfb8aa3b, v172
    v_exp_f32 v172, v172
    s_nop 0
    v_add_f32 v172, 1.0, v172
    v_rcp_f32 v172, v172
    v_lshlrev_b32 v173, 23, v160
    s_nop 0
    buffer_store_dword v172, v173, s[76:79], s87 offen sc1
    v_pk_mul_f32 v[162:163], v[40:41], v[40:41]
    v_pk_mul_f32 v[166:167], v[56:57], v[56:57]
    v_pk_mul_f32 v[164:165], v[42:43], v[42:43]
    v_pk_mul_f32 v[168:169], v[58:59], v[58:59]
    v_pk_fma_f32 v[162:163], v[162:163], s[90:91], v[178:179]
    v_pk_fma_f32 v[166:167], v[166:167], s[90:91], v[178:179]
    v_pk_fma_f32 v[164:165], v[164:165], s[90:91], v[178:179]
    v_pk_fma_f32 v[168:169], v[168:169], s[90:91], v[178:179]
    v_pk_mul_f32 v[162:163], v[162:163], v[40:41]
    v_pk_mul_f32 v[166:167], v[166:167], v[56:57]
    v_pk_mul_f32 v[164:165], v[164:165], v[42:43]
    v_pk_mul_f32 v[168:169], v[168:169], v[58:59]
    v_exp_f32 v162, v162
    v_exp_f32 v166, v166
    v_exp_f32 v163, v163
    v_exp_f32 v167, v167
    v_exp_f32 v164, v164
    v_exp_f32 v168, v168
    v_exp_f32 v165, v165
    v_exp_f32 v169, v169
    v_pk_mul_f32 v[104:105], v[104:105], v[40:41]
    v_pk_mul_f32 v[120:121], v[120:121], v[56:57]
    v_pk_mul_f32 v[106:107], v[106:107], v[42:43]
    v_pk_mul_f32 v[122:123], v[122:123], v[58:59]
    v_pk_add_f32 v[162:163], v[162:163], s[92:93]
    v_pk_add_f32 v[166:167], v[166:167], s[92:93]
    v_pk_add_f32 v[164:165], v[164:165], s[92:93]
    v_pk_add_f32 v[168:169], v[168:169], s[92:93]
    v_rcp_f32 v162, v162
    v_rcp_f32 v166, v166
    v_rcp_f32 v163, v163
    v_rcp_f32 v167, v167
    v_rcp_f32 v164, v164
    v_rcp_f32 v168, v168
    v_rcp_f32 v165, v165
    v_rcp_f32 v169, v169
    v_pk_mul_f32 v[104:105], v[104:105], v[162:163]
    v_pk_mul_f32 v[120:121], v[120:121], v[166:167]
    v_pk_mul_f32 v[106:107], v[106:107], v[164:165]
    v_pk_mul_f32 v[122:123], v[122:123], v[168:169]
    v_cvt_pk_bf16_f32 v40, v104, v105
    v_cvt_pk_bf16_f32 v42, v120, v121
    v_cvt_pk_bf16_f32 v41, v106, v107
    v_cvt_pk_bf16_f32 v43, v122, v123
    buffer_store_dwordx4 v[40:43], v160, s[76:79], s85 offen offset:2048 sc1
    v_pk_mul_f32 v[162:163], v[44:45], v[44:45]
    v_pk_mul_f32 v[166:167], v[60:61], v[60:61]
    v_pk_mul_f32 v[164:165], v[46:47], v[46:47]
    v_pk_mul_f32 v[168:169], v[62:63], v[62:63]
    v_pk_fma_f32 v[162:163], v[162:163], s[90:91], v[178:179]
    v_pk_fma_f32 v[166:167], v[166:167], s[90:91], v[178:179]
    v_pk_fma_f32 v[164:165], v[164:165], s[90:91], v[178:179]
    v_pk_fma_f32 v[168:169], v[168:169], s[90:91], v[178:179]
    v_pk_mul_f32 v[162:163], v[162:163], v[44:45]
    v_pk_mul_f32 v[166:167], v[166:167], v[60:61]
    v_pk_mul_f32 v[164:165], v[164:165], v[46:47]
    v_pk_mul_f32 v[168:169], v[168:169], v[62:63]
    v_exp_f32 v162, v162
    v_exp_f32 v166, v166
    v_exp_f32 v163, v163
    v_exp_f32 v167, v167
    v_exp_f32 v164, v164
    v_exp_f32 v168, v168
    v_exp_f32 v165, v165
    v_exp_f32 v169, v169
    v_pk_mul_f32 v[108:109], v[108:109], v[44:45]
    v_pk_mul_f32 v[124:125], v[124:125], v[60:61]
    v_pk_mul_f32 v[110:111], v[110:111], v[46:47]
    v_pk_mul_f32 v[126:127], v[126:127], v[62:63]
    v_pk_add_f32 v[162:163], v[162:163], s[92:93]
    v_pk_add_f32 v[166:167], v[166:167], s[92:93]
    v_pk_add_f32 v[164:165], v[164:165], s[92:93]
    v_pk_add_f32 v[168:169], v[168:169], s[92:93]
    v_rcp_f32 v162, v162
    v_rcp_f32 v166, v166
    v_rcp_f32 v163, v163
    v_rcp_f32 v167, v167
    v_rcp_f32 v164, v164
    v_rcp_f32 v168, v168
    v_rcp_f32 v165, v165
    v_rcp_f32 v169, v169
    v_pk_mul_f32 v[108:109], v[108:109], v[162:163]
    v_pk_mul_f32 v[124:125], v[124:125], v[166:167]
    v_pk_mul_f32 v[110:111], v[110:111], v[164:165]
    v_pk_mul_f32 v[126:127], v[126:127], v[168:169]
    v_cvt_pk_bf16_f32 v44, v108, v109
    v_cvt_pk_bf16_f32 v46, v124, v125
    v_cvt_pk_bf16_f32 v45, v110, v111
    v_cvt_pk_bf16_f32 v47, v126, v127
    buffer_store_dwordx4 v[44:47], v160, s[76:79], s85 offen offset:3072 sc1
    s_setprio 0
    v_cvt_pk_bf16_f32 v128, v128, v129
    v_cvt_pk_bf16_f32 v132, v132, v133
    v_cvt_pk_bf16_f32 v136, v136, v137
    v_cvt_pk_bf16_f32 v140, v140, v141
    v_cvt_pk_bf16_f32 v129, v130, v131
    v_cvt_pk_bf16_f32 v133, v134, v135
    v_cvt_pk_bf16_f32 v137, v138, v139
    v_cvt_pk_bf16_f32 v141, v142, v143
    v_cvt_pk_bf16_f32 v130, v144, v145
    v_cvt_pk_bf16_f32 v134, v148, v149
    v_cvt_pk_bf16_f32 v138, v152, v153
    v_cvt_pk_bf16_f32 v142, v156, v157
    v_cvt_pk_bf16_f32 v131, v146, v147
    v_cvt_pk_bf16_f32 v135, v150, v151
    v_cvt_pk_bf16_f32 v139, v154, v155
    v_cvt_pk_bf16_f32 v143, v158, v159
    v_mfma_f32_16x16x32_bf16 v[64:67], a[32:35], v[128:131], 0
    v_mfma_f32_16x16x32_bf16 v[68:71], a[32:35], v[132:135], 0
    v_mfma_f32_16x16x32_bf16 v[72:75], a[32:35], v[136:139], 0
    v_mfma_f32_16x16x32_bf16 v[76:79], a[32:35], v[140:143], 0
    v_mfma_f32_16x16x32_bf16 v[80:83], a[36:39], v[128:131], 0
    v_mfma_f32_16x16x32_bf16 v[84:87], a[36:39], v[132:135], 0
    v_mfma_f32_16x16x32_bf16 v[88:91], a[36:39], v[136:139], 0
    v_mfma_f32_16x16x32_bf16 v[92:95], a[36:39], v[140:143], 0
    s_nop 0
    v_max3_f32 v16, v64, v65, v66
    v_max3_f32 v20, v68, v69, v70
    v_max3_f32 v17, -v64, -v65, -v66
    v_max3_f32 v21, -v68, -v69, -v70
    v_max3_f32 v18, v67, v80, v81
    v_max3_f32 v22, v71, v84, v85
    v_max3_f32 v19, -v67, -v80, -v81
    v_max3_f32 v23, -v71, -v84, -v85
    v_max3_f32 v16, v82, v83, v16
    v_max3_f32 v20, v86, v87, v20
    v_max3_f32 v17, -v82, -v83, v17
    v_max3_f32 v21, -v86, -v87, v21
    v_max_f32 v16, v16, v18
    v_max_f32 v20, v20, v22
    v_max_f32 v17, v17, v19
    v_max_f32 v21, v21, v23
    s_nop 0
    v_permlane16_swap_b32 v16, v17
    v_permlane16_swap_b32 v20, v21
    v_max_f32 v16, v16, v17
    v_max_f32 v20, v20, v21
    v_mov_b32 v18, v16
    v_mov_b32 v22, v20
    s_nop 0
    v_permlane32_swap_b32 v16, v18
    v_permlane32_swap_b32 v20, v22
    v_max_f32 v16, v16, v18
    v_max_f32 v20, v20, v22
    v_mov_b32 v17, v16
    v_mov_b32 v21, v20
    s_nop 0
    v_permlane16_swap_b32 v16, v17
    v_permlane16_swap_b32 v20, v21
    v_mul_f32 v18, s96, v17
    v_mul_f32 v22, s96, v21
    v_mul_f32 v19, s96, v17
    v_mul_f32 v23, s96, v21
    v_mul_f32 v17, s96, v16
    v_mul_f32 v21, s96, v20
    v_mul_f32 v16, s96, v16
    v_mul_f32 v20, s96, v20
    v_pk_fma_f32 v[128:129], v[64:65], s[96:97], v[18:19]
    v_pk_fma_f32 v[132:133], v[68:69], s[96:97], v[22:23]
    v_pk_fma_f32 v[130:131], v[66:67], s[96:97], v[18:19]
    v_pk_fma_f32 v[134:135], v[70:71], s[96:97], v[22:23]
    v_pk_fma_f32 v[144:145], v[80:81], s[96:97], v[18:19]
    v_pk_fma_f32 v[148:149], v[84:85], s[96:97], v[22:23]
    v_pk_fma_f32 v[146:147], v[82:83], s[96:97], v[18:19]
    v_pk_fma_f32 v[150:151], v[86:87], s[96:97], v[22:23]
    v_pk_fma_f32 v[64:65], v[64:65], s[94:95], v[16:17]
    v_pk_fma_f32 v[68:69], v[68:69], s[94:95], v[20:21]
    v_pk_fma_f32 v[66:67], v[66:67], s[94:95], v[16:17]
    v_pk_fma_f32 v[70:71], v[70:71], s[94:95], v[20:21]
    v_pk_fma_f32 v[80:81], v[80:81], s[94:95], v[16:17]
    v_pk_fma_f32 v[84:85], v[84:85], s[94:95], v[20:21]
    v_pk_fma_f32 v[82:83], v[82:83], s[94:95], v[16:17]
    v_pk_fma_f32 v[86:87], v[86:87], s[94:95], v[20:21]
    v_exp_f32 v128, v128
    v_exp_f32 v132, v132
    v_exp_f32 v129, v129
    v_exp_f32 v133, v133
    v_exp_f32 v130, v130
    v_exp_f32 v134, v134
    v_exp_f32 v131, v131
    v_exp_f32 v135, v135
    v_exp_f32 v144, v144
    v_exp_f32 v148, v148
    v_exp_f32 v145, v145
    v_exp_f32 v149, v149
    v_exp_f32 v146, v146
    v_exp_f32 v150, v150
    v_exp_f32 v147, v147
    v_exp_f32 v151, v151
    v_exp_f32 v64, v64
    v_exp_f32 v68, v68
    v_exp_f32 v65, v65
    v_exp_f32 v69, v69
    v_exp_f32 v66, v66
    v_exp_f32 v70, v70
    v_exp_f32 v67, v67
    v_exp_f32 v71, v71
    v_exp_f32 v80, v80
    v_exp_f32 v84, v84
    v_exp_f32 v81, v81
    v_exp_f32 v85, v85
    v_exp_f32 v82, v82
    v_exp_f32 v86, v86
    v_exp_f32 v83, v83
    v_exp_f32 v87, v87
    v_pk_add_f32 v[18:19], v[128:129], v[130:131]
    v_pk_add_f32 v[22:23], v[132:133], v[134:135]
    v_pk_add_f32 v[16:17], v[64:65], v[66:67]
    v_pk_add_f32 v[20:21], v[68:69], v[70:71]
    v_pk_add_f32 v[18:19], v[18:19], v[144:145]
    v_pk_add_f32 v[22:23], v[22:23], v[148:149]
    v_pk_add_f32 v[16:17], v[16:17], v[80:81]
    v_pk_add_f32 v[20:21], v[20:21], v[84:85]
    v_pk_add_f32 v[18:19], v[18:19], v[146:147]
    v_pk_add_f32 v[22:23], v[22:23], v[150:151]
    v_pk_add_f32 v[16:17], v[16:17], v[82:83]
    v_pk_add_f32 v[20:21], v[20:21], v[86:87]
    v_add_f32 v16, v16, v17
    v_add_f32 v20, v20, v21
    v_add_f32 v17, v18, v19
    v_add_f32 v21, v22, v23
    s_nop 0
    v_permlane16_swap_b32 v16, v17
    v_permlane16_swap_b32 v20, v21
    v_add_f32 v16, v16, v17
    v_add_f32 v20, v20, v21
    v_mov_b32 v18, v16
    v_mov_b32 v22, v20
    s_nop 0
    v_permlane32_swap_b32 v16, v18
    v_permlane32_swap_b32 v20, v22
    v_add_f32 v16, v16, v18
    v_add_f32 v20, v20, v22
    v_mov_b32 v17, v16
    v_mov_b32 v21, v20
    s_nop 0
    v_permlane16_swap_b32 v16, v17
    v_permlane16_swap_b32 v20, v21
    v_rcp_f32 v16, v16
    v_rcp_f32 v20, v20
    v_rcp_f32 v18, v17
    v_rcp_f32 v22, v21
    v_mov_b32 v17, v16
    v_mov_b32 v21, v20
    v_mov_b32 v19, v18
    v_mov_b32 v23, v22
    v_pk_mul_f32 v[64:65], v[64:65], v[16:17]
    v_pk_mul_f32 v[68:69], v[68:69], v[20:21]
    v_pk_mul_f32 v[66:67], v[66:67], v[16:17]
    v_pk_mul_f32 v[70:71], v[70:71], v[20:21]
    v_pk_mul_f32 v[80:81], v[80:81], v[16:17]
    v_pk_mul_f32 v[84:85], v[84:85], v[20:21]
    v_pk_mul_f32 v[82:83], v[82:83], v[16:17]
    v_pk_mul_f32 v[86:87], v[86:87], v[20:21]
    v_pk_mul_f32 v[128:129], v[128:129], v[18:19]
    v_pk_mul_f32 v[132:133], v[132:133], v[22:23]
    v_pk_mul_f32 v[130:131], v[130:131], v[18:19]
    v_pk_mul_f32 v[134:135], v[134:135], v[22:23]
    v_pk_mul_f32 v[144:145], v[144:145], v[18:19]
    v_pk_mul_f32 v[148:149], v[148:149], v[22:23]
    v_pk_mul_f32 v[146:147], v[146:147], v[18:19]
    v_pk_mul_f32 v[150:151], v[150:151], v[22:23]
    v_cvt_pk_bf16_f32 v64, v64, v65
    v_cvt_pk_bf16_f32 v68, v68, v69
    v_cvt_pk_bf16_f32 v65, v66, v67
    v_cvt_pk_bf16_f32 v69, v70, v71
    v_cvt_pk_bf16_f32 v66, v80, v81
    v_cvt_pk_bf16_f32 v70, v84, v85
    v_cvt_pk_bf16_f32 v67, v82, v83
    v_cvt_pk_bf16_f32 v71, v86, v87
    v_cvt_pk_bf16_f32 v128, v128, v129
    v_cvt_pk_bf16_f32 v132, v132, v133
    v_cvt_pk_bf16_f32 v129, v130, v131
    v_cvt_pk_bf16_f32 v133, v134, v135
    v_cvt_pk_bf16_f32 v130, v144, v145
    v_cvt_pk_bf16_f32 v134, v148, v149
    v_cvt_pk_bf16_f32 v131, v146, v147
    v_cvt_pk_bf16_f32 v135, v150, v151
    ds_write_b128 v170, v[64:67] offset:0
    ds_write_b128 v170, v[68:71] offset:2048
    ds_write_b128 v170, v[128:131] offset:1024
    ds_write_b128 v170, v[132:135] offset:3072
    v_mov_b32 v173, 0
    buffer_load_dword v161, v173, s[76:79], s67 offen sc1
    v_max3_f32 v24, v72, v73, v74
    v_max3_f32 v28, v76, v77, v78
    v_max3_f32 v25, -v72, -v73, -v74
    v_max3_f32 v29, -v76, -v77, -v78
    v_max3_f32 v26, v75, v88, v89
    v_max3_f32 v30, v79, v92, v93
    v_max3_f32 v27, -v75, -v88, -v89
    v_max3_f32 v31, -v79, -v92, -v93
    v_max3_f32 v24, v90, v91, v24
    v_max3_f32 v28, v94, v95, v28
    v_max3_f32 v25, -v90, -v91, v25
    v_max3_f32 v29, -v94, -v95, v29
    v_max_f32 v24, v24, v26
    v_max_f32 v28, v28, v30
    v_max_f32 v25, v25, v27
    v_max_f32 v29, v29, v31
    s_nop 0
    v_permlane16_swap_b32 v24, v25
    v_permlane16_swap_b32 v28, v29
    v_max_f32 v24, v24, v25
    v_max_f32 v28, v28, v29
    v_mov_b32 v26, v24
    v_mov_b32 v30, v28
    s_nop 0
    v_permlane32_swap_b32 v24, v26
    v_permlane32_swap_b32 v28, v30
    v_max_f32 v24, v24, v26
    v_max_f32 v28, v28, v30
    v_mov_b32 v25, v24
    v_mov_b32 v29, v28
    s_nop 0
    v_permlane16_swap_b32 v24, v25
    v_permlane16_swap_b32 v28, v29
    v_mul_f32 v26, s96, v25
    v_mul_f32 v30, s96, v29
    v_mul_f32 v27, s96, v25
    v_mul_f32 v31, s96, v29
    v_mul_f32 v25, s96, v24
    v_mul_f32 v29, s96, v28
    v_mul_f32 v24, s96, v24
    v_mul_f32 v28, s96, v28
    v_pk_fma_f32 v[136:137], v[72:73], s[96:97], v[26:27]
    v_pk_fma_f32 v[140:141], v[76:77], s[96:97], v[30:31]
    v_pk_fma_f32 v[138:139], v[74:75], s[96:97], v[26:27]
    v_pk_fma_f32 v[142:143], v[78:79], s[96:97], v[30:31]
    v_pk_fma_f32 v[152:153], v[88:89], s[96:97], v[26:27]
    v_pk_fma_f32 v[156:157], v[92:93], s[96:97], v[30:31]
    v_pk_fma_f32 v[154:155], v[90:91], s[96:97], v[26:27]
    v_pk_fma_f32 v[158:159], v[94:95], s[96:97], v[30:31]
    v_pk_fma_f32 v[72:73], v[72:73], s[94:95], v[24:25]
    v_pk_fma_f32 v[76:77], v[76:77], s[94:95], v[28:29]
    v_pk_fma_f32 v[74:75], v[74:75], s[94:95], v[24:25]
    v_pk_fma_f32 v[78:79], v[78:79], s[94:95], v[28:29]
    v_pk_fma_f32 v[88:89], v[88:89], s[94:95], v[24:25]
    v_pk_fma_f32 v[92:93], v[92:93], s[94:95], v[28:29]
    v_pk_fma_f32 v[90:91], v[90:91], s[94:95], v[24:25]
    v_pk_fma_f32 v[94:95], v[94:95], s[94:95], v[28:29]
    v_exp_f32 v136, v136
    v_exp_f32 v140, v140
    v_exp_f32 v137, v137
    v_exp_f32 v141, v141
    v_exp_f32 v138, v138
    v_exp_f32 v142, v142
    v_exp_f32 v139, v139
    v_exp_f32 v143, v143
    v_exp_f32 v152, v152
    v_exp_f32 v156, v156
    v_exp_f32 v153, v153
    v_exp_f32 v157, v157
    v_exp_f32 v154, v154
    v_exp_f32 v158, v158
    v_exp_f32 v155, v155
    v_exp_f32 v159, v159
    v_exp_f32 v72, v72
    v_exp_f32 v76, v76
    v_exp_f32 v73, v73
    v_exp_f32 v77, v77
    v_exp_f32 v74, v74
    v_exp_f32 v78, v78
    v_exp_f32 v75, v75
    v_exp_f32 v79, v79
    v_exp_f32 v88, v88
    v_exp_f32 v92, v92
    v_exp_f32 v89, v89
    v_exp_f32 v93, v93
    v_exp_f32 v90, v90
    v_exp_f32 v94, v94
    v_exp_f32 v91, v91
    v_exp_f32 v95, v95
    v_pk_add_f32 v[26:27], v[136:137], v[138:139]
    v_pk_add_f32 v[30:31], v[140:141], v[142:143]
    v_pk_add_f32 v[24:25], v[72:73], v[74:75]
    v_pk_add_f32 v[28:29], v[76:77], v[78:79]
    v_pk_add_f32 v[26:27], v[26:27], v[152:153]
    v_pk_add_f32 v[30:31], v[30:31], v[156:157]
    v_pk_add_f32 v[24:25], v[24:25], v[88:89]
    v_pk_add_f32 v[28:29], v[28:29], v[92:93]
    v_pk_add_f32 v[26:27], v[26:27], v[154:155]
    v_pk_add_f32 v[30:31], v[30:31], v[158:159]
    v_pk_add_f32 v[24:25], v[24:25], v[90:91]
    v_pk_add_f32 v[28:29], v[28:29], v[94:95]
    v_add_f32 v24, v24, v25
    v_add_f32 v28, v28, v29
    v_add_f32 v25, v26, v27
    v_add_f32 v29, v30, v31
    s_nop 0
    v_permlane16_swap_b32 v24, v25
    v_permlane16_swap_b32 v28, v29
    v_add_f32 v24, v24, v25
    v_add_f32 v28, v28, v29
    v_mov_b32 v26, v24
    v_mov_b32 v30, v28
    s_nop 0
    v_permlane32_swap_b32 v24, v26
    v_permlane32_swap_b32 v28, v30
    v_add_f32 v24, v24, v26
    v_add_f32 v28, v28, v30
    v_mov_b32 v25, v24
    v_mov_b32 v29, v28
    s_nop 0
    v_permlane16_swap_b32 v24, v25
    v_permlane16_swap_b32 v28, v29
    v_rcp_f32 v24, v24
    v_rcp_f32 v28, v28
    v_rcp_f32 v26, v25
    v_rcp_f32 v30, v29
    v_mov_b32 v25, v24
    v_mov_b32 v29, v28
    v_mov_b32 v27, v26
    v_mov_b32 v31, v30
    v_pk_mul_f32 v[72:73], v[72:73], v[24:25]
    v_pk_mul_f32 v[76:77], v[76:77], v[28:29]
    v_pk_mul_f32 v[74:75], v[74:75], v[24:25]
    v_pk_mul_f32 v[78:79], v[78:79], v[28:29]
    v_pk_mul_f32 v[88:89], v[88:89], v[24:25]
    v_pk_mul_f32 v[92:93], v[92:93], v[28:29]
    v_pk_mul_f32 v[90:91], v[90:91], v[24:25]
    v_pk_mul_f32 v[94:95], v[94:95], v[28:29]
    v_pk_mul_f32 v[136:137], v[136:137], v[26:27]
    v_pk_mul_f32 v[140:141], v[140:141], v[30:31]
    v_pk_mul_f32 v[138:139], v[138:139], v[26:27]
    v_pk_mul_f32 v[142:143], v[142:143], v[30:31]
    v_pk_mul_f32 v[152:153], v[152:153], v[26:27]
    v_pk_mul_f32 v[156:157], v[156:157], v[30:31]
    v_pk_mul_f32 v[154:155], v[154:155], v[26:27]
    v_pk_mul_f32 v[158:159], v[158:159], v[30:31]
    v_cvt_pk_bf16_f32 v72, v72, v73
    v_cvt_pk_bf16_f32 v76, v76, v77
    v_cvt_pk_bf16_f32 v73, v74, v75
    v_cvt_pk_bf16_f32 v77, v78, v79
    v_cvt_pk_bf16_f32 v74, v88, v89
    v_cvt_pk_bf16_f32 v78, v92, v93
    v_cvt_pk_bf16_f32 v75, v90, v91
    v_cvt_pk_bf16_f32 v79, v94, v95
    v_cvt_pk_bf16_f32 v136, v136, v137
    v_cvt_pk_bf16_f32 v140, v140, v141
    v_cvt_pk_bf16_f32 v137, v138, v139
    v_cvt_pk_bf16_f32 v141, v142, v143
    v_cvt_pk_bf16_f32 v138, v152, v153
    v_cvt_pk_bf16_f32 v142, v156, v157
    v_cvt_pk_bf16_f32 v139, v154, v155
    v_cvt_pk_bf16_f32 v143, v158, v159
    ds_write_b128 v170, v[72:75] offset:4096
    ds_write_b128 v170, v[76:79] offset:6144
    ds_write_b128 v170, v[136:139] offset:5120
    ds_write_b128 v170, v[140:143] offset:7168
    v_mul_u32_u24 v104, 160, v182
    v_lshl_add_u32 v104, v183, 3, v104
    s_lshl_b32 s86, s32, 5
    s_add_u32 s86, s86, 0x10000
    v_add_u32 v104, s86, v104
    v_lshlrev_b32 v105, 4, v181
    v_mov_b32 v96, 0x3f803f80
    v_mov_b32 v97, 0x3f803f80
    v_mov_b32 v98, 0x3f803f80
    v_mov_b32 v99, 0x3f803f80
    v_mov_b32 v173, 0
    s_waitcnt vmcnt(0)
    v_readfirstlane_b32 s98, v161
    s_nop 1
    s_cmp_ge_u32 s98, 8
    s_cselect_b32 s89, 1, 0
    s_waitcnt lgkmcnt(0)
    s_barrier
    v_mov_b32 v174, 1
    s_cmp_lg_u32 s30, 0
    s_cbranch_scc1 K1_SF_NS
    s_mov_b64 exec, 1
    buffer_atomic_add v174, v173, s[76:79], s66 offen sc1
    s_mov_b64 exec, -1
K1_SF_NS:
    ds_read_b64_tr_b16 v[64:65], v104 offset:0
    ds_read_b64_tr_b16 v[66:67], v104 offset:2560
    ds_read_b64_tr_b16 v[68:69], v104 offset:5120
    ds_read_b64_tr_b16 v[70:71], v104 offset:7680
    ds_read_b64_tr_b16 v[72:73], v104 offset:10240
    ds_read_b64_tr_b16 v[74:75], v104 offset:12800
    ds_read_b64_tr_b16 v[76:77], v104 offset:15360
    ds_read_b64_tr_b16 v[78:79], v104 offset:17920
    ds_read_b64_tr_b16 v[80:81], v104 offset:20480
    ds_read_b64_tr_b16 v[82:83], v104 offset:23040
    ds_read_b64_tr_b16 v[84:85], v104 offset:25600
    ds_read_b64_tr_b16 v[86:87], v104 offset:28160
    ds_read_b64_tr_b16 v[88:89], v104 offset:30720
    ds_read_b64_tr_b16 v[90:91], v104 offset:33280
    ds_read_b64_tr_b16 v[92:93], v104 offset:35840
    ds_read_b64_tr_b16 v[94:95], v104 offset:38400
    s_cmp_eq_u32 s89, 1
    s_cbranch_scc0 K1_NA0
    s_add_u32 s24, s59, 0x0
    buffer_load_dwordx4 a[0:3], v160, s[76:79], s24 offen offset:0 sc1
    buffer_load_dwordx4 a[4:7], v160, s[76:79], s24 offen offset:1024 sc1
    s_add_u32 s24, s59, 0x20000
    buffer_load_dwordx4 a[8:11], v160, s[76:79], s24 offen offset:0 sc1
    buffer_load_dwordx4 a[12:15], v160, s[76:79], s24 offen offset:1024 sc1
    s_add_u32 s24, s59, 0xa0000
    buffer_load_dwordx4 a[16:19], v160, s[76:79], s24 offen offset:0 sc1
    buffer_load_dwordx4 a[20:23], v160, s[76:79], s24 offen offset:1024 sc1
    s_add_u32 s24, s59, 0xc0000
    buffer_load_dwordx4 a[24:27], v160, s[76:79], s24 offen offset:0 sc1
    buffer_load_dwordx4 a[28:31], v160, s[76:79], s24 offen offset:1024 sc1
    s_branch K1_NB0
K1_NA0:
    buffer_load_dword v175, v173, s[76:79], s67 offen sc1
K1_NB0:
    v_lshrrev_b32 v110, 4, v160
    v_lshrrev_b32 v112, 4, v110
    v_bfe_u32 v113, v110, 1, 3
    v_xor_b32 v113, v113, v112
    v_lshlrev_b32 v113, 5, v113
    v_and_b32 v114, 1, v110
    v_lshl_add_u32 v113, v114, 4, v113
    v_lshl_add_u32 v113, v112, 11, v113
    s_lshl_b32 s86, s57, 8
    v_add_u32 v161, s86, v113
    v_xor_b32 v162, 128, v161
    v_add_u32 v162, 0x2000, v162
    v_lshrrev_b32 v111, 4, v110
    v_bfe_u32 v112, v110, 2, 2
    v_lshl_add_u32 v112, v111, 2, v112
    v_and_b32 v113, 7, v112
    v_lshlrev_b32 v112, 8, v112
    v_lshl_add_u32 v112, v113, 5, v112
    v_and_b32 v113, 3, v110
    v_lshl_add_u32 v163, v113, 3, v112
    s_lshl_b32 s86, s56, 6
    v_xor_b32 v163, s86, v163
    v_xor_b32 v164, 32, v163
    v_xor_b32 v165, 64, v163
    v_xor_b32 v166, 96, v163
    v_xor_b32 v167, 128, v163
    v_xor_b32 v168, 160, v163
    v_xor_b32 v169, 192, v163
    v_xor_b32 v170, 224, v163
    v_mov_b32 v173, 0
    v_mov_b32 v174, 1
    s_lshl_b32 s86, s30, 12
    s_add_u32 s86, s86, 0x20000
    v_add_u32 v177, s86, v160
    v_add_u32 v178, 0x1a000, v160
    v_lshrrev_b32 v112, 5, v110
    v_and_b32 v113, 0x1f0, v160
    v_lshl_add_u32 v180, v112, 3, v113
    v_and_b32 v113, 0xf0, v160
    v_lshl_add_u32 v181, v111, 12, v113
    s_lshl_b32 s86, s30, 9
    s_add_u32 s86, s86, 0x1a000
    v_add_u32 v180, s86, v180
    v_and_b32 v112, 7, v110
    v_lshlrev_b32 v112, 7, v112
    v_lshl_add_u32 v182, v111, 4, v112
    v_and_b32 v112, 15, v110
    v_lshlrev_b32 v183, 2, v112
    s_waitcnt lgkmcnt(14)
    v_mfma_f32_16x16x32_bf16 v[100:103], v[64:67], v[96:99], 0
    s_waitcnt lgkmcnt(12)
    v_mfma_f32_16x16x32_bf16 v[100:103], v[68:71], v[96:99], v[100:103]
    s_waitcnt lgkmcnt(10)
    v_mfma_f32_16x16x32_bf16 v[100:103], v[72:75], v[96:99], v[100:103]
    s_waitcnt lgkmcnt(8)
    v_mfma_f32_16x16x32_bf16 v[100:103], v[76:79], v[96:99], v[100:103]
    s_waitcnt lgkmcnt(6)
    v_mfma_f32_16x16x32_bf16 v[100:103], v[80:83], v[96:99], v[100:103]
    s_waitcnt lgkmcnt(4)
    v_mfma_f32_16x16x32_bf16 v[100:103], v[84:87], v[96:99], v[100:103]
    s_waitcnt lgkmcnt(2)
    v_mfma_f32_16x16x32_bf16 v[100:103], v[88:91], v[96:99], v[100:103]
    s_waitcnt lgkmcnt(0)
    v_mfma_f32_16x16x32_bf16 v[100:103], v[92:95], v[96:99], v[100:103]
    s_nop 7
    v_cvt_pk_bf16_f32 v100, v100, v101
    v_cvt_pk_bf16_f32 v101, v102, v103
    s_cmp_eq_u32 s89, 1
    s_cbranch_scc1 K1_HA0
    s_waitcnt vmcnt(0)
    v_readfirstlane_b32 s98, v175
    s_nop 1
    s_cmp_ge_u32 s98, 8
    s_cbranch_scc1 K1_WH0_OK
    s_mov_b32 s99, 0x10000
K1_WH0_SPIN:
    s_sleep 2
    buffer_load_dword v175, v173, s[76:79], s67 offen sc1
    s_waitcnt vmcnt(0)
    v_readfirstlane_b32 s98, v175
    s_nop 1
    s_cmp_ge_u32 s98, 8
    s_cbranch_scc1 K1_WH0_OK
    s_sub_u32 s99, s99, 1
    s_cmp_lg_u32 s99, 0
    s_cbranch_scc1 K1_WH0_SPIN
K1_WH0_OK:
    s_add_u32 s24, s59, 0x0
    buffer_load_dwordx4 a[0:3], v160, s[76:79], s24 offen offset:0 sc1
    buffer_load_dwordx4 a[4:7], v160, s[76:79], s24 offen offset:1024 sc1
    s_add_u32 s24, s59, 0x20000
    buffer_load_dwordx4 a[8:11], v160, s[76:79], s24 offen offset:0 sc1
    buffer_load_dwordx4 a[12:15], v160, s[76:79], s24 offen offset:1024 sc1
    s_add_u32 s24, s59, 0xa0000
    buffer_load_dwordx4 a[16:19], v160, s[76:79], s24 offen offset:0 sc1
    buffer_load_dwordx4 a[20:23], v160, s[76:79], s24 offen offset:1024 sc1
    s_add_u32 s24, s59, 0xc0000
    buffer_load_dwordx4 a[24:27], v160, s[76:79], s24 offen offset:0 sc1
    buffer_load_dwordx4 a[28:31], v160, s[76:79], s24 offen offset:1024 sc1
K1_HA0:
    s_mov_b32 s86, 0x10001
    s_mov_b32 s87, 0x10001
    s_mov_b64 exec, s[86:87]
    buffer_store_dwordx2 v[100:101], v105, s[76:79], s88 offen sc1
    s_mov_b64 exec, -1
    s_branch K3_START
K1_H1:
    ds_read_b128 a[0:3], v168 offset:0
    ds_read_b128 a[16:19], v169 offset:0
    ds_read_b64_tr_b16 a[32:33], v172 offset:0
    ds_read_b64_tr_b16 a[34:35], v172 offset:1792
    ds_read_b64_tr_b16 a[36:37], v172 offset:7168
    ds_read_b64_tr_b16 a[38:39], v172 offset:8960
    ds_read_b64_tr_b16 a[40:41], v172 offset:32
    ds_read_b64_tr_b16 a[42:43], v172 offset:1824
    ds_read_b64_tr_b16 a[44:45], v172 offset:7200
    ds_read_b64_tr_b16 a[46:47], v172 offset:8992
    ds_read_b128 a[4:7], v168 offset:2048
    ds_read_b128 a[20:23], v169 offset:2048
    ds_read_b128 a[8:11], v168 offset:4096
    ds_read_b128 a[24:27], v169 offset:4096
    ds_read_b128 a[12:15], v168 offset:6144
    ds_read_b64_tr_b16 a[48:49], v172 offset:64
    ds_read_b64_tr_b16 a[50:51], v172 offset:1856
    ds_read_b64_tr_b16 a[52:53], v172 offset:7232
    ds_read_b64_tr_b16 a[54:55], v172 offset:9024
    ds_read_b64_tr_b16 a[64:65], v172 offset:14368
    s_waitcnt lgkmcnt(0)
    s_mov_b32 s74, 7
    s_waitcnt lgkmcnt(7)
    v_mfma_f32_16x16x32_bf16 v[0:3], a[32:35], a[0:3], 0
    ds_read_b128 a[28:31], v169 offset:6144
    s_add_u32 m0, s52, 0x12000
    v_mfma_f32_16x16x32_bf16 v[0:3], a[36:39], a[16:19], v[0:3]
    buffer_load_dwordx4 v163, s[40:43], s60 offen lds
    v_mfma_f32_16x16x32_bf16 v[16:19], a[44:47], a[16:19], 0
    ds_read_b64_tr_b16 a[66:67], v172 offset:16160
    v_mfma_f32_16x16x32_bf16 v[16:19], a[40:43], a[0:3], v[16:19]
    ds_read_b64_tr_b16 a[68:69], v172 offset:21536
    s_waitcnt lgkmcnt(7)
    v_mfma_f32_16x16x32_bf16 v[20:23], a[40:43], a[4:7], 0
    ds_read_b64_tr_b16 a[70:71], v172 offset:23328
    s_add_u32 m0, s53, 0x12000
    v_mfma_f32_16x16x32_bf16 v[20:23], a[44:47], a[20:23], v[20:23]
    buffer_load_dwordx4 v163, s[40:43], s61 offen lds
    v_mfma_f32_16x16x32_bf16 v[4:7], a[36:39], a[20:23], 0
    ds_read_b64_tr_b16 a[56:57], v172 offset:14336
    v_mfma_f32_16x16x32_bf16 v[4:7], a[32:35], a[4:7], v[4:7]
    ds_read_b64_tr_b16 a[58:59], v172 offset:16128
    s_waitcnt lgkmcnt(8)
    v_mfma_f32_16x16x32_bf16 v[8:11], a[32:35], a[8:11], 0
    ds_read_b64_tr_b16 a[60:61], v172 offset:21504
    s_add_u32 m0, s54, 0x12000
    v_mfma_f32_16x16x32_bf16 v[8:11], a[36:39], a[24:27], v[8:11]
    buffer_load_dwordx4 v163, s[44:47], s62 offen lds
    v_mfma_f32_16x16x32_bf16 v[24:27], a[44:47], a[24:27], 0
    ds_read_b64_tr_b16 a[62:63], v172 offset:23296
    v_mfma_f32_16x16x32_bf16 v[24:27], a[40:43], a[8:11], v[24:27]
    s_waitcnt lgkmcnt(7)
    v_mfma_f32_16x16x32_bf16 v[28:31], a[40:43], a[12:15], 0
    s_add_u32 m0, s55, 0x12000
    v_mfma_f32_16x16x32_bf16 v[28:31], a[44:47], a[28:31], v[28:31]
    buffer_load_dwordx4 v163, s[44:47], s63 offen lds
    v_mfma_f32_16x16x32_bf16 v[12:15], a[36:39], a[28:31], 0
    ds_read_b64_tr_b16 a[40:41], v174 offset:4096
    v_mfma_f32_16x16x32_bf16 v[12:15], a[32:35], a[12:15], v[12:15]
    ds_read_b64_tr_b16 a[42:43], v174 offset:4608
    v_mfma_f32_16x16x32_bf16 v[44:47], a[48:51], a[12:15], 0
    ds_read_b64_tr_b16 a[44:45], v174 offset:6144
    s_add_u32 m0, s56, 0x12000
    v_mfma_f32_16x16x32_bf16 v[44:47], a[52:55], a[28:31], v[44:47]
    buffer_load_dwordx4 v164, s[48:51], s64 offen lds
    v_mfma_f32_16x16x32_bf16 v[40:43], a[52:55], a[24:27], 0
    ds_read_b64_tr_b16 a[46:47], v174 offset:6656
    v_mfma_f32_16x16x32_bf16 v[40:43], a[48:51], a[8:11], v[40:43]
    ds_read_b64_tr_b16 a[32:33], v172 offset:14400
    v_mfma_f32_16x16x32_bf16 v[36:39], a[48:51], a[4:7], 0
    ds_read_b64_tr_b16 a[34:35], v172 offset:16192
    v_mfma_f32_16x16x32_bf16 v[36:39], a[52:55], a[20:23], v[36:39]
    ds_read_b64_tr_b16 a[36:37], v172 offset:21568
    v_mfma_f32_16x16x32_bf16 v[32:35], a[52:55], a[16:19], 0
    ds_read_b64_tr_b16 a[38:39], v172 offset:23360
    v_mfma_f32_16x16x32_bf16 v[32:35], a[48:51], a[0:3], v[32:35]
    ds_read_b64_tr_b16 a[48:49], v175 offset:4096
    s_waitcnt lgkmcnt(9)
    v_mfma_f32_16x16x32_bf16 v[48:51], a[56:59], a[0:3], 0
    ds_read_b64_tr_b16 a[50:51], v175 offset:4608
    v_mfma_f32_16x16x32_bf16 v[48:51], a[60:63], a[16:19], v[48:51]
    ds_read_b64_tr_b16 a[52:53], v175 offset:6144
    v_mfma_f32_16x16x32_bf16 v[52:55], a[60:63], a[20:23], 0
    ds_read_b64_tr_b16 a[54:55], v175 offset:6656
    v_mfma_f32_16x16x32_bf16 v[52:55], a[56:59], a[4:7], v[52:55]
    v_mfma_f32_16x16x32_bf16 v[56:59], a[56:59], a[8:11], 0
    v_mfma_f32_16x16x32_bf16 v[56:59], a[60:63], a[24:27], v[56:59]
    v_mfma_f32_16x16x32_bf16 v[60:63], a[60:63], a[28:31], 0
    v_mfma_f32_16x16x32_bf16 v[60:63], a[56:59], a[12:15], v[60:63]
    ds_read_b64_tr_b16 a[56:57], v174 offset:8192
    v_mfma_f32_16x16x32_bf16 v[76:79], a[64:67], a[12:15], 0
    ds_read_b64_tr_b16 a[58:59], v174 offset:8704
    v_mfma_f32_16x16x32_bf16 v[76:79], a[68:71], a[28:31], v[76:79]
    ds_read_b64_tr_b16 a[60:61], v174 offset:10240
    v_mfma_f32_16x16x32_bf16 v[72:75], a[68:71], a[24:27], 0
    ds_read_b64_tr_b16 a[62:63], v174 offset:10752
    v_mfma_f32_16x16x32_bf16 v[72:75], a[64:67], a[8:11], v[72:75]
    v_mfma_f32_16x16x32_bf16 v[68:71], a[64:67], a[4:7], 0
    v_mfma_f32_16x16x32_bf16 v[68:71], a[68:71], a[20:23], v[68:71]
    v_mfma_f32_16x16x32_bf16 v[64:67], a[68:71], a[16:19], 0
    v_mfma_f32_16x16x32_bf16 v[64:67], a[64:67], a[0:3], v[64:67]
    ds_read_b64_tr_b16 a[64:65], v175 offset:8192
    s_add_u32 s70, s70, 128
    s_add_u32 s71, s71, 128
    s_add_u32 s60, s60, s65
    s_add_u32 s61, s61, s65
    s_add_u32 s62, s62, s65
    s_add_u32 s63, s63, s65
    s_add_u32 s64, s64, 0x60000
    buffer_store_dword v166, v165, s[84:87], 0 offen sc1
    s_branch K1_MID1
.p2align 6
K1_LOOP1:
    s_waitcnt lgkmcnt(7)
    v_mfma_f32_16x16x32_bf16 v[0:3], a[32:35], a[0:3], v[0:3]
    ds_read_b128 a[28:31], v169 offset:6144
    v_mfma_f32_16x16x32_bf16 v[0:3], a[36:39], a[16:19], v[0:3]
    ds_read_b64_tr_b16 a[66:67], v172 offset:16160
    v_mfma_f32_16x16x32_bf16 v[16:19], a[44:47], a[16:19], v[16:19]
    ds_read_b64_tr_b16 a[68:69], v172 offset:21536
    v_mfma_f32_16x16x32_bf16 v[16:19], a[40:43], a[0:3], v[16:19]
    ds_read_b64_tr_b16 a[70:71], v172 offset:23328
    s_waitcnt lgkmcnt(8)
    v_mfma_f32_16x16x32_bf16 v[20:23], a[40:43], a[4:7], v[20:23]
    ds_read_b64_tr_b16 a[56:57], v172 offset:14336
    v_mfma_f32_16x16x32_bf16 v[20:23], a[44:47], a[20:23], v[20:23]
    ds_read_b64_tr_b16 a[58:59], v172 offset:16128
    v_mfma_f32_16x16x32_bf16 v[4:7], a[36:39], a[20:23], v[4:7]
    ds_read_b64_tr_b16 a[60:61], v172 offset:21504
    v_mfma_f32_16x16x32_bf16 v[4:7], a[32:35], a[4:7], v[4:7]
    ds_read_b64_tr_b16 a[62:63], v172 offset:23296
    s_waitcnt lgkmcnt(10)
    v_mfma_f32_16x16x32_bf16 v[8:11], a[32:35], a[8:11], v[8:11]
    v_mfma_f32_16x16x32_bf16 v[8:11], a[36:39], a[24:27], v[8:11]
    v_mfma_f32_16x16x32_bf16 v[24:27], a[44:47], a[24:27], v[24:27]
    v_mfma_f32_16x16x32_bf16 v[24:27], a[40:43], a[8:11], v[24:27]
    s_waitcnt lgkmcnt(7)
    v_mfma_f32_16x16x32_bf16 v[28:31], a[40:43], a[12:15], v[28:31]
    v_mfma_f32_16x16x32_bf16 v[28:31], a[44:47], a[28:31], v[28:31]
    ds_read_b64_tr_b16 a[40:41], v174 offset:4096
    v_mfma_f32_16x16x32_bf16 v[12:15], a[36:39], a[28:31], v[12:15]
    ds_read_b64_tr_b16 a[42:43], v174 offset:4608
    v_mfma_f32_16x16x32_bf16 v[12:15], a[32:35], a[12:15], v[12:15]
    ds_read_b64_tr_b16 a[44:45], v174 offset:6144
    v_mfma_f32_16x16x32_bf16 v[44:47], a[48:51], a[12:15], v[44:47]
    ds_read_b64_tr_b16 a[46:47], v174 offset:6656
    v_mfma_f32_16x16x32_bf16 v[44:47], a[52:55], a[28:31], v[44:47]
    ds_read_b64_tr_b16 a[32:33], v172 offset:14400
    v_mfma_f32_16x16x32_bf16 v[40:43], a[52:55], a[24:27], v[40:43]
    ds_read_b64_tr_b16 a[34:35], v172 offset:16192
    v_mfma_f32_16x16x32_bf16 v[40:43], a[48:51], a[8:11], v[40:43]
    ds_read_b64_tr_b16 a[36:37], v172 offset:21568
    v_mfma_f32_16x16x32_bf16 v[36:39], a[48:51], a[4:7], v[36:39]
    ds_read_b64_tr_b16 a[38:39], v172 offset:23360
    v_mfma_f32_16x16x32_bf16 v[36:39], a[52:55], a[20:23], v[36:39]
    v_mfma_f32_16x16x32_bf16 v[32:35], a[52:55], a[16:19], v[32:35]
    v_mfma_f32_16x16x32_bf16 v[32:35], a[48:51], a[0:3], v[32:35]
    ds_read_b64_tr_b16 a[48:49], v175 offset:4096
    s_waitcnt lgkmcnt(9)
    v_mfma_f32_16x16x32_bf16 v[48:51], a[56:59], a[0:3], v[48:51]
    ds_read_b64_tr_b16 a[50:51], v175 offset:4608
    v_mfma_f32_16x16x32_bf16 v[48:51], a[60:63], a[16:19], v[48:51]
    ds_read_b64_tr_b16 a[52:53], v175 offset:6144
    v_mfma_f32_16x16x32_bf16 v[52:55], a[60:63], a[20:23], v[52:55]
    ds_read_b64_tr_b16 a[54:55], v175 offset:6656
    v_mfma_f32_16x16x32_bf16 v[52:55], a[56:59], a[4:7], v[52:55]
    v_mfma_f32_16x16x32_bf16 v[56:59], a[56:59], a[8:11], v[56:59]
    v_mfma_f32_16x16x32_bf16 v[56:59], a[60:63], a[24:27], v[56:59]
    v_mfma_f32_16x16x32_bf16 v[60:63], a[60:63], a[28:31], v[60:63]
    v_mfma_f32_16x16x32_bf16 v[60:63], a[56:59], a[12:15], v[60:63]
    ds_read_b64_tr_b16 a[56:57], v174 offset:8192
    v_mfma_f32_16x16x32_bf16 v[76:79], a[64:67], a[12:15], v[76:79]
    ds_read_b64_tr_b16 a[58:59], v174 offset:8704
    v_mfma_f32_16x16x32_bf16 v[76:79], a[68:71], a[28:31], v[76:79]
    ds_read_b64_tr_b16 a[60:61], v174 offset:10240
    v_mfma_f32_16x16x32_bf16 v[72:75], a[68:71], a[24:27], v[72:75]
    ds_read_b64_tr_b16 a[62:63], v174 offset:10752
    v_mfma_f32_16x16x32_bf16 v[72:75], a[64:67], a[8:11], v[72:75]
    v_mfma_f32_16x16x32_bf16 v[68:71], a[64:67], a[4:7], v[68:71]
    v_mfma_f32_16x16x32_bf16 v[68:71], a[68:71], a[20:23], v[68:71]
    v_mfma_f32_16x16x32_bf16 v[64:67], a[68:71], a[16:19], v[64:67]
    v_mfma_f32_16x16x32_bf16 v[64:67], a[64:67], a[0:3], v[64:67]
    ds_read_b64_tr_b16 a[64:65], v175 offset:8192
K1_MID1:
    s_waitcnt lgkmcnt(9)
    v_mfma_f32_16x16x32_bf16 v[80:83], a[32:35], a[0:3], v[80:83]
    ds_read_b64_tr_b16 a[66:67], v175 offset:8704
    v_mfma_f32_16x16x32_bf16 v[80:83], a[36:39], a[16:19], v[80:83]
    ds_read_b64_tr_b16 a[68:69], v175 offset:10240
    v_mfma_f32_16x16x32_bf16 v[84:87], a[36:39], a[20:23], v[84:87]
    ds_read_b64_tr_b16 a[70:71], v175 offset:10752
    v_mfma_f32_16x16x32_bf16 v[84:87], a[32:35], a[4:7], v[84:87]
    v_mfma_f32_16x16x32_bf16 v[88:91], a[32:35], a[8:11], v[88:91]
    v_mfma_f32_16x16x32_bf16 v[88:91], a[36:39], a[24:27], v[88:91]
    v_mfma_f32_16x16x32_bf16 v[92:95], a[36:39], a[28:31], v[92:95]
    v_mfma_f32_16x16x32_bf16 v[92:95], a[32:35], a[12:15], v[92:95]
    s_waitcnt vmcnt(1) lgkmcnt(0)
    s_barrier
    s_setprio 2
    ds_read_b64_tr_b16 a[32:33], v173 offset:0
    v_mfma_f32_16x16x32_bf16 v[108:111], a[40:43], a[12:15], v[108:111]
    ds_read_b64_tr_b16 a[34:35], v173 offset:1792
    s_add_u32 m0, s72, 0x0
    v_mfma_f32_16x16x32_bf16 v[108:111], a[44:47], a[28:31], v[108:111]
    buffer_load_dwordx4 v161, s[36:39], s70 offen lds
    v_mfma_f32_16x16x32_bf16 v[104:107], a[44:47], a[24:27], v[104:107]
    ds_read_b64_tr_b16 a[36:37], v173 offset:7168
    s_add_u32 m0, s72, 0x400
    v_mfma_f32_16x16x32_bf16 v[104:107], a[40:43], a[8:11], v[104:107]
    buffer_load_dwordx4 v162, s[36:39], s70 offen lds
    v_mfma_f32_16x16x32_bf16 v[100:103], a[40:43], a[4:7], v[100:103]
    ds_read_b64_tr_b16 a[38:39], v173 offset:8960
    s_add_u32 m0, s72, 0x800
    v_mfma_f32_16x16x32_bf16 v[100:103], a[44:47], a[20:23], v[100:103]
    buffer_load_dwordx4 v161, s[36:39], s71 offen lds
    v_mfma_f32_16x16x32_bf16 v[96:99], a[44:47], a[16:19], v[96:99]
    v_mfma_f32_16x16x32_bf16 v[96:99], a[40:43], a[0:3], v[96:99]
    ds_read_b64_tr_b16 a[40:41], v173 offset:32
    v_mfma_f32_16x16x32_bf16 v[112:115], a[48:51], a[0:3], v[112:115]
    ds_read_b64_tr_b16 a[42:43], v173 offset:1824
    s_add_u32 m0, s72, 0xc00
    v_mfma_f32_16x16x32_bf16 v[112:115], a[52:55], a[16:19], v[112:115]
    buffer_load_dwordx4 v162, s[36:39], s71 offen lds
    v_mfma_f32_16x16x32_bf16 v[116:119], a[52:55], a[20:23], v[116:119]
    ds_read_b64_tr_b16 a[44:45], v173 offset:7200
    v_mfma_f32_16x16x32_bf16 v[116:119], a[48:51], a[4:7], v[116:119]
    ds_read_b64_tr_b16 a[46:47], v173 offset:8992
    v_mfma_f32_16x16x32_bf16 v[120:123], a[48:51], a[8:11], v[120:123]
    s_add_u32 m0, s52, 0x0
    v_mfma_f32_16x16x32_bf16 v[120:123], a[52:55], a[24:27], v[120:123]
    buffer_load_dwordx4 v163, s[40:43], s60 offen lds
    v_mfma_f32_16x16x32_bf16 v[124:127], a[52:55], a[28:31], v[124:127]
    v_mfma_f32_16x16x32_bf16 v[124:127], a[48:51], a[12:15], v[124:127]
    ds_read_b64_tr_b16 a[48:49], v173 offset:64
    v_mfma_f32_16x16x32_bf16 v[140:143], a[56:59], a[12:15], v[140:143]
    ds_read_b64_tr_b16 a[50:51], v173 offset:1856
    s_add_u32 m0, s53, 0x0
    v_mfma_f32_16x16x32_bf16 v[140:143], a[60:63], a[28:31], v[140:143]
    buffer_load_dwordx4 v163, s[40:43], s61 offen lds
    v_mfma_f32_16x16x32_bf16 v[156:159], a[68:71], a[28:31], v[156:159]
    ds_read_b64_tr_b16 a[52:53], v173 offset:7232
    v_mfma_f32_16x16x32_bf16 v[156:159], a[64:67], a[12:15], v[156:159]
    ds_read_b128 a[12:15], v170 offset:6144
    v_mfma_f32_16x16x32_bf16 v[152:155], a[64:67], a[8:11], v[152:155]
    ds_read_b128 a[28:31], v171 offset:6144
    s_add_u32 m0, s54, 0x0
    v_mfma_f32_16x16x32_bf16 v[152:155], a[68:71], a[24:27], v[152:155]
    buffer_load_dwordx4 v163, s[44:47], s62 offen lds
    v_mfma_f32_16x16x32_bf16 v[136:139], a[60:63], a[24:27], v[136:139]
    ds_read_b64_tr_b16 a[54:55], v173 offset:9024
    v_mfma_f32_16x16x32_bf16 v[136:139], a[56:59], a[8:11], v[136:139]
    ds_read_b128 a[8:11], v170 offset:4096
    v_mfma_f32_16x16x32_bf16 v[132:135], a[56:59], a[4:7], v[132:135]
    ds_read_b128 a[24:27], v171 offset:4096
    s_add_u32 m0, s55, 0x0
    v_mfma_f32_16x16x32_bf16 v[132:135], a[60:63], a[20:23], v[132:135]
    buffer_load_dwordx4 v163, s[44:47], s63 offen lds
    v_mfma_f32_16x16x32_bf16 v[148:151], a[68:71], a[20:23], v[148:151]
    v_mfma_f32_16x16x32_bf16 v[148:151], a[64:67], a[4:7], v[148:151]
    ds_read_b128 a[4:7], v170 offset:2048
    v_mfma_f32_16x16x32_bf16 v[144:147], a[64:67], a[0:3], v[144:147]
    ds_read_b128 a[20:23], v171 offset:2048
    s_add_u32 m0, s56, 0x0
    v_mfma_f32_16x16x32_bf16 v[144:147], a[68:71], a[16:19], v[144:147]
    buffer_load_dwordx4 v164, s[48:51], s64 offen lds
    v_mfma_f32_16x16x32_bf16 v[128:131], a[60:63], a[16:19], v[128:131]
    ds_read_b64_tr_b16 a[64:65], v173 offset:14368
    v_mfma_f32_16x16x32_bf16 v[128:131], a[56:59], a[0:3], v[128:131]
    ds_read_b128 a[0:3], v170 offset:0
    s_setprio 0
    buffer_load_dword v179, v178, s[96:99], s94 offen
    s_add_u32 s91, s91, 1
    s_and_b32 s91, s91, s92
    s_mul_i32 s94, s91, s95
    s_add_u32 s70, s70, 128
    s_add_u32 s71, s71, 128
    s_add_u32 s60, s60, s65
    s_add_u32 s61, s61, s65
    s_add_u32 s62, s62, s65
    s_add_u32 s63, s63, s65
    s_add_u32 s64, s64, 0x60000
    s_waitcnt lgkmcnt(7)
    v_mfma_f32_16x16x32_bf16 v[12:15], a[32:35], a[12:15], v[12:15]
    ds_read_b128 a[16:19], v171 offset:0
    v_mfma_f32_16x16x32_bf16 v[12:15], a[36:39], a[28:31], v[12:15]
    ds_read_b64_tr_b16 a[66:67], v173 offset:16160
    v_mfma_f32_16x16x32_bf16 v[28:31], a[44:47], a[28:31], v[28:31]
    ds_read_b64_tr_b16 a[68:69], v173 offset:21536
    v_mfma_f32_16x16x32_bf16 v[28:31], a[40:43], a[12:15], v[28:31]
    ds_read_b64_tr_b16 a[70:71], v173 offset:23328
    s_waitcnt lgkmcnt(8)
    v_mfma_f32_16x16x32_bf16 v[24:27], a[40:43], a[8:11], v[24:27]
    ds_read_b64_tr_b16 a[56:57], v173 offset:14336
    v_mfma_f32_16x16x32_bf16 v[24:27], a[44:47], a[24:27], v[24:27]
    ds_read_b64_tr_b16 a[58:59], v173 offset:16128
    v_mfma_f32_16x16x32_bf16 v[8:11], a[36:39], a[24:27], v[8:11]
    ds_read_b64_tr_b16 a[60:61], v173 offset:21504
    v_mfma_f32_16x16x32_bf16 v[8:11], a[32:35], a[8:11], v[8:11]
    ds_read_b64_tr_b16 a[62:63], v173 offset:23296
    s_waitcnt lgkmcnt(10)
    v_mfma_f32_16x16x32_bf16 v[4:7], a[32:35], a[4:7], v[4:7]
    v_mfma_f32_16x16x32_bf16 v[4:7], a[36:39], a[20:23], v[4:7]
    v_mfma_f32_16x16x32_bf16 v[20:23], a[44:47], a[20:23], v[20:23]
    v_mfma_f32_16x16x32_bf16 v[20:23], a[40:43], a[4:7], v[20:23]
    s_waitcnt lgkmcnt(7)
    v_mfma_f32_16x16x32_bf16 v[16:19], a[40:43], a[0:3], v[16:19]
    v_mfma_f32_16x16x32_bf16 v[16:19], a[44:47], a[16:19], v[16:19]
    ds_read_b64_tr_b16 a[40:41], v176 offset:4096
    v_mfma_f32_16x16x32_bf16 v[0:3], a[36:39], a[16:19], v[0:3]
    ds_read_b64_tr_b16 a[42:43], v176 offset:4608
    v_mfma_f32_16x16x32_bf16 v[0:3], a[32:35], a[0:3], v[0:3]
    ds_read_b64_tr_b16 a[44:45], v176 offset:6144
    v_mfma_f32_16x16x32_bf16 v[32:35], a[48:51], a[0:3], v[32:35]
    ds_read_b64_tr_b16 a[46:47], v176 offset:6656
    v_mfma_f32_16x16x32_bf16 v[32:35], a[52:55], a[16:19], v[32:35]
    ds_read_b64_tr_b16 a[32:33], v173 offset:14400
    v_mfma_f32_16x16x32_bf16 v[36:39], a[52:55], a[20:23], v[36:39]
    ds_read_b64_tr_b16 a[34:35], v173 offset:16192
    v_mfma_f32_16x16x32_bf16 v[36:39], a[48:51], a[4:7], v[36:39]
    ds_read_b64_tr_b16 a[36:37], v173 offset:21568
    v_mfma_f32_16x16x32_bf16 v[40:43], a[48:51], a[8:11], v[40:43]
    ds_read_b64_tr_b16 a[38:39], v173 offset:23360
    v_mfma_f32_16x16x32_bf16 v[40:43], a[52:55], a[24:27], v[40:43]
    v_mfma_f32_16x16x32_bf16 v[44:47], a[52:55], a[28:31], v[44:47]
    v_mfma_f32_16x16x32_bf16 v[44:47], a[48:51], a[12:15], v[44:47]
    ds_read_b64_tr_b16 a[48:49], v177 offset:4096
    s_waitcnt lgkmcnt(9)
    v_mfma_f32_16x16x32_bf16 v[60:63], a[56:59], a[12:15], v[60:63]
    ds_read_b64_tr_b16 a[50:51], v177 offset:4608
    v_mfma_f32_16x16x32_bf16 v[60:63], a[60:63], a[28:31], v[60:63]
    ds_read_b64_tr_b16 a[52:53], v177 offset:6144
    v_mfma_f32_16x16x32_bf16 v[56:59], a[60:63], a[24:27], v[56:59]
    ds_read_b64_tr_b16 a[54:55], v177 offset:6656
    v_mfma_f32_16x16x32_bf16 v[56:59], a[56:59], a[8:11], v[56:59]
    v_mfma_f32_16x16x32_bf16 v[52:55], a[56:59], a[4:7], v[52:55]
    v_mfma_f32_16x16x32_bf16 v[52:55], a[60:63], a[20:23], v[52:55]
    v_mfma_f32_16x16x32_bf16 v[48:51], a[60:63], a[16:19], v[48:51]
    v_mfma_f32_16x16x32_bf16 v[48:51], a[56:59], a[0:3], v[48:51]
    ds_read_b64_tr_b16 a[56:57], v176 offset:8192
    buffer_store_dwordx4 v[180:183], v160, s[76:79], s35 offen sc1
    s_add_u32 s35, s35, 0x400
    v_mfma_f32_16x16x32_bf16 v[64:67], a[64:67], a[0:3], v[64:67]
    ds_read_b64_tr_b16 a[58:59], v176 offset:8704
    v_mfma_f32_16x16x32_bf16 v[64:67], a[68:71], a[16:19], v[64:67]
    ds_read_b64_tr_b16 a[60:61], v176 offset:10240
    v_mfma_f32_16x16x32_bf16 v[68:71], a[68:71], a[20:23], v[68:71]
    ds_read_b64_tr_b16 a[62:63], v176 offset:10752
    v_mfma_f32_16x16x32_bf16 v[68:71], a[64:67], a[4:7], v[68:71]
    v_mfma_f32_16x16x32_bf16 v[72:75], a[64:67], a[8:11], v[72:75]
    v_mfma_f32_16x16x32_bf16 v[72:75], a[68:71], a[24:27], v[72:75]
    v_mfma_f32_16x16x32_bf16 v[76:79], a[68:71], a[28:31], v[76:79]
    v_mfma_f32_16x16x32_bf16 v[76:79], a[64:67], a[12:15], v[76:79]
    ds_read_b64_tr_b16 a[64:65], v177 offset:8192
    s_waitcnt lgkmcnt(9)
    v_mfma_f32_16x16x32_bf16 v[92:95], a[32:35], a[12:15], v[92:95]
    ds_read_b64_tr_b16 a[66:67], v177 offset:8704
    v_mfma_f32_16x16x32_bf16 v[92:95], a[36:39], a[28:31], v[92:95]
    ds_read_b64_tr_b16 a[68:69], v177 offset:10240
    v_mfma_f32_16x16x32_bf16 v[88:91], a[36:39], a[24:27], v[88:91]
    ds_read_b64_tr_b16 a[70:71], v177 offset:10752
    v_mfma_f32_16x16x32_bf16 v[88:91], a[32:35], a[8:11], v[88:91]
    v_mfma_f32_16x16x32_bf16 v[84:87], a[32:35], a[4:7], v[84:87]
    v_mfma_f32_16x16x32_bf16 v[84:87], a[36:39], a[20:23], v[84:87]
    v_mfma_f32_16x16x32_bf16 v[80:83], a[36:39], a[16:19], v[80:83]
    v_mfma_f32_16x16x32_bf16 v[80:83], a[32:35], a[0:3], v[80:83]
    s_waitcnt vmcnt(2) lgkmcnt(0)
    s_barrier
    s_setprio 2
    ds_read_b64_tr_b16 a[32:33], v172 offset:0
    v_mfma_f32_16x16x32_bf16 v[96:99], a[40:43], a[0:3], v[96:99]
    ds_read_b64_tr_b16 a[34:35], v172 offset:1792
    s_add_u32 m0, s72, 0x12000
    v_mfma_f32_16x16x32_bf16 v[96:99], a[44:47], a[16:19], v[96:99]
    buffer_load_dwordx4 v161, s[36:39], s70 offen lds
    v_mfma_f32_16x16x32_bf16 v[100:103], a[44:47], a[20:23], v[100:103]
    ds_read_b64_tr_b16 a[36:37], v172 offset:7168
    s_add_u32 m0, s72, 0x12400
    v_mfma_f32_16x16x32_bf16 v[100:103], a[40:43], a[4:7], v[100:103]
    buffer_load_dwordx4 v162, s[36:39], s70 offen lds
    v_mfma_f32_16x16x32_bf16 v[104:107], a[40:43], a[8:11], v[104:107]
    ds_read_b64_tr_b16 a[38:39], v172 offset:8960
    s_add_u32 m0, s72, 0x12800
    v_mfma_f32_16x16x32_bf16 v[104:107], a[44:47], a[24:27], v[104:107]
    buffer_load_dwordx4 v161, s[36:39], s71 offen lds
    v_mfma_f32_16x16x32_bf16 v[108:111], a[44:47], a[28:31], v[108:111]
    v_mfma_f32_16x16x32_bf16 v[108:111], a[40:43], a[12:15], v[108:111]
    ds_read_b64_tr_b16 a[40:41], v172 offset:32
    v_mfma_f32_16x16x32_bf16 v[124:127], a[48:51], a[12:15], v[124:127]
    ds_read_b64_tr_b16 a[42:43], v172 offset:1824
    s_add_u32 m0, s72, 0x12c00
    v_mfma_f32_16x16x32_bf16 v[124:127], a[52:55], a[28:31], v[124:127]
    buffer_load_dwordx4 v162, s[36:39], s71 offen lds
    v_mfma_f32_16x16x32_bf16 v[120:123], a[52:55], a[24:27], v[120:123]
    ds_read_b64_tr_b16 a[44:45], v172 offset:7200
    v_mfma_f32_16x16x32_bf16 v[120:123], a[48:51], a[8:11], v[120:123]
    ds_read_b64_tr_b16 a[46:47], v172 offset:8992
    v_mfma_f32_16x16x32_bf16 v[116:119], a[48:51], a[4:7], v[116:119]
    s_add_u32 m0, s52, 0x12000
    v_mfma_f32_16x16x32_bf16 v[116:119], a[52:55], a[20:23], v[116:119]
    buffer_load_dwordx4 v163, s[40:43], s60 offen lds
    v_mfma_f32_16x16x32_bf16 v[112:115], a[52:55], a[16:19], v[112:115]
    v_mfma_f32_16x16x32_bf16 v[112:115], a[48:51], a[0:3], v[112:115]
    ds_read_b64_tr_b16 a[48:49], v172 offset:64
    v_mfma_f32_16x16x32_bf16 v[128:131], a[56:59], a[0:3], v[128:131]
    ds_read_b64_tr_b16 a[50:51], v172 offset:1856
    s_add_u32 m0, s53, 0x12000
    v_mfma_f32_16x16x32_bf16 v[128:131], a[60:63], a[16:19], v[128:131]
    buffer_load_dwordx4 v163, s[40:43], s61 offen lds
    v_mfma_f32_16x16x32_bf16 v[144:147], a[68:71], a[16:19], v[144:147]
    ds_read_b64_tr_b16 a[52:53], v172 offset:7232
    v_mfma_f32_16x16x32_bf16 v[144:147], a[64:67], a[0:3], v[144:147]
    ds_read_b128 a[0:3], v168 offset:0
    v_mfma_f32_16x16x32_bf16 v[148:151], a[64:67], a[4:7], v[148:151]
    ds_read_b128 a[16:19], v169 offset:0
    s_add_u32 m0, s54, 0x12000
    v_mfma_f32_16x16x32_bf16 v[148:151], a[68:71], a[20:23], v[148:151]
    buffer_load_dwordx4 v163, s[44:47], s62 offen lds
    v_mfma_f32_16x16x32_bf16 v[132:135], a[60:63], a[20:23], v[132:135]
    ds_read_b64_tr_b16 a[54:55], v172 offset:9024
    v_mfma_f32_16x16x32_bf16 v[132:135], a[56:59], a[4:7], v[132:135]
    ds_read_b128 a[4:7], v168 offset:2048
    v_mfma_f32_16x16x32_bf16 v[136:139], a[56:59], a[8:11], v[136:139]
    ds_read_b128 a[20:23], v169 offset:2048
    s_add_u32 m0, s55, 0x12000
    v_mfma_f32_16x16x32_bf16 v[136:139], a[60:63], a[24:27], v[136:139]
    buffer_load_dwordx4 v163, s[44:47], s63 offen lds
    v_mfma_f32_16x16x32_bf16 v[152:155], a[68:71], a[24:27], v[152:155]
    v_mfma_f32_16x16x32_bf16 v[152:155], a[64:67], a[8:11], v[152:155]
    ds_read_b128 a[8:11], v168 offset:4096
    v_mfma_f32_16x16x32_bf16 v[156:159], a[64:67], a[12:15], v[156:159]
    ds_read_b128 a[24:27], v169 offset:4096
    s_add_u32 m0, s56, 0x12000
    v_mfma_f32_16x16x32_bf16 v[156:159], a[68:71], a[28:31], v[156:159]
    buffer_load_dwordx4 v164, s[48:51], s64 offen lds
    v_mfma_f32_16x16x32_bf16 v[140:143], a[60:63], a[28:31], v[140:143]
    ds_read_b64_tr_b16 a[64:65], v172 offset:14368
    v_mfma_f32_16x16x32_bf16 v[140:143], a[56:59], a[12:15], v[140:143]
    ds_read_b128 a[12:15], v168 offset:6144
    s_setprio 0
    buffer_load_dword v179, v178, s[96:99], s94 offen
    s_add_u32 s91, s91, 1
    s_and_b32 s91, s91, s92
    s_mul_i32 s94, s91, s95
    s_add_u32 s70, s70, 128
    s_add_u32 s71, s71, 128
    s_add_u32 s60, s60, s65
    s_add_u32 s61, s61, s65
    s_add_u32 s62, s62, s65
    s_add_u32 s63, s63, s65
    s_add_u32 s64, s64, 0x60000
    s_sub_u32 s74, s74, 1
    s_cmp_lg_u32 s74, 0
    s_cbranch_scc1 K1_LOOP1
    s_waitcnt lgkmcnt(7)
    v_mfma_f32_16x16x32_bf16 v[0:3], a[32:35], a[0:3], v[0:3]
    ds_read_b128 a[28:31], v169 offset:6144
    s_lshr_b32 s86, s28, 1
    s_mul_i32 s86, s86, 7
    s_and_b32 s89, s28, 1
    s_lshl_b32 s87, s29, 4
    v_mfma_f32_16x16x32_bf16 v[0:3], a[36:39], a[16:19], v[0:3]
    ds_read_b64_tr_b16 a[66:67], v172 offset:16160
    s_lshl_b32 s88, s32, 2
    s_add_u32 s87, s87, s88
    s_lshl_b32 s87, s87, 10
    s_mul_i32 s84, s89, 5
    v_mfma_f32_16x16x32_bf16 v[16:19], a[44:47], a[16:19], v[16:19]
    ds_read_b64_tr_b16 a[68:69], v172 offset:21536
    s_add_u32 s84, s84, s86
    s_add_u32 s84, s84, 1
    s_lshl_b32 s84, s84, 17
    s_add_u32 s84, s84, s87
    v_mfma_f32_16x16x32_bf16 v[16:19], a[40:43], a[0:3], v[16:19]
    ds_read_b64_tr_b16 a[70:71], v172 offset:23328
    s_add_u32 s85, s86, 3
    s_lshl_b32 s85, s85, 17
    s_lshl_b32 s89, s89, 16
    s_add_u32 s85, s85, s89
    s_waitcnt lgkmcnt(8)
    v_mfma_f32_16x16x32_bf16 v[20:23], a[40:43], a[4:7], v[20:23]
    ds_read_b64_tr_b16 a[56:57], v172 offset:14336
    s_lshr_b32 s89, s87, 1
    s_add_u32 s85, s85, s89
    s_lshl_b32 s88, s28, 3
    s_add_u32 s88, s88, s29
    v_mfma_f32_16x16x32_bf16 v[20:23], a[44:47], a[20:23], v[20:23]
    ds_read_b64_tr_b16 a[58:59], v172 offset:16128
    s_lshl_b32 s88, s88, 2
    s_add_u32 s88, s88, s32
    s_lshl_b32 s88, s88, 10
    s_add_u32 s88, s88, 0x1a00000
    v_mfma_f32_16x16x32_bf16 v[4:7], a[36:39], a[20:23], v[4:7]
    ds_read_b64_tr_b16 a[60:61], v172 offset:21504
    s_mov_b32 s40, s18
    s_and_b32 s41, s19, 0xffff
    s_mov_b32 s42, 0x700000
    s_mov_b32 s43, 0x20000
    v_mfma_f32_16x16x32_bf16 v[4:7], a[32:35], a[4:7], v[4:7]
    ds_read_b64_tr_b16 a[62:63], v172 offset:23296
    s_mov_b32 s44, s10
    s_and_b32 s45, s11, 0xffff
    s_mov_b32 s46, 0x200000
    s_mov_b32 s47, 0x20000
    s_waitcnt lgkmcnt(10)
    v_mfma_f32_16x16x32_bf16 v[8:11], a[32:35], a[8:11], v[8:11]
    s_mov_b32 s48, s22
    s_and_b32 s49, s23, 0xffff
    s_mov_b32 s50, 0x400000
    s_mov_b32 s51, 0x20000
    v_mfma_f32_16x16x32_bf16 v[8:11], a[36:39], a[24:27], v[8:11]
    s_mov_b32 s52, s24
    s_and_b32 s53, s25, 0xffff
    s_mov_b32 s54, 0x100
    s_mov_b32 s55, 0x20000
    v_mfma_f32_16x16x32_bf16 v[24:27], a[44:47], a[24:27], v[24:27]
    s_lshr_b32 s56, s28, 3
    s_and_b32 s3, s28, 7
    s_mov_b32 s57, s29
    s_lshr_b32 s34, s28, 2
    v_mfma_f32_16x16x32_bf16 v[24:27], a[40:43], a[8:11], v[24:27]
    s_lshl_b32 s58, s3, 4
    s_lshl_b32 s86, s30, 1
    s_add_u32 s58, s58, s86
    s_lshl_b32 s89, s29, 4
    s_waitcnt lgkmcnt(7)
    v_mfma_f32_16x16x32_bf16 v[28:31], a[40:43], a[12:15], v[28:31]
    s_add_u32 s89, s89, s86
    s_lshl_b32 s86, s89, 6
    s_add_u32 s75, s86, 0x1d00000
    s_lshl_b32 s89, s89, 10
    v_mfma_f32_16x16x32_bf16 v[28:31], a[44:47], a[28:31], v[28:31]
    ds_read_b64_tr_b16 a[40:41], v174 offset:4096
    s_lshl_b32 s35, s28, 17
    s_add_u32 s35, s35, s89
    s_add_u32 s35, s35, 0xe00000
    s_lshl_b32 s33, s58, 9
    v_mfma_f32_16x16x32_bf16 v[12:15], a[36:39], a[28:31], v[12:15]
    ds_read_b64_tr_b16 a[42:43], v174 offset:4608
    s_mul_i32 s86, s34, 14
    s_xor_b32 s89, s34, 1
    s_mul_i32 s89, s89, 14
    s_lshl_b32 s96, s58, 10
    v_mfma_f32_16x16x32_bf16 v[12:15], a[32:35], a[12:15], v[12:15]
    ds_read_b64_tr_b16 a[44:45], v174 offset:6144
    s_lshl_b32 s97, s30, 14
    s_lshl_b32 s10, s86, 17
    s_add_u32 s59, s10, s96
    s_lshl_b32 s11, s89, 17
    v_mfma_f32_16x16x32_bf16 v[44:47], a[48:51], a[12:15], v[44:47]
    ds_read_b64_tr_b16 a[46:47], v174 offset:6656
    s_add_u32 s60, s11, s96
    s_lshl_b32 s61, s86, 16
    s_add_u32 s61, s61, s97
    s_lshl_b32 s62, s89, 16
    v_mfma_f32_16x16x32_bf16 v[44:47], a[52:55], a[28:31], v[44:47]
    ds_read_b64_tr_b16 a[32:33], v172 offset:14400
    s_add_u32 s62, s62, s97
    s_lshl_b32 s63, s56, 20
    s_add_u32 s18, s63, 0xe00000
    s_add_u32 s63, s18, s96
    v_mfma_f32_16x16x32_bf16 v[40:43], a[52:55], a[24:27], v[40:43]
    ds_read_b64_tr_b16 a[34:35], v172 offset:16192
    s_lshl_b32 s19, s3, 14
    s_lshl_b32 s96, s57, 11
    s_add_u32 s19, s19, s96
    s_lshl_b32 s22, s3, 13
    v_mfma_f32_16x16x32_bf16 v[40:43], a[48:51], a[8:11], v[40:43]
    ds_read_b64_tr_b16 a[36:37], v172 offset:21568
    s_and_b32 s96, s96, 0x1800
    s_add_u32 s22, s22, s96
    s_lshr_b32 s96, s57, 2
    s_lshl_b32 s96, s96, 16
    v_mfma_f32_16x16x32_bf16 v[36:39], a[48:51], a[4:7], v[36:39]
    ds_read_b64_tr_b16 a[38:39], v172 offset:23360
    s_add_u32 s22, s22, s96
    s_lshl_b32 s64, s56, 19
    s_add_u32 s64, s64, s97
    s_lshl_b32 s65, s30, 11
    v_mfma_f32_16x16x32_bf16 v[36:39], a[52:55], a[20:23], v[36:39]
    s_lshl_b32 s86, s34, 2
    s_add_u32 s86, s86, 0x1e00000
    s_lshl_b32 s67, s3, 7
    s_add_u32 s67, s67, s86
    v_mfma_f32_16x16x32_bf16 v[32:35], a[52:55], a[16:19], v[32:35]
    s_lshl_b32 s66, s29, 7
    s_add_u32 s66, s66, s86
    s_lshl_b32 s68, s28, 7
    s_add_u32 s68, s68, 0x1e00400
    v_mfma_f32_16x16x32_bf16 v[32:35], a[48:51], a[0:3], v[32:35]
    ds_read_b64_tr_b16 a[48:49], v175 offset:4096
    s_lshl_b32 s86, s3, 2
    s_add_u32 s86, s86, s56
    s_lshl_b32 s86, s86, 7
    s_add_u32 s69, s86, 0x1e01400
    s_waitcnt lgkmcnt(9)
    v_mfma_f32_16x16x32_bf16 v[48:51], a[56:59], a[0:3], v[48:51]
    ds_read_b64_tr_b16 a[50:51], v175 offset:4608
    s_lshl_b32 s86, s3, 3
    s_add_u32 s86, s86, s57
    s_lshl_b32 s89, s86, 7
    s_lshl_b32 s96, s30, 2
    v_mfma_f32_16x16x32_bf16 v[48:51], a[60:63], a[16:19], v[48:51]
    ds_read_b64_tr_b16 a[52:53], v175 offset:6144
    s_add_u32 s89, s89, s96
    s_add_u32 s70, s89, 0x1e02400
    s_lshl_b32 s86, s86, 18
    s_lshl_b32 s89, s30, 13
    v_mfma_f32_16x16x32_bf16 v[52:55], a[60:63], a[20:23], v[52:55]
    ds_read_b64_tr_b16 a[54:55], v175 offset:6656
    s_add_u32 s86, s86, s89
    s_add_u32 s71, s86, 0x2400000
    s_lshl_b32 s86, s28, 15
    s_lshl_b32 s89, s30, 9
    v_mfma_f32_16x16x32_bf16 v[52:55], a[56:59], a[4:7], v[52:55]
    s_add_u32 s86, s86, s89
    s_add_u32 s72, s86, 0x1a00000
    s_lshl_b32 s86, s28, 10
    s_add_u32 s73, s86, 0x1c00000
    v_mfma_f32_16x16x32_bf16 v[56:59], a[56:59], a[8:11], v[56:59]
    s_lshl_b32 s86, s58, 6
    s_add_u32 s74, s86, 0x1d00000
    s_lshl_b32 s86, s56, 2
    s_add_u32 s86, s86, 0x1e00400
    v_mfma_f32_16x16x32_bf16 v[56:59], a[60:63], a[24:27], v[56:59]
    s_lshl_b32 s67, s3, 7
    s_add_u32 s67, s67, s86
    s_lshl_b32 s68, s29, 7
    s_add_u32 s68, s68, s86
    v_mfma_f32_16x16x32_bf16 v[60:63], a[60:63], a[28:31], v[60:63]
    s_lshl_b32 s70, s31, 18
    s_lshl_b32 s86, s56, 16
    s_add_u32 s86, s86, 0x1800
    s_add_u32 s35, s86, s71
    v_mfma_f32_16x16x32_bf16 v[60:63], a[56:59], a[12:15], v[60:63]
    ds_read_b64_tr_b16 a[56:57], v174 offset:8192
    s_lshl_b32 s89, s3, 18
    s_add_u32 s86, s86, s89
    s_lshl_b32 s89, s30, 13
    s_add_u32 s86, s86, s89
    v_mfma_f32_16x16x32_bf16 v[76:79], a[64:67], a[12:15], v[76:79]
    ds_read_b64_tr_b16 a[58:59], v174 offset:8704
    s_add_u32 s63, s86, 0x2400000
    s_mov_b32 s90, 0xbdd2d3e8
    s_mov_b32 s91, 0xbdd2d3e8
    s_mov_b32 s92, 1.0
    v_mfma_f32_16x16x32_bf16 v[76:79], a[68:71], a[28:31], v[76:79]
    ds_read_b64_tr_b16 a[60:61], v174 offset:10240
    s_mov_b32 s93, 1.0
    s_mov_b32 s94, 0x3fb8aa3b
    s_mov_b32 s95, 0x3fb8aa3b
    s_mov_b32 s96, 0xbfb8aa3b
    v_mfma_f32_16x16x32_bf16 v[72:75], a[68:71], a[24:27], v[72:75]
    ds_read_b64_tr_b16 a[62:63], v174 offset:10752
    s_mov_b32 s97, 0xbfb8aa3b
    v_lshrrev_b32 v162, 4, v160
    v_lshrrev_b32 v165, 4, v162
    v_bfe_u32 v166, v162, 1, 3
    v_mfma_f32_16x16x32_bf16 v[72:75], a[64:67], a[8:11], v[72:75]
    v_xor_b32 v166, v166, v165
    v_lshlrev_b32 v166, 5, v166
    v_and_b32 v167, 1, v162
    v_lshl_add_u32 v166, v167, 4, v166
    v_mfma_f32_16x16x32_bf16 v[68:71], a[64:67], a[4:7], v[68:71]
    v_lshl_add_u32 v166, v165, 11, v166
    s_lshl_b32 s86, s57, 8
    v_add_u32 v163, s86, v166
    v_xor_b32 v164, 128, v163
    v_mfma_f32_16x16x32_bf16 v[68:71], a[68:71], a[20:23], v[68:71]
    v_add_u32 v164, 0x2000, v164
    v_mfma_f32_16x16x32_bf16 v[64:67], a[68:71], a[16:19], v[64:67]
    v_mfma_f32_16x16x32_bf16 v[64:67], a[64:67], a[0:3], v[64:67]
    ds_read_b64_tr_b16 a[64:65], v175 offset:8192
    s_waitcnt lgkmcnt(9)
    v_mfma_f32_16x16x32_bf16 v[80:83], a[32:35], a[0:3], v[80:83]
    ds_read_b64_tr_b16 a[66:67], v175 offset:8704
    v_mfma_f32_16x16x32_bf16 v[80:83], a[36:39], a[16:19], v[80:83]
    ds_read_b64_tr_b16 a[68:69], v175 offset:10240
    v_mfma_f32_16x16x32_bf16 v[84:87], a[36:39], a[20:23], v[84:87]
    ds_read_b64_tr_b16 a[70:71], v175 offset:10752
    v_mfma_f32_16x16x32_bf16 v[84:87], a[32:35], a[4:7], v[84:87]
    v_mfma_f32_16x16x32_bf16 v[88:91], a[32:35], a[8:11], v[88:91]
    v_mfma_f32_16x16x32_bf16 v[88:91], a[36:39], a[24:27], v[88:91]
    v_mfma_f32_16x16x32_bf16 v[92:95], a[36:39], a[28:31], v[92:95]
    v_mfma_f32_16x16x32_bf16 v[92:95], a[32:35], a[12:15], v[92:95]
    s_waitcnt vmcnt(0) lgkmcnt(0)
    s_barrier
    ds_read_b64_tr_b16 a[32:33], v173 offset:0
    v_mfma_f32_16x16x32_bf16 v[108:111], a[40:43], a[12:15], v[108:111]
    ds_read_b64_tr_b16 a[34:35], v173 offset:1792
    v_mov_b32 v165, 0x10080
    v_mov_b32 v166, 0
    v_mov_b32 v167, 0
    ds_write_b64 v165, v[166:167]
    v_mfma_f32_16x16x32_bf16 v[108:111], a[44:47], a[28:31], v[108:111]
    ds_read_b64_tr_b16 a[36:37], v173 offset:32
    s_add_u32 s23, s61, 0x0
    s_add_u32 m0, s65, 0
    s_nop 0
    buffer_load_dwordx4 v163, s[40:43], s23 offen lds
    v_mfma_f32_16x16x32_bf16 v[104:107], a[44:47], a[24:27], v[104:107]
    ds_read_b64_tr_b16 a[38:39], v173 offset:1824
    v_mfma_f32_16x16x32_bf16 v[104:107], a[40:43], a[8:11], v[104:107]
    v_mfma_f32_16x16x32_bf16 v[100:103], a[40:43], a[4:7], v[100:103]
    s_add_u32 m0, s65, 1024
    s_nop 0
    buffer_load_dwordx4 v164, s[40:43], s23 offen lds
    v_mfma_f32_16x16x32_bf16 v[100:103], a[44:47], a[20:23], v[100:103]
    v_mfma_f32_16x16x32_bf16 v[96:99], a[44:47], a[16:19], v[96:99]
    v_mfma_f32_16x16x32_bf16 v[96:99], a[40:43], a[0:3], v[96:99]
    ds_read_b64_tr_b16 a[40:41], v173 offset:64
    v_mfma_f32_16x16x32_bf16 v[112:115], a[48:51], a[0:3], v[112:115]
    ds_read_b64_tr_b16 a[42:43], v173 offset:1856
    s_add_u32 s23, s61, 0x50000
    s_add_u32 m0, s65, 16384
    s_nop 0
    buffer_load_dwordx4 v163, s[40:43], s23 offen lds
    v_mfma_f32_16x16x32_bf16 v[112:115], a[52:55], a[16:19], v[112:115]
    ds_read_b64_tr_b16 a[44:45], v173 offset:14336
    v_mfma_f32_16x16x32_bf16 v[116:119], a[52:55], a[20:23], v[116:119]
    ds_read_b64_tr_b16 a[46:47], v173 offset:16128
    v_mfma_f32_16x16x32_bf16 v[116:119], a[48:51], a[4:7], v[116:119]
    v_mfma_f32_16x16x32_bf16 v[120:123], a[48:51], a[8:11], v[120:123]
    s_add_u32 m0, s65, 17408
    s_nop 0
    buffer_load_dwordx4 v164, s[40:43], s23 offen lds
    v_mfma_f32_16x16x32_bf16 v[120:123], a[52:55], a[24:27], v[120:123]
    v_mfma_f32_16x16x32_bf16 v[124:127], a[52:55], a[28:31], v[124:127]
    v_mfma_f32_16x16x32_bf16 v[124:127], a[48:51], a[12:15], v[124:127]
    ds_read_b64_tr_b16 a[48:49], v173 offset:14368
    v_mfma_f32_16x16x32_bf16 v[140:143], a[56:59], a[12:15], v[140:143]
    ds_read_b64_tr_b16 a[50:51], v173 offset:16160
    s_add_u32 s23, s61, 0x70000
    s_add_u32 m0, s65, 32768
    s_nop 0
    buffer_load_dwordx4 v163, s[40:43], s23 offen lds
    v_mfma_f32_16x16x32_bf16 v[140:143], a[60:63], a[28:31], v[140:143]
    ds_read_b64_tr_b16 a[52:53], v173 offset:14400
    v_mfma_f32_16x16x32_bf16 v[156:159], a[68:71], a[28:31], v[156:159]
    ds_read_b64_tr_b16 a[54:55], v173 offset:16192
    v_mfma_f32_16x16x32_bf16 v[156:159], a[64:67], a[12:15], v[156:159]
    ds_read_b128 a[12:15], v170 offset:6144
    v_mfma_f32_16x16x32_bf16 v[152:155], a[64:67], a[8:11], v[152:155]
    s_add_u32 m0, s65, 33792
    s_nop 0
    buffer_load_dwordx4 v164, s[40:43], s23 offen lds
    v_mfma_f32_16x16x32_bf16 v[152:155], a[68:71], a[24:27], v[152:155]
    v_mfma_f32_16x16x32_bf16 v[136:139], a[60:63], a[24:27], v[136:139]
    v_mfma_f32_16x16x32_bf16 v[136:139], a[56:59], a[8:11], v[136:139]
    ds_read_b128 a[8:11], v170 offset:4096
    v_mfma_f32_16x16x32_bf16 v[132:135], a[56:59], a[4:7], v[132:135]
    s_add_u32 s23, s61, 0xc0000
    s_add_u32 m0, s65, 49152
    s_nop 0
    buffer_load_dwordx4 v163, s[40:43], s23 offen lds
    v_mfma_f32_16x16x32_bf16 v[132:135], a[60:63], a[20:23], v[132:135]
    v_mfma_f32_16x16x32_bf16 v[148:151], a[68:71], a[20:23], v[148:151]
    v_mfma_f32_16x16x32_bf16 v[148:151], a[64:67], a[4:7], v[148:151]
    ds_read_b128 a[4:7], v170 offset:2048
    v_mfma_f32_16x16x32_bf16 v[144:147], a[64:67], a[0:3], v[144:147]
    s_add_u32 m0, s65, 50176
    s_nop 0
    buffer_load_dwordx4 v164, s[40:43], s23 offen lds
    v_mfma_f32_16x16x32_bf16 v[144:147], a[68:71], a[16:19], v[144:147]
    ds_read_b64_tr_b16 a[64:65], v176 offset:8192
    buffer_store_dwordx4 v[180:183], v160, s[76:79], s35 offen offset:1024 sc1
    v_mfma_f32_16x16x32_bf16 v[128:131], a[60:63], a[16:19], v[128:131]
    ds_read_b64_tr_b16 a[66:67], v176 offset:8704
    buffer_store_dwordx4 v[180:183], v160, s[76:79], s88 offen sc1
    v_mfma_f32_16x16x32_bf16 v[128:131], a[56:59], a[0:3], v[128:131]
    ds_read_b128 a[0:3], v170 offset:0
    s_waitcnt lgkmcnt(0)
    v_mfma_f32_16x16x32_bf16 v[0:3], a[32:35], a[0:3], v[0:3]
    ds_read_b64_tr_b16 a[68:69], v177 offset:8192
    v_lshrrev_b32 v162, 2, v160
    buffer_load_dword v161, v162, s[52:55], 0 offen sc1
    v_mfma_f32_16x16x32_bf16 v[4:7], a[32:35], a[4:7], v[4:7]
    ds_read_b64_tr_b16 a[70:71], v177 offset:8704
    v_mov_b32 v178, 0xc0135761
    v_mov_b32 v179, 0xc0135761
    v_bfe_u32 v180, v160, 4, 4
    v_lshrrev_b32 v181, 8, v160
    v_mfma_f32_16x16x32_bf16 v[8:11], a[32:35], a[8:11], v[8:11]
    ds_read_b64_tr_b16 a[56:57], v176 offset:4096
    v_lshrrev_b32 v182, 6, v160
    v_bfe_u32 v183, v160, 4, 2
    v_mfma_f32_16x16x32_bf16 v[12:15], a[32:35], a[12:15], v[12:15]
    ds_read_b64_tr_b16 a[58:59], v176 offset:4608
    v_mfma_f32_16x16x32_bf16 v[16:19], a[36:39], a[0:3], v[16:19]
    ds_read_b64_tr_b16 a[60:61], v177 offset:4096
    v_mfma_f32_16x16x32_bf16 v[20:23], a[36:39], a[4:7], v[20:23]
    ds_read_b64_tr_b16 a[62:63], v177 offset:4608
    v_mfma_f32_16x16x32_bf16 v[24:27], a[36:39], a[8:11], v[24:27]
    ds_read_b128 a[16:19], v171 offset:0
    v_mfma_f32_16x16x32_bf16 v[28:31], a[36:39], a[12:15], v[28:31]
    ds_read_b128 a[20:23], v171 offset:2048
    v_mfma_f32_16x16x32_bf16 v[48:51], a[44:47], a[0:3], v[48:51]
    ds_read_b128 a[24:27], v171 offset:4096
    v_mfma_f32_16x16x32_bf16 v[52:55], a[44:47], a[4:7], v[52:55]
    ds_read_b128 a[28:31], v171 offset:6144
    v_mfma_f32_16x16x32_bf16 v[56:59], a[44:47], a[8:11], v[56:59]
    ds_read_b64_tr_b16 a[32:33], v173 offset:7168
    v_mfma_f32_16x16x32_bf16 v[60:63], a[44:47], a[12:15], v[60:63]
    ds_read_b64_tr_b16 a[34:35], v173 offset:8960
    v_mfma_f32_16x16x32_bf16 v[64:67], a[48:51], a[0:3], v[64:67]
    ds_read_b64_tr_b16 a[36:37], v173 offset:7200
    v_mfma_f32_16x16x32_bf16 v[68:71], a[48:51], a[4:7], v[68:71]
    ds_read_b64_tr_b16 a[38:39], v173 offset:8992
    v_mfma_f32_16x16x32_bf16 v[72:75], a[48:51], a[8:11], v[72:75]
    ds_read_b64_tr_b16 a[44:45], v173 offset:21504
    v_mfma_f32_16x16x32_bf16 v[76:79], a[48:51], a[12:15], v[76:79]
    ds_read_b64_tr_b16 a[46:47], v173 offset:23296
    s_waitcnt lgkmcnt(4)
    v_mfma_f32_16x16x32_bf16 v[0:3], a[32:35], a[16:19], v[0:3]
    ds_read_b64_tr_b16 a[48:49], v173 offset:21536
    v_mfma_f32_16x16x32_bf16 v[4:7], a[32:35], a[20:23], v[4:7]
    ds_read_b64_tr_b16 a[50:51], v173 offset:23328
    v_mfma_f32_16x16x32_bf16 v[8:11], a[32:35], a[24:27], v[8:11]
    v_mfma_f32_16x16x32_bf16 v[12:15], a[32:35], a[28:31], v[12:15]
    s_waitcnt lgkmcnt(4)
    v_mfma_f32_16x16x32_bf16 v[16:19], a[36:39], a[16:19], v[16:19]
    v_mfma_f32_16x16x32_bf16 v[20:23], a[36:39], a[20:23], v[20:23]
    v_mfma_f32_16x16x32_bf16 v[24:27], a[36:39], a[24:27], v[24:27]
    v_mfma_f32_16x16x32_bf16 v[28:31], a[36:39], a[28:31], v[28:31]
    s_waitcnt lgkmcnt(2)
    v_mfma_f32_16x16x32_bf16 v[48:51], a[44:47], a[16:19], v[48:51]
    v_lshlrev_b32 v172, 6, v182
    v_lshl_add_u32 v172, v183, 3, v172
    v_add_u32 v172, 0x24000, v172
    ds_read_b64_tr_b16 a[32:33], v172 offset:0
    v_mfma_f32_16x16x32_bf16 v[52:55], a[44:47], a[20:23], v[52:55]
    ds_read_b64_tr_b16 a[34:35], v172 offset:1024
    v_mfma_f32_16x16x32_bf16 v[56:59], a[44:47], a[24:27], v[56:59]
    ds_read_b64_tr_b16 a[36:37], v172 offset:32
    v_mfma_f32_16x16x32_bf16 v[60:63], a[44:47], a[28:31], v[60:63]
    ds_read_b64_tr_b16 a[38:39], v172 offset:1056
    s_waitcnt lgkmcnt(4)
    v_mfma_f32_16x16x32_bf16 v[64:67], a[48:51], a[16:19], v[64:67]
    v_mfma_f32_16x16x32_bf16 v[68:71], a[48:51], a[20:23], v[68:71]
    v_mfma_f32_16x16x32_bf16 v[72:75], a[48:51], a[24:27], v[72:75]
    v_mfma_f32_16x16x32_bf16 v[76:79], a[48:51], a[28:31], v[76:79]
    v_mfma_f32_16x16x32_bf16 v[32:35], a[40:43], a[0:3], v[32:35]
    v_mul_f32 v162, v0, v0
    v_mul_f32 v166, v16, v16
    v_mul_f32 v163, v1, v1
    v_mul_f32 v167, v17, v17
    v_mfma_f32_16x16x32_bf16 v[36:39], a[40:43], a[4:7], v[36:39]
    v_mul_f32 v164, v2, v2
    v_mul_f32 v168, v18, v18
    v_mul_f32 v165, v3, v3
    v_mul_f32 v169, v19, v19
    v_mfma_f32_16x16x32_bf16 v[40:43], a[40:43], a[8:11], v[40:43]
    v_fma_f32 v162, v162, s90, v178
    v_fma_f32 v166, v166, s90, v178
    v_fma_f32 v163, v163, s90, v178
    v_fma_f32 v167, v167, s90, v178
    v_mfma_f32_16x16x32_bf16 v[44:47], a[40:43], a[12:15], v[44:47]
    v_fma_f32 v164, v164, s90, v178
    v_fma_f32 v168, v168, s90, v178
    v_fma_f32 v165, v165, s90, v178
    v_fma_f32 v169, v169, s90, v178
    v_mfma_f32_16x16x32_bf16 v[80:83], a[52:55], a[0:3], v[80:83]
    ds_read_b64_tr_b16 a[40:41], v173 offset:7232
    v_mul_f32 v162, v162, v0
    v_mul_f32 v166, v166, v16
    v_mul_f32 v163, v163, v1
    v_mul_f32 v167, v167, v17
    v_mfma_f32_16x16x32_bf16 v[84:87], a[52:55], a[4:7], v[84:87]
    ds_read_b64_tr_b16 a[42:43], v173 offset:9024
    v_mul_f32 v164, v164, v2
    v_mul_f32 v168, v168, v18
    v_mul_f32 v165, v165, v3
    v_mul_f32 v169, v169, v19
    v_mfma_f32_16x16x32_bf16 v[88:91], a[52:55], a[8:11], v[88:91]
    v_exp_f32 v162, v162
    v_exp_f32 v166, v166
    v_exp_f32 v163, v163
    v_exp_f32 v167, v167
    v_mfma_f32_16x16x32_bf16 v[92:95], a[52:55], a[12:15], v[92:95]
    v_exp_f32 v164, v164
    v_exp_f32 v168, v168
    v_exp_f32 v165, v165
    v_exp_f32 v169, v169
    v_mfma_f32_16x16x32_bf16 v[96:99], a[56:59], a[0:3], v[96:99]
    ds_read_b64_tr_b16 a[52:53], v173 offset:21568
    v_mul_f32 v48, v48, v0
    v_mul_f32 v64, v64, v16
    v_mul_f32 v49, v49, v1
    v_mul_f32 v65, v65, v17
    v_mfma_f32_16x16x32_bf16 v[100:103], a[56:59], a[4:7], v[100:103]
    ds_read_b64_tr_b16 a[54:55], v173 offset:23360
    v_mul_f32 v50, v50, v2
    v_mul_f32 v66, v66, v18
    v_mul_f32 v51, v51, v3
    v_mul_f32 v67, v67, v19
    v_mfma_f32_16x16x32_bf16 v[104:107], a[56:59], a[8:11], v[104:107]
    v_add_f32 v162, 1.0, v162
    v_add_f32 v166, 1.0, v166
    v_add_f32 v163, 1.0, v163
    v_add_f32 v167, 1.0, v167
    v_mfma_f32_16x16x32_bf16 v[108:111], a[56:59], a[12:15], v[108:111]
    v_add_f32 v164, 1.0, v164
    v_add_f32 v168, 1.0, v168
    v_add_f32 v165, 1.0, v165
    v_add_f32 v169, 1.0, v169
    v_mfma_f32_16x16x32_bf16 v[112:115], a[60:63], a[0:3], v[112:115]
    ds_read_b64_tr_b16 a[56:57], v176 offset:6144
    v_rcp_f32 v162, v162
    v_rcp_f32 v166, v166
    v_rcp_f32 v163, v163
    v_rcp_f32 v167, v167
    v_mfma_f32_16x16x32_bf16 v[116:119], a[60:63], a[4:7], v[116:119]
    ds_read_b64_tr_b16 a[58:59], v176 offset:6656
    v_rcp_f32 v164, v164
    v_rcp_f32 v168, v168
    v_rcp_f32 v165, v165
    v_rcp_f32 v169, v169
    v_mfma_f32_16x16x32_bf16 v[120:123], a[60:63], a[8:11], v[120:123]
    v_mul_f32 v48, v48, v162
    v_mul_f32 v64, v64, v166
    v_mul_f32 v49, v49, v163
    v_mul_f32 v65, v65, v167
    v_mfma_f32_16x16x32_bf16 v[124:127], a[60:63], a[12:15], v[124:127]
    v_mul_f32 v50, v50, v164
    v_mul_f32 v66, v66, v168
    v_mul_f32 v51, v51, v165
    v_mul_f32 v67, v67, v169
    v_mfma_f32_16x16x32_bf16 v[128:131], a[64:67], a[0:3], v[128:131]
    ds_read_b64_tr_b16 a[60:61], v177 offset:6144
    v_cvt_pk_bf16_f32 v0, v48, v49
    v_cvt_pk_bf16_f32 v2, v64, v65
    v_cvt_pk_bf16_f32 v1, v50, v51
    v_cvt_pk_bf16_f32 v3, v66, v67
    v_mfma_f32_16x16x32_bf16 v[132:135], a[64:67], a[4:7], v[132:135]
    ds_read_b64_tr_b16 a[62:63], v177 offset:6656
    buffer_store_dwordx4 v[0:3], v160, s[76:79], s84 offen offset:0 sc1
    v_mul_f32 v162, v4, v4
    v_mul_f32 v166, v20, v20
    v_mul_f32 v163, v5, v5
    v_mfma_f32_16x16x32_bf16 v[136:139], a[64:67], a[8:11], v[136:139]
    v_mul_f32 v167, v21, v21
    v_mul_f32 v164, v6, v6
    v_mul_f32 v168, v22, v22
    v_mul_f32 v165, v7, v7
    v_mfma_f32_16x16x32_bf16 v[140:143], a[64:67], a[12:15], v[140:143]
    v_mul_f32 v169, v23, v23
    v_fma_f32 v162, v162, s90, v178
    v_fma_f32 v166, v166, s90, v178
    v_fma_f32 v163, v163, s90, v178
    v_mfma_f32_16x16x32_bf16 v[144:147], a[68:71], a[0:3], v[144:147]
    ds_read_b64_tr_b16 a[64:65], v176 offset:10240
    v_fma_f32 v167, v167, s90, v178
    v_fma_f32 v164, v164, s90, v178
    v_fma_f32 v168, v168, s90, v178
    v_fma_f32 v165, v165, s90, v178
    v_mfma_f32_16x16x32_bf16 v[148:151], a[68:71], a[4:7], v[148:151]
    ds_read_b64_tr_b16 a[66:67], v176 offset:10752
    v_fma_f32 v169, v169, s90, v178
    v_mul_f32 v162, v162, v4
    v_mul_f32 v166, v166, v20
    v_mul_f32 v163, v163, v5
    v_mfma_f32_16x16x32_bf16 v[152:155], a[68:71], a[8:11], v[152:155]
    v_mul_f32 v167, v167, v21
    v_mul_f32 v164, v164, v6
    v_mul_f32 v168, v168, v22
    v_mul_f32 v165, v165, v7
    v_mfma_f32_16x16x32_bf16 v[156:159], a[68:71], a[12:15], v[156:159]
    v_mul_f32 v169, v169, v23
    v_exp_f32 v162, v162
    v_exp_f32 v166, v166
    v_exp_f32 v163, v163
    s_waitcnt lgkmcnt(8)
    v_mfma_f32_16x16x32_bf16 v[32:35], a[40:43], a[16:19], v[32:35]
    ds_read_b64_tr_b16 a[68:69], v177 offset:10240
    s_mov_b32 s80, s20
    s_and_b32 s81, s21, 0xffff
    s_mov_b32 s82, 0x800
    s_mov_b32 s83, 0x20000
    v_mfma_f32_16x16x32_bf16 v[36:39], a[40:43], a[20:23], v[36:39]
    ds_read_b64_tr_b16 a[70:71], v177 offset:10752
    s_lshl_b32 s89, s28, 3
    s_add_u32 s89, s89, s30
    s_lshl_b32 s86, s89, 11
    v_lshlrev_b32 v172, 1, v160
    v_mfma_f32_16x16x32_bf16 v[40:43], a[40:43], a[24:27], v[40:43]
    buffer_load_dwordx4 a[0:3], v172, s[36:39], s86 offen
    v_exp_f32 v167, v167
    v_exp_f32 v164, v164
    v_exp_f32 v168, v168
    v_mfma_f32_16x16x32_bf16 v[44:47], a[40:43], a[28:31], v[44:47]
    buffer_load_dwordx4 a[4:7], v172, s[36:39], s86 offen offset:16
    v_exp_f32 v165, v165
    v_exp_f32 v169, v169
    v_mul_f32 v52, v52, v4
    s_waitcnt lgkmcnt(8)
    v_mfma_f32_16x16x32_bf16 v[80:83], a[52:55], a[16:19], v[80:83]
    buffer_load_dwordx4 a[8:11], v172, s[80:83], 0 offen
    v_mul_f32 v68, v68, v20
    v_mul_f32 v53, v53, v5
    v_mul_f32 v69, v69, v21
    v_mfma_f32_16x16x32_bf16 v[84:87], a[52:55], a[20:23], v[84:87]
    buffer_load_dwordx4 a[12:15], v172, s[80:83], 0 offen offset:16
    v_mul_f32 v54, v54, v6
    v_mul_f32 v70, v70, v22
    v_mul_f32 v55, v55, v7
    v_mfma_f32_16x16x32_bf16 v[88:91], a[52:55], a[24:27], v[88:91]
    s_lshl_b32 s86, s29, 8
    s_add_u32 s86, s86, s89
    s_lshl_b32 s86, s86, 2
    s_add_u32 s87, s86, 0x1d00000
    v_mfma_f32_16x16x32_bf16 v[92:95], a[52:55], a[28:31], v[92:95]
    v_mul_f32 v71, v71, v23
    v_add_f32 v162, 1.0, v162
    v_add_f32 v166, 1.0, v166
    v_add_f32 v163, 1.0, v163
    s_waitcnt lgkmcnt(6)
    v_mfma_f32_16x16x32_bf16 v[96:99], a[56:59], a[16:19], v[96:99]
    v_add_f32 v167, 1.0, v167
    v_add_f32 v164, 1.0, v164
    v_add_f32 v168, 1.0, v168
    v_add_f32 v165, 1.0, v165
    v_mfma_f32_16x16x32_bf16 v[100:103], a[56:59], a[20:23], v[100:103]
    v_add_f32 v169, 1.0, v169
    v_rcp_f32 v162, v162
    v_rcp_f32 v166, v166
    v_rcp_f32 v163, v163
    v_mfma_f32_16x16x32_bf16 v[104:107], a[56:59], a[24:27], v[104:107]
    v_rcp_f32 v167, v167
    v_rcp_f32 v164, v164
    v_rcp_f32 v168, v168
    v_rcp_f32 v165, v165
    v_mfma_f32_16x16x32_bf16 v[108:111], a[56:59], a[28:31], v[108:111]
    v_rcp_f32 v169, v169
    v_mul_f32 v52, v52, v162
    v_mul_f32 v68, v68, v166
    v_mul_f32 v53, v53, v163
    s_waitcnt lgkmcnt(4)
    v_mfma_f32_16x16x32_bf16 v[112:115], a[60:63], a[16:19], v[112:115]
    v_mul_f32 v69, v69, v167
    v_mul_f32 v54, v54, v164
    v_mul_f32 v70, v70, v168
    v_mul_f32 v55, v55, v165
    v_mfma_f32_16x16x32_bf16 v[116:119], a[60:63], a[20:23], v[116:119]
    v_mul_f32 v71, v71, v169
    v_cvt_pk_bf16_f32 v4, v52, v53
    v_cvt_pk_bf16_f32 v6, v68, v69
    v_cvt_pk_bf16_f32 v5, v54, v55
    v_mfma_f32_16x16x32_bf16 v[120:123], a[60:63], a[24:27], v[120:123]
    v_cvt_pk_bf16_f32 v7, v70, v71
    buffer_store_dwordx4 v[4:7], v160, s[76:79], s84 offen offset:1024 sc1
    v_mul_f32 v162, v8, v8
    v_mul_f32 v166, v24, v24
    v_mfma_f32_16x16x32_bf16 v[124:127], a[60:63], a[28:31], v[124:127]
    v_mul_f32 v163, v9, v9
    v_mul_f32 v167, v25, v25
    v_mul_f32 v164, v10, v10
    v_mul_f32 v168, v26, v26
    s_waitcnt lgkmcnt(2)
    v_mfma_f32_16x16x32_bf16 v[128:131], a[64:67], a[16:19], v[128:131]
    v_mul_f32 v165, v11, v11
    v_mul_f32 v169, v27, v27
    v_fma_f32 v162, v162, s90, v178
    v_fma_f32 v166, v166, s90, v178
    v_mfma_f32_16x16x32_bf16 v[132:135], a[64:67], a[20:23], v[132:135]
    v_fma_f32 v163, v163, s90, v178
    v_fma_f32 v167, v167, s90, v178
    v_fma_f32 v164, v164, s90, v178
    v_fma_f32 v168, v168, s90, v178
    v_mfma_f32_16x16x32_bf16 v[136:139], a[64:67], a[24:27], v[136:139]
    v_fma_f32 v165, v165, s90, v178
    v_fma_f32 v169, v169, s90, v178
    v_mul_f32 v162, v162, v8
    v_mul_f32 v166, v166, v24
    v_mfma_f32_16x16x32_bf16 v[140:143], a[64:67], a[28:31], v[140:143]
    v_mul_f32 v163, v163, v9
    v_mul_f32 v167, v167, v25
    v_mul_f32 v164, v164, v10
    v_mul_f32 v168, v168, v26
    s_waitcnt lgkmcnt(0)
    v_mfma_f32_16x16x32_bf16 v[144:147], a[68:71], a[16:19], v[144:147]
    v_mul_f32 v165, v165, v11
    v_mul_f32 v169, v169, v27
    v_exp_f32 v162, v162
    v_exp_f32 v166, v166
    v_mfma_f32_16x16x32_bf16 v[148:151], a[68:71], a[20:23], v[148:151]
    v_exp_f32 v163, v163
    v_exp_f32 v167, v167
    v_exp_f32 v164, v164
    v_exp_f32 v168, v168
    v_mfma_f32_16x16x32_bf16 v[152:155], a[68:71], a[24:27], v[152:155]
    v_exp_f32 v165, v165
    v_exp_f32 v169, v169
    v_mul_f32 v56, v56, v8
    v_mul_f32 v72, v72, v24
    v_mfma_f32_16x16x32_bf16 v[156:159], a[68:71], a[28:31], v[156:159]
    v_mul_f32 v57, v57, v9
    v_mul_f32 v73, v73, v25
    v_mul_f32 v58, v58, v10
    v_mul_f32 v74, v74, v26
    v_mul_f32 v59, v59, v11
    v_mul_f32 v75, v75, v27
    v_add_f32 v162, 1.0, v162
    v_add_f32 v166, 1.0, v166
    v_add_f32 v163, 1.0, v163
    v_add_f32 v167, 1.0, v167
    v_add_f32 v164, 1.0, v164
    v_add_f32 v168, 1.0, v168
    v_add_f32 v165, 1.0, v165
    v_add_f32 v169, 1.0, v169
    v_rcp_f32 v162, v162
    v_rcp_f32 v166, v166
    v_rcp_f32 v163, v163
    v_rcp_f32 v167, v167
    v_rcp_f32 v164, v164
    v_rcp_f32 v168, v168
    v_rcp_f32 v165, v165
    v_rcp_f32 v169, v169
    v_mul_f32 v56, v56, v162
    v_mul_f32 v72, v72, v166
    v_mul_f32 v57, v57, v163
    v_mul_f32 v73, v73, v167
    v_mul_f32 v58, v58, v164
    v_mul_f32 v74, v74, v168
    v_mul_f32 v59, v59, v165
    v_mul_f32 v75, v75, v169
    v_cvt_pk_bf16_f32 v8, v56, v57
    v_cvt_pk_bf16_f32 v10, v72, v73
    v_cvt_pk_bf16_f32 v9, v58, v59
    v_cvt_pk_bf16_f32 v11, v74, v75
    buffer_store_dwordx4 v[8:11], v160, s[76:79], s84 offen offset:2048 sc1
    s_waitcnt lgkmcnt(0)
    s_setprio 1
    s_lshl_b32 s89, s32, 6
    v_add_u32 v171, s89, v180
    v_mul_u32_u24 v170, 96, v171
    v_mul_u32_u24 v171, 160, v171
    v_lshl_add_u32 v170, v181, 3, v170
    v_lshl_add_u32 v171, v181, 3, v171
    v_add_u32 v170, 0x1a000, v170
    v_add_u32 v171, 0x10000, v171
    s_barrier
    v_pk_mul_f32 v[162:163], v[12:13], v[12:13]
    v_pk_mul_f32 v[166:167], v[28:29], v[28:29]
    v_pk_mul_f32 v[164:165], v[14:15], v[14:15]
    v_pk_mul_f32 v[168:169], v[30:31], v[30:31]
    v_pk_fma_f32 v[162:163], v[162:163], s[90:91], v[178:179]
    v_pk_fma_f32 v[166:167], v[166:167], s[90:91], v[178:179]
    v_pk_fma_f32 v[164:165], v[164:165], s[90:91], v[178:179]
    v_pk_fma_f32 v[168:169], v[168:169], s[90:91], v[178:179]
    v_pk_mul_f32 v[162:163], v[162:163], v[12:13]
    v_pk_mul_f32 v[166:167], v[166:167], v[28:29]
    v_pk_mul_f32 v[164:165], v[164:165], v[14:15]
    v_pk_mul_f32 v[168:169], v[168:169], v[30:31]
    v_exp_f32 v162, v162
    v_exp_f32 v166, v166
    v_exp_f32 v163, v163
    v_exp_f32 v167, v167
    v_exp_f32 v164, v164
    v_exp_f32 v168, v168
    v_exp_f32 v165, v165
    v_exp_f32 v169, v169
    v_pk_mul_f32 v[60:61], v[60:61], v[12:13]
    v_pk_mul_f32 v[76:77], v[76:77], v[28:29]
    v_pk_mul_f32 v[62:63], v[62:63], v[14:15]
    v_pk_mul_f32 v[78:79], v[78:79], v[30:31]
    v_pk_add_f32 v[162:163], v[162:163], s[92:93]
    v_pk_add_f32 v[166:167], v[166:167], s[92:93]
    v_pk_add_f32 v[164:165], v[164:165], s[92:93]
    v_pk_add_f32 v[168:169], v[168:169], s[92:93]
    v_rcp_f32 v162, v162
    v_rcp_f32 v166, v166
    v_rcp_f32 v163, v163
    v_rcp_f32 v167, v167
    v_rcp_f32 v164, v164
    v_rcp_f32 v168, v168
    v_rcp_f32 v165, v165
    v_rcp_f32 v169, v169
    v_pk_mul_f32 v[60:61], v[60:61], v[162:163]
    v_pk_mul_f32 v[76:77], v[76:77], v[166:167]
    v_pk_mul_f32 v[62:63], v[62:63], v[164:165]
    v_pk_mul_f32 v[78:79], v[78:79], v[168:169]
    v_cvt_pk_bf16_f32 v12, v60, v61
    v_cvt_pk_bf16_f32 v14, v76, v77
    v_cvt_pk_bf16_f32 v13, v62, v63
    v_cvt_pk_bf16_f32 v15, v78, v79
    buffer_store_dwordx4 v[12:15], v160, s[76:79], s84 offen offset:3072 sc1
    v_pk_mul_f32 v[162:163], v[32:33], v[32:33]
    v_pk_mul_f32 v[166:167], v[36:37], v[36:37]
    v_pk_mul_f32 v[164:165], v[34:35], v[34:35]
    v_pk_mul_f32 v[168:169], v[38:39], v[38:39]
    v_pk_fma_f32 v[162:163], v[162:163], s[90:91], v[178:179]
    v_pk_fma_f32 v[166:167], v[166:167], s[90:91], v[178:179]
    v_pk_fma_f32 v[164:165], v[164:165], s[90:91], v[178:179]
    v_pk_fma_f32 v[168:169], v[168:169], s[90:91], v[178:179]
    v_pk_mul_f32 v[162:163], v[162:163], v[32:33]
    v_pk_mul_f32 v[166:167], v[166:167], v[36:37]
    v_pk_mul_f32 v[164:165], v[164:165], v[34:35]
    v_pk_mul_f32 v[168:169], v[168:169], v[38:39]
    v_exp_f32 v162, v162
    v_exp_f32 v166, v166
    v_exp_f32 v163, v163
    v_exp_f32 v167, v167
    v_exp_f32 v164, v164
    v_exp_f32 v168, v168
    v_exp_f32 v165, v165
    v_exp_f32 v169, v169
    v_pk_mul_f32 v[80:81], v[80:81], v[32:33]
    v_pk_mul_f32 v[84:85], v[84:85], v[36:37]
    v_pk_mul_f32 v[82:83], v[82:83], v[34:35]
    v_pk_mul_f32 v[86:87], v[86:87], v[38:39]
    v_pk_add_f32 v[162:163], v[162:163], s[92:93]
    v_pk_add_f32 v[166:167], v[166:167], s[92:93]
    v_pk_add_f32 v[164:165], v[164:165], s[92:93]
    v_pk_add_f32 v[168:169], v[168:169], s[92:93]
    v_rcp_f32 v162, v162
    v_rcp_f32 v166, v166
    v_rcp_f32 v163, v163
    v_rcp_f32 v167, v167
    v_rcp_f32 v164, v164
    v_rcp_f32 v168, v168
    v_rcp_f32 v165, v165
    v_rcp_f32 v169, v169
    v_pk_mul_f32 v[80:81], v[80:81], v[162:163]
    v_pk_mul_f32 v[84:85], v[84:85], v[166:167]
    v_pk_mul_f32 v[82:83], v[82:83], v[164:165]
    v_pk_mul_f32 v[86:87], v[86:87], v[168:169]
    v_cvt_pk_bf16_f32 v32, v80, v81
    v_cvt_pk_bf16_f32 v34, v84, v85
    v_cvt_pk_bf16_f32 v33, v82, v83
    v_cvt_pk_bf16_f32 v35, v86, v87
    buffer_store_dwordx4 v[32:35], v160, s[76:79], s85 offen offset:0 sc1
    s_waitcnt vmcnt(4)
    v_accvgpr_read_b32 v162, a0
    v_accvgpr_read_b32 v166, a8
    v_accvgpr_read_b32 v163, a1
    v_accvgpr_read_b32 v167, a9
    v_accvgpr_read_b32 v164, a2
    v_accvgpr_read_b32 v168, a10
    v_accvgpr_read_b32 v165, a3
    v_accvgpr_read_b32 v169, a11
    v_dot2_f32_bf16 v172, v162, v166, 0
    v_dot2_f32_bf16 v172, v163, v167, v172
    v_dot2_f32_bf16 v172, v164, v168, v172
    v_dot2_f32_bf16 v172, v165, v169, v172
    s_nop 3
    v_accvgpr_read_b32 v162, a4
    v_accvgpr_read_b32 v166, a12
    v_accvgpr_read_b32 v163, a5
    v_accvgpr_read_b32 v167, a13
    v_accvgpr_read_b32 v164, a6
    v_accvgpr_read_b32 v168, a14
    v_accvgpr_read_b32 v165, a7
    v_accvgpr_read_b32 v169, a15
    v_dot2_f32_bf16 v173, v162, v166, 0
    v_dot2_f32_bf16 v173, v163, v167, v173
    v_dot2_f32_bf16 v173, v164, v168, v173
    v_dot2_f32_bf16 v173, v165, v169, v173
    s_nop 3
    v_add_f32 v172, v172, v173
    s_nop 1
    v_add_f32_dpp v172, v172, v172 quad_perm:[1,0,3,2] row_mask:0xf bank_mask:0xf
    s_nop 1
    v_add_f32_dpp v172, v172, v172 quad_perm:[2,3,0,1] row_mask:0xf bank_mask:0xf
    s_nop 1
    v_add_f32_dpp v172, v172, v172 row_half_mirror row_mask:0xf bank_mask:0xf
    s_nop 1
    v_add_f32_dpp v172, v172, v172 row_mirror row_mask:0xf bank_mask:0xf
    v_mov_b32 v173, v172
    s_nop 1
    v_permlane16_swap_b32 v172, v173
    v_add_f32 v172, v172, v173
    v_mov_b32 v173, v172
    s_nop 1
    v_permlane32_swap_b32 v172, v173
    v_add_f32 v172, v172, v173
    v_mul_f32 v172, 0xbfb8aa3b, v172
    v_exp_f32 v172, v172
    s_nop 0
    v_add_f32 v172, 1.0, v172
    v_rcp_f32 v172, v172
    v_lshlrev_b32 v173, 23, v160
    s_nop 0
    buffer_store_dword v172, v173, s[76:79], s87 offen sc1
    s_waitcnt vmcnt(2)
    v_cmp_le_u32 vcc, 1, v161
    s_nop 1
    s_cmp_eq_u64 vcc, -1
    s_cbranch_scc1 K1_IN1_OK
    s_mov_b32 s99, 0x10000
K1_IN1_SPIN:
    s_sleep 2
    v_lshrrev_b32 v166, 2, v160
    buffer_load_dword v161, v166, s[52:55], 0 offen sc1
    s_waitcnt vmcnt(0)
    v_cmp_le_u32 vcc, 1, v161
    s_nop 1
    s_cmp_eq_u64 vcc, -1
    s_cbranch_scc1 K1_IN1_OK
    s_sub_u32 s99, s99, 1
    s_cmp_lg_u32 s99, 0
    s_cbranch_scc1 K1_IN1_SPIN
K1_IN1_OK:
    v_mov_b32 v166, 0x10084
    v_mov_b32 v167, 1
    s_mov_b64 exec, 1
    ds_add_rtn_u32 v168, v166, v167
    v_mov_b32 v166, 0
    s_waitcnt lgkmcnt(0)
    v_readfirstlane_b32 s86, v168
    s_nop 1
    s_cmp_lg_u32 s86, 7
    s_cbranch_scc1 K1_HS11
    buffer_atomic_add v167, v166, s[76:79], s68 offen sc1
K1_HS11:
    s_mov_b64 exec, -1
    v_pk_mul_f32 v[162:163], v[40:41], v[40:41]
    v_pk_mul_f32 v[166:167], v[44:45], v[44:45]
    v_pk_mul_f32 v[164:165], v[42:43], v[42:43]
    v_pk_mul_f32 v[168:169], v[46:47], v[46:47]
    v_pk_fma_f32 v[162:163], v[162:163], s[90:91], v[178:179]
    v_pk_fma_f32 v[166:167], v[166:167], s[90:91], v[178:179]
    v_pk_fma_f32 v[164:165], v[164:165], s[90:91], v[178:179]
    v_pk_fma_f32 v[168:169], v[168:169], s[90:91], v[178:179]
    v_pk_mul_f32 v[162:163], v[162:163], v[40:41]
    v_pk_mul_f32 v[166:167], v[166:167], v[44:45]
    v_pk_mul_f32 v[164:165], v[164:165], v[42:43]
    v_pk_mul_f32 v[168:169], v[168:169], v[46:47]
    v_exp_f32 v162, v162
    v_exp_f32 v166, v166
    v_exp_f32 v163, v163
    v_exp_f32 v167, v167
    v_exp_f32 v164, v164
    v_exp_f32 v168, v168
    v_exp_f32 v165, v165
    v_exp_f32 v169, v169
    v_pk_mul_f32 v[88:89], v[88:89], v[40:41]
    v_pk_mul_f32 v[92:93], v[92:93], v[44:45]
    v_pk_mul_f32 v[90:91], v[90:91], v[42:43]
    v_pk_mul_f32 v[94:95], v[94:95], v[46:47]
    v_pk_add_f32 v[162:163], v[162:163], s[92:93]
    v_pk_add_f32 v[166:167], v[166:167], s[92:93]
    v_pk_add_f32 v[164:165], v[164:165], s[92:93]
    v_pk_add_f32 v[168:169], v[168:169], s[92:93]
    v_rcp_f32 v162, v162
    v_rcp_f32 v166, v166
    v_rcp_f32 v163, v163
    v_rcp_f32 v167, v167
    v_rcp_f32 v164, v164
    v_rcp_f32 v168, v168
    v_rcp_f32 v165, v165
    v_rcp_f32 v169, v169
    v_pk_mul_f32 v[88:89], v[88:89], v[162:163]
    v_pk_mul_f32 v[92:93], v[92:93], v[166:167]
    v_pk_mul_f32 v[90:91], v[90:91], v[164:165]
    v_pk_mul_f32 v[94:95], v[94:95], v[168:169]
    v_cvt_pk_bf16_f32 v40, v88, v89
    v_cvt_pk_bf16_f32 v42, v92, v93
    v_cvt_pk_bf16_f32 v41, v90, v91
    v_cvt_pk_bf16_f32 v43, v94, v95
    buffer_store_dwordx4 v[40:43], v160, s[76:79], s85 offen offset:1024 sc1
    v_cvt_pk_bf16_f32 v128, v128, v129
    v_cvt_pk_bf16_f32 v129, v130, v131
    ds_write_b64 v170, v[128:129] offset:0
    v_cvt_pk_bf16_f32 v144, v144, v145
    v_cvt_pk_bf16_f32 v145, v146, v147
    ds_write_b64 v170, v[144:145] offset:32
    v_cvt_pk_bf16_f32 v132, v132, v133
    v_cvt_pk_bf16_f32 v133, v134, v135
    ds_write_b64 v170, v[132:133] offset:1536
    v_cvt_pk_bf16_f32 v148, v148, v149
    v_cvt_pk_bf16_f32 v149, v150, v151
    ds_write_b64 v170, v[148:149] offset:1568
    v_cvt_pk_bf16_f32 v136, v136, v137
    v_cvt_pk_bf16_f32 v137, v138, v139
    ds_write_b64 v170, v[136:137] offset:3072
    v_cvt_pk_bf16_f32 v152, v152, v153
    v_cvt_pk_bf16_f32 v153, v154, v155
    ds_write_b64 v170, v[152:153] offset:3104
    v_cvt_pk_bf16_f32 v140, v140, v141
    v_cvt_pk_bf16_f32 v141, v142, v143
    ds_write_b64 v170, v[140:141] offset:4608
    v_cvt_pk_bf16_f32 v156, v156, v157
    v_cvt_pk_bf16_f32 v157, v158, v159
    ds_write_b64 v170, v[156:157] offset:4640
    v_cvt_pk_bf16_f32 v96, v96, v97
    v_cvt_pk_bf16_f32 v100, v100, v101
    v_cvt_pk_bf16_f32 v104, v104, v105
    v_cvt_pk_bf16_f32 v108, v108, v109
    v_cvt_pk_bf16_f32 v97, v98, v99
    v_cvt_pk_bf16_f32 v101, v102, v103
    v_cvt_pk_bf16_f32 v105, v106, v107
    v_cvt_pk_bf16_f32 v109, v110, v111
    v_cvt_pk_bf16_f32 v98, v112, v113
    v_cvt_pk_bf16_f32 v102, v116, v117
    v_cvt_pk_bf16_f32 v106, v120, v121
    v_cvt_pk_bf16_f32 v110, v124, v125
    v_cvt_pk_bf16_f32 v99, v114, v115
    v_cvt_pk_bf16_f32 v103, v118, v119
    v_cvt_pk_bf16_f32 v107, v122, v123
    v_cvt_pk_bf16_f32 v111, v126, v127
    v_mfma_f32_16x16x32_bf16 v[128:131], a[32:35], v[96:99], 0
    v_mfma_f32_16x16x32_bf16 v[132:135], a[32:35], v[100:103], 0
    v_mfma_f32_16x16x32_bf16 v[136:139], a[32:35], v[104:107], 0
    v_mfma_f32_16x16x32_bf16 v[140:143], a[32:35], v[108:111], 0
    v_mfma_f32_16x16x32_bf16 v[144:147], a[36:39], v[96:99], 0
    v_mfma_f32_16x16x32_bf16 v[148:151], a[36:39], v[100:103], 0
    v_mfma_f32_16x16x32_bf16 v[152:155], a[36:39], v[104:107], 0
    v_mfma_f32_16x16x32_bf16 v[156:159], a[36:39], v[108:111], 0
    s_nop 0
    v_max3_f32 v162, v128, v129, v130
    v_max3_f32 v174, v132, v133, v134
    v_max3_f32 v163, -v128, -v129, -v130
    v_max3_f32 v175, -v132, -v133, -v134
    v_max3_f32 v164, v131, v144, v145
    v_max3_f32 v176, v135, v148, v149
    v_max3_f32 v165, -v131, -v144, -v145
    v_max3_f32 v177, -v135, -v148, -v149
    v_max3_f32 v162, v146, v147, v162
    v_max3_f32 v174, v150, v151, v174
    v_max3_f32 v163, -v146, -v147, v163
    v_max3_f32 v175, -v150, -v151, v175
    v_max_f32 v162, v162, v164
    v_max_f32 v174, v174, v176
    v_max_f32 v163, v163, v165
    v_max_f32 v175, v175, v177
    s_nop 0
    v_permlane16_swap_b32 v162, v163
    v_permlane16_swap_b32 v174, v175
    v_max_f32 v162, v162, v163
    v_max_f32 v174, v174, v175
    v_mov_b32 v164, v162
    v_mov_b32 v176, v174
    s_nop 0
    v_permlane32_swap_b32 v162, v164
    v_permlane32_swap_b32 v174, v176
    v_max_f32 v162, v162, v164
    v_max_f32 v174, v174, v176
    v_mov_b32 v163, v162
    v_mov_b32 v175, v174
    s_nop 0
    v_permlane16_swap_b32 v162, v163
    v_permlane16_swap_b32 v174, v175
    v_mul_f32 v164, s96, v163
    v_mul_f32 v176, s96, v175
    v_mul_f32 v165, s96, v163
    v_mul_f32 v177, s96, v175
    v_mul_f32 v163, s96, v162
    v_mul_f32 v175, s96, v174
    v_mul_f32 v162, s96, v162
    v_mul_f32 v174, s96, v174
    v_pk_fma_f32 v[96:97], v[128:129], s[96:97], v[164:165]
    v_pk_fma_f32 v[100:101], v[132:133], s[96:97], v[176:177]
    v_pk_fma_f32 v[98:99], v[130:131], s[96:97], v[164:165]
    v_pk_fma_f32 v[102:103], v[134:135], s[96:97], v[176:177]
    v_pk_fma_f32 v[112:113], v[144:145], s[96:97], v[164:165]
    v_pk_fma_f32 v[116:117], v[148:149], s[96:97], v[176:177]
    v_pk_fma_f32 v[114:115], v[146:147], s[96:97], v[164:165]
    v_pk_fma_f32 v[118:119], v[150:151], s[96:97], v[176:177]
    v_pk_fma_f32 v[128:129], v[128:129], s[94:95], v[162:163]
    v_pk_fma_f32 v[132:133], v[132:133], s[94:95], v[174:175]
    v_pk_fma_f32 v[130:131], v[130:131], s[94:95], v[162:163]
    v_pk_fma_f32 v[134:135], v[134:135], s[94:95], v[174:175]
    v_pk_fma_f32 v[144:145], v[144:145], s[94:95], v[162:163]
    v_pk_fma_f32 v[148:149], v[148:149], s[94:95], v[174:175]
    v_pk_fma_f32 v[146:147], v[146:147], s[94:95], v[162:163]
    v_pk_fma_f32 v[150:151], v[150:151], s[94:95], v[174:175]
    v_exp_f32 v96, v96
    v_exp_f32 v100, v100
    v_exp_f32 v97, v97
    v_exp_f32 v101, v101
    v_exp_f32 v98, v98
    v_exp_f32 v102, v102
    v_exp_f32 v99, v99
    v_exp_f32 v103, v103
    v_exp_f32 v112, v112
    v_exp_f32 v116, v116
    v_exp_f32 v113, v113
    v_exp_f32 v117, v117
    v_exp_f32 v114, v114
    v_exp_f32 v118, v118
    v_exp_f32 v115, v115
    v_exp_f32 v119, v119
    v_exp_f32 v128, v128
    v_exp_f32 v132, v132
    v_exp_f32 v129, v129
    v_exp_f32 v133, v133
    v_exp_f32 v130, v130
    v_exp_f32 v134, v134
    v_exp_f32 v131, v131
    v_exp_f32 v135, v135
    v_exp_f32 v144, v144
    v_exp_f32 v148, v148
    v_exp_f32 v145, v145
    v_exp_f32 v149, v149
    v_exp_f32 v146, v146
    v_exp_f32 v150, v150
    v_exp_f32 v147, v147
    v_exp_f32 v151, v151
    v_pk_add_f32 v[164:165], v[96:97], v[98:99]
    v_pk_add_f32 v[176:177], v[100:101], v[102:103]
    v_pk_add_f32 v[162:163], v[128:129], v[130:131]
    v_pk_add_f32 v[174:175], v[132:133], v[134:135]
    v_pk_add_f32 v[164:165], v[164:165], v[112:113]
    v_pk_add_f32 v[176:177], v[176:177], v[116:117]
    v_pk_add_f32 v[162:163], v[162:163], v[144:145]
    v_pk_add_f32 v[174:175], v[174:175], v[148:149]
    v_pk_add_f32 v[164:165], v[164:165], v[114:115]
    v_pk_add_f32 v[176:177], v[176:177], v[118:119]
    v_pk_add_f32 v[162:163], v[162:163], v[146:147]
    v_pk_add_f32 v[174:175], v[174:175], v[150:151]
    v_add_f32 v162, v162, v163
    v_add_f32 v174, v174, v175
    v_add_f32 v163, v164, v165
    v_add_f32 v175, v176, v177
    s_nop 0
    v_permlane16_swap_b32 v162, v163
    v_permlane16_swap_b32 v174, v175
    v_add_f32 v162, v162, v163
    v_add_f32 v174, v174, v175
    v_mov_b32 v164, v162
    v_mov_b32 v176, v174
    s_nop 0
    v_permlane32_swap_b32 v162, v164
    v_permlane32_swap_b32 v174, v176
    v_add_f32 v162, v162, v164
    v_add_f32 v174, v174, v176
    v_mov_b32 v163, v162
    v_mov_b32 v175, v174
    s_nop 0
    v_permlane16_swap_b32 v162, v163
    v_permlane16_swap_b32 v174, v175
    v_rcp_f32 v162, v162
    v_rcp_f32 v174, v174
    v_rcp_f32 v164, v163
    v_rcp_f32 v176, v175
    v_mov_b32 v163, v162
    v_mov_b32 v175, v174
    v_mov_b32 v165, v164
    v_mov_b32 v177, v176
    v_pk_mul_f32 v[128:129], v[128:129], v[162:163]
    v_pk_mul_f32 v[132:133], v[132:133], v[174:175]
    v_pk_mul_f32 v[130:131], v[130:131], v[162:163]
    v_pk_mul_f32 v[134:135], v[134:135], v[174:175]
    v_pk_mul_f32 v[144:145], v[144:145], v[162:163]
    v_pk_mul_f32 v[148:149], v[148:149], v[174:175]
    v_pk_mul_f32 v[146:147], v[146:147], v[162:163]
    v_pk_mul_f32 v[150:151], v[150:151], v[174:175]
    v_pk_mul_f32 v[96:97], v[96:97], v[164:165]
    v_pk_mul_f32 v[100:101], v[100:101], v[176:177]
    v_pk_mul_f32 v[98:99], v[98:99], v[164:165]
    v_pk_mul_f32 v[102:103], v[102:103], v[176:177]
    v_pk_mul_f32 v[112:113], v[112:113], v[164:165]
    v_pk_mul_f32 v[116:117], v[116:117], v[176:177]
    v_pk_mul_f32 v[114:115], v[114:115], v[164:165]
    v_pk_mul_f32 v[118:119], v[118:119], v[176:177]
    v_cvt_pk_bf16_f32 v128, v128, v129
    v_cvt_pk_bf16_f32 v132, v132, v133
    v_cvt_pk_bf16_f32 v129, v130, v131
    v_cvt_pk_bf16_f32 v133, v134, v135
    v_cvt_pk_bf16_f32 v130, v144, v145
    v_cvt_pk_bf16_f32 v134, v148, v149
    v_cvt_pk_bf16_f32 v131, v146, v147
    v_cvt_pk_bf16_f32 v135, v150, v151
    v_cvt_pk_bf16_f32 v96, v96, v97
    v_cvt_pk_bf16_f32 v100, v100, v101
    v_cvt_pk_bf16_f32 v97, v98, v99
    v_cvt_pk_bf16_f32 v101, v102, v103
    v_cvt_pk_bf16_f32 v98, v112, v113
    v_cvt_pk_bf16_f32 v102, v116, v117
    v_cvt_pk_bf16_f32 v99, v114, v115
    v_cvt_pk_bf16_f32 v103, v118, v119
    ds_write_b64 v171, v[128:129] offset:0
    ds_write_b64 v171, v[132:133] offset:2560
    ds_write_b64 v171, v[130:131] offset:32
    ds_write_b64 v171, v[134:135] offset:2592
    ds_write_b64 v171, v[96:97] offset:64
    ds_write_b64 v171, v[100:101] offset:2624
    ds_write_b64 v171, v[98:99] offset:96
    ds_write_b64 v171, v[102:103] offset:2656
    v_mov_b32 v173, 0
    buffer_load_dword v161, v173, s[76:79], s67 offen sc1
    v_max3_f32 v162, v136, v137, v138
    v_max3_f32 v174, v140, v141, v142
    v_max3_f32 v163, -v136, -v137, -v138
    v_max3_f32 v175, -v140, -v141, -v142
    v_max3_f32 v164, v139, v152, v153
    v_max3_f32 v176, v143, v156, v157
    v_max3_f32 v165, -v139, -v152, -v153
    v_max3_f32 v177, -v143, -v156, -v157
    v_max3_f32 v162, v154, v155, v162
    v_max3_f32 v174, v158, v159, v174
    v_max3_f32 v163, -v154, -v155, v163
    v_max3_f32 v175, -v158, -v159, v175
    v_max_f32 v162, v162, v164
    v_max_f32 v174, v174, v176
    v_max_f32 v163, v163, v165
    v_max_f32 v175, v175, v177
    s_nop 0
    v_permlane16_swap_b32 v162, v163
    v_permlane16_swap_b32 v174, v175
    v_max_f32 v162, v162, v163
    v_max_f32 v174, v174, v175
    v_mov_b32 v164, v162
    v_mov_b32 v176, v174
    s_nop 0
    v_permlane32_swap_b32 v162, v164
    v_permlane32_swap_b32 v174, v176
    v_max_f32 v162, v162, v164
    v_max_f32 v174, v174, v176
    v_mov_b32 v163, v162
    v_mov_b32 v175, v174
    s_nop 0
    v_permlane16_swap_b32 v162, v163
    v_permlane16_swap_b32 v174, v175
    v_mul_f32 v164, s96, v163
    v_mul_f32 v176, s96, v175
    v_mul_f32 v165, s96, v163
    v_mul_f32 v177, s96, v175
    v_mul_f32 v163, s96, v162
    v_mul_f32 v175, s96, v174
    v_mul_f32 v162, s96, v162
    v_mul_f32 v174, s96, v174
    v_pk_fma_f32 v[104:105], v[136:137], s[96:97], v[164:165]
    v_pk_fma_f32 v[108:109], v[140:141], s[96:97], v[176:177]
    v_pk_fma_f32 v[106:107], v[138:139], s[96:97], v[164:165]
    v_pk_fma_f32 v[110:111], v[142:143], s[96:97], v[176:177]
    v_pk_fma_f32 v[120:121], v[152:153], s[96:97], v[164:165]
    v_pk_fma_f32 v[124:125], v[156:157], s[96:97], v[176:177]
    v_pk_fma_f32 v[122:123], v[154:155], s[96:97], v[164:165]
    v_pk_fma_f32 v[126:127], v[158:159], s[96:97], v[176:177]
    v_pk_fma_f32 v[136:137], v[136:137], s[94:95], v[162:163]
    v_pk_fma_f32 v[140:141], v[140:141], s[94:95], v[174:175]
    v_pk_fma_f32 v[138:139], v[138:139], s[94:95], v[162:163]
    v_pk_fma_f32 v[142:143], v[142:143], s[94:95], v[174:175]
    v_pk_fma_f32 v[152:153], v[152:153], s[94:95], v[162:163]
    v_pk_fma_f32 v[156:157], v[156:157], s[94:95], v[174:175]
    v_pk_fma_f32 v[154:155], v[154:155], s[94:95], v[162:163]
    v_pk_fma_f32 v[158:159], v[158:159], s[94:95], v[174:175]
    v_exp_f32 v104, v104
    v_exp_f32 v108, v108
    v_exp_f32 v105, v105
    v_exp_f32 v109, v109
    v_exp_f32 v106, v106
    v_exp_f32 v110, v110
    v_exp_f32 v107, v107
    v_exp_f32 v111, v111
    v_exp_f32 v120, v120
    v_exp_f32 v124, v124
    v_exp_f32 v121, v121
    v_exp_f32 v125, v125
    v_exp_f32 v122, v122
    v_exp_f32 v126, v126
    v_exp_f32 v123, v123
    v_exp_f32 v127, v127
    v_exp_f32 v136, v136
    v_exp_f32 v140, v140
    v_exp_f32 v137, v137
    v_exp_f32 v141, v141
    v_exp_f32 v138, v138
    v_exp_f32 v142, v142
    v_exp_f32 v139, v139
    v_exp_f32 v143, v143
    v_exp_f32 v152, v152
    v_exp_f32 v156, v156
    v_exp_f32 v153, v153
    v_exp_f32 v157, v157
    v_exp_f32 v154, v154
    v_exp_f32 v158, v158
    v_exp_f32 v155, v155
    v_exp_f32 v159, v159
    v_pk_add_f32 v[164:165], v[104:105], v[106:107]
    v_pk_add_f32 v[176:177], v[108:109], v[110:111]
    v_pk_add_f32 v[162:163], v[136:137], v[138:139]
    v_pk_add_f32 v[174:175], v[140:141], v[142:143]
    v_pk_add_f32 v[164:165], v[164:165], v[120:121]
    v_pk_add_f32 v[176:177], v[176:177], v[124:125]
    v_pk_add_f32 v[162:163], v[162:163], v[152:153]
    v_pk_add_f32 v[174:175], v[174:175], v[156:157]
    v_pk_add_f32 v[164:165], v[164:165], v[122:123]
    v_pk_add_f32 v[176:177], v[176:177], v[126:127]
    v_pk_add_f32 v[162:163], v[162:163], v[154:155]
    v_pk_add_f32 v[174:175], v[174:175], v[158:159]
    v_add_f32 v162, v162, v163
    v_add_f32 v174, v174, v175
    v_add_f32 v163, v164, v165
    v_add_f32 v175, v176, v177
    s_nop 0
    v_permlane16_swap_b32 v162, v163
    v_permlane16_swap_b32 v174, v175
    v_add_f32 v162, v162, v163
    v_add_f32 v174, v174, v175
    v_mov_b32 v164, v162
    v_mov_b32 v176, v174
    s_nop 0
    v_permlane32_swap_b32 v162, v164
    v_permlane32_swap_b32 v174, v176
    v_add_f32 v162, v162, v164
    v_add_f32 v174, v174, v176
    v_mov_b32 v163, v162
    v_mov_b32 v175, v174
    s_nop 0
    v_permlane16_swap_b32 v162, v163
    v_permlane16_swap_b32 v174, v175
    v_rcp_f32 v162, v162
    v_rcp_f32 v174, v174
    v_rcp_f32 v164, v163
    v_rcp_f32 v176, v175
    v_mov_b32 v163, v162
    v_mov_b32 v175, v174
    v_mov_b32 v165, v164
    v_mov_b32 v177, v176
    v_pk_mul_f32 v[136:137], v[136:137], v[162:163]
    v_pk_mul_f32 v[140:141], v[140:141], v[174:175]
    v_pk_mul_f32 v[138:139], v[138:139], v[162:163]
    v_pk_mul_f32 v[142:143], v[142:143], v[174:175]
    v_pk_mul_f32 v[152:153], v[152:153], v[162:163]
    v_pk_mul_f32 v[156:157], v[156:157], v[174:175]
    v_pk_mul_f32 v[154:155], v[154:155], v[162:163]
    v_pk_mul_f32 v[158:159], v[158:159], v[174:175]
    v_pk_mul_f32 v[104:105], v[104:105], v[164:165]
    v_pk_mul_f32 v[108:109], v[108:109], v[176:177]
    v_pk_mul_f32 v[106:107], v[106:107], v[164:165]
    v_pk_mul_f32 v[110:111], v[110:111], v[176:177]
    v_pk_mul_f32 v[120:121], v[120:121], v[164:165]
    v_pk_mul_f32 v[124:125], v[124:125], v[176:177]
    v_pk_mul_f32 v[122:123], v[122:123], v[164:165]
    v_pk_mul_f32 v[126:127], v[126:127], v[176:177]
    v_cvt_pk_bf16_f32 v136, v136, v137
    v_cvt_pk_bf16_f32 v140, v140, v141
    v_cvt_pk_bf16_f32 v137, v138, v139
    v_cvt_pk_bf16_f32 v141, v142, v143
    v_cvt_pk_bf16_f32 v138, v152, v153
    v_cvt_pk_bf16_f32 v142, v156, v157
    v_cvt_pk_bf16_f32 v139, v154, v155
    v_cvt_pk_bf16_f32 v143, v158, v159
    v_cvt_pk_bf16_f32 v104, v104, v105
    v_cvt_pk_bf16_f32 v108, v108, v109
    v_cvt_pk_bf16_f32 v105, v106, v107
    v_cvt_pk_bf16_f32 v109, v110, v111
    v_cvt_pk_bf16_f32 v106, v120, v121
    v_cvt_pk_bf16_f32 v110, v124, v125
    v_cvt_pk_bf16_f32 v107, v122, v123
    v_cvt_pk_bf16_f32 v111, v126, v127
    ds_write_b64 v171, v[136:137] offset:5120
    ds_write_b64 v171, v[140:141] offset:7680
    ds_write_b64 v171, v[138:139] offset:5152
    ds_write_b64 v171, v[142:143] offset:7712
    ds_write_b64 v171, v[104:105] offset:5184
    ds_write_b64 v171, v[108:109] offset:7744
    ds_write_b64 v171, v[106:107] offset:5216
    ds_write_b64 v171, v[110:111] offset:7776
    v_mul_u32_u24 v130, 160, v182
    v_lshl_add_u32 v130, v183, 3, v130
    s_and_b32 s86, s32, 1
    s_lshl_b32 s86, s86, 6
    s_add_u32 s86, s86, 0x10000
    v_add_u32 v130, s86, v130
    v_mul_u32_u24 v131, 96, v182
    v_lshl_add_u32 v131, v183, 3, v131
    s_lshr_b32 s86, s32, 1
    s_lshl_b32 s86, s86, 5
    s_add_u32 s86, s86, 0x1a000
    v_add_u32 v131, s86, v131
    v_mov_b32 v173, 0
    s_waitcnt vmcnt(0)
    v_readfirstlane_b32 s98, v161
    s_nop 1
    s_cmp_ge_u32 s98, 8
    s_cselect_b32 s89, 1, 0
    s_cbranch_scc0 K1_NA1
    s_add_u32 s24, s59, 0x0
    buffer_load_dwordx4 a[0:3], v160, s[76:79], s24 offen offset:0 sc1
    buffer_load_dwordx4 a[4:7], v160, s[76:79], s24 offen offset:1024 sc1
    s_add_u32 s24, s59, 0x20000
    buffer_load_dwordx4 a[8:11], v160, s[76:79], s24 offen offset:0 sc1
    buffer_load_dwordx4 a[12:15], v160, s[76:79], s24 offen offset:1024 sc1
    s_add_u32 s24, s59, 0xa0000
    buffer_load_dwordx4 a[16:19], v160, s[76:79], s24 offen offset:0 sc1
    buffer_load_dwordx4 a[20:23], v160, s[76:79], s24 offen offset:1024 sc1
    s_add_u32 s24, s59, 0xc0000
    buffer_load_dwordx4 a[24:27], v160, s[76:79], s24 offen offset:0 sc1
    buffer_load_dwordx4 a[28:31], v160, s[76:79], s24 offen offset:1024 sc1
    s_branch K1_NB1
K1_NA1:
    buffer_load_dword v175, v173, s[76:79], s67 offen sc1
K1_NB1:
    s_waitcnt lgkmcnt(0)
    s_barrier
    ds_read_b64_tr_b16 v[64:65], v131 offset:0
    ds_read_b64_tr_b16 v[0:1], v130 offset:0
    ds_read_b64_tr_b16 v[32:33], v130 offset:32
    ds_read_b64_tr_b16 v[66:67], v131 offset:1536
    ds_read_b64_tr_b16 v[2:3], v130 offset:2560
    ds_read_b64_tr_b16 v[34:35], v130 offset:2592
    ds_read_b64_tr_b16 v[68:69], v131 offset:3072
    ds_read_b64_tr_b16 v[4:5], v130 offset:5120
    ds_read_b64_tr_b16 v[36:37], v130 offset:5152
    ds_read_b64_tr_b16 v[70:71], v131 offset:4608
    ds_read_b64_tr_b16 v[6:7], v130 offset:7680
    ds_read_b64_tr_b16 v[38:39], v130 offset:7712
    ds_read_b64_tr_b16 v[72:73], v131 offset:6144
    ds_read_b64_tr_b16 v[8:9], v130 offset:10240
    ds_read_b64_tr_b16 v[40:41], v130 offset:10272
    ds_read_b64_tr_b16 v[74:75], v131 offset:7680
    ds_read_b64_tr_b16 v[10:11], v130 offset:12800
    ds_read_b64_tr_b16 v[42:43], v130 offset:12832
    ds_read_b64_tr_b16 v[76:77], v131 offset:9216
    ds_read_b64_tr_b16 v[12:13], v130 offset:15360
    ds_read_b64_tr_b16 v[44:45], v130 offset:15392
    ds_read_b64_tr_b16 v[78:79], v131 offset:10752
    ds_read_b64_tr_b16 v[14:15], v130 offset:17920
    ds_read_b64_tr_b16 v[46:47], v130 offset:17952
    ds_read_b64_tr_b16 v[80:81], v131 offset:12288
    ds_read_b64_tr_b16 v[16:17], v130 offset:20480
    ds_read_b64_tr_b16 v[48:49], v130 offset:20512
    ds_read_b64_tr_b16 v[82:83], v131 offset:13824
    ds_read_b64_tr_b16 v[18:19], v130 offset:23040
    ds_read_b64_tr_b16 v[50:51], v130 offset:23072
    ds_read_b64_tr_b16 v[84:85], v131 offset:15360
    ds_read_b64_tr_b16 v[20:21], v130 offset:25600
    ds_read_b64_tr_b16 v[52:53], v130 offset:25632
    ds_read_b64_tr_b16 v[86:87], v131 offset:16896
    ds_read_b64_tr_b16 v[22:23], v130 offset:28160
    ds_read_b64_tr_b16 v[54:55], v130 offset:28192
    ds_read_b64_tr_b16 v[88:89], v131 offset:18432
    ds_read_b64_tr_b16 v[24:25], v130 offset:30720
    ds_read_b64_tr_b16 v[56:57], v130 offset:30752
    ds_read_b64_tr_b16 v[90:91], v131 offset:19968
    ds_read_b64_tr_b16 v[26:27], v130 offset:33280
    ds_read_b64_tr_b16 v[58:59], v130 offset:33312
    ds_read_b64_tr_b16 v[92:93], v131 offset:21504
    ds_read_b64_tr_b16 v[28:29], v130 offset:35840
    ds_read_b64_tr_b16 v[60:61], v130 offset:35872
    ds_read_b64_tr_b16 v[94:95], v131 offset:23040
    ds_read_b64_tr_b16 v[30:31], v130 offset:38400
    ds_read_b64_tr_b16 v[62:63], v130 offset:38432
    v_lshrrev_b32 v110, 4, v160
    v_lshrrev_b32 v112, 4, v110
    v_bfe_u32 v113, v110, 1, 3
    v_xor_b32 v113, v113, v112
    v_lshlrev_b32 v113, 5, v113
    v_and_b32 v114, 1, v110
    v_lshl_add_u32 v113, v114, 4, v113
    v_lshl_add_u32 v113, v112, 11, v113
    s_lshl_b32 s86, s57, 8
    v_add_u32 v161, s86, v113
    v_xor_b32 v162, 128, v161
    v_add_u32 v162, 0x2000, v162
    v_lshrrev_b32 v111, 4, v110
    v_bfe_u32 v112, v110, 2, 2
    v_lshl_add_u32 v112, v111, 2, v112
    v_and_b32 v113, 7, v112
    v_lshlrev_b32 v112, 8, v112
    v_lshl_add_u32 v112, v113, 5, v112
    v_and_b32 v113, 3, v110
    v_lshl_add_u32 v163, v113, 3, v112
    s_lshl_b32 s86, s56, 6
    v_xor_b32 v163, s86, v163
    v_xor_b32 v164, 32, v163
    v_xor_b32 v165, 64, v163
    v_xor_b32 v166, 96, v163
    v_xor_b32 v167, 128, v163
    v_xor_b32 v168, 160, v163
    v_xor_b32 v169, 192, v163
    v_xor_b32 v170, 224, v163
    v_mov_b32 v173, 0
    v_mov_b32 v174, 1
    s_lshl_b32 s86, s30, 12
    s_add_u32 s86, s86, 0x20000
    v_add_u32 v177, s86, v160
    v_add_u32 v178, 0x1a000, v160
    v_lshrrev_b32 v112, 5, v110
    v_and_b32 v113, 0x1f0, v160
    v_lshl_add_u32 v180, v112, 3, v113
    v_and_b32 v113, 0xf0, v160
    v_lshl_add_u32 v181, v111, 12, v113
    s_lshl_b32 s86, s30, 9
    s_add_u32 s86, s86, 0x1a000
    v_add_u32 v180, s86, v180
    v_and_b32 v112, 7, v110
    v_lshlrev_b32 v112, 7, v112
    v_lshl_add_u32 v182, v111, 4, v112
    v_and_b32 v112, 15, v110
    v_lshlrev_b32 v183, 2, v112
    s_waitcnt lgkmcnt(15)
    v_mfma_f32_16x16x32_bf16 v[96:99], v[0:3], v[64:67], 0
    v_mfma_f32_16x16x32_bf16 v[100:103], v[32:35], v[64:67], 0
    s_waitcnt lgkmcnt(15)
    v_mfma_f32_16x16x32_bf16 v[96:99], v[4:7], v[68:71], v[96:99]
    v_mfma_f32_16x16x32_bf16 v[100:103], v[36:39], v[68:71], v[100:103]
    s_waitcnt lgkmcnt(15)
    v_mfma_f32_16x16x32_bf16 v[96:99], v[8:11], v[72:75], v[96:99]
    v_mfma_f32_16x16x32_bf16 v[100:103], v[40:43], v[72:75], v[100:103]
    s_waitcnt lgkmcnt(15)
    v_mfma_f32_16x16x32_bf16 v[96:99], v[12:15], v[76:79], v[96:99]
    v_mfma_f32_16x16x32_bf16 v[100:103], v[44:47], v[76:79], v[100:103]
    s_waitcnt lgkmcnt(15)
    v_mfma_f32_16x16x32_bf16 v[96:99], v[16:19], v[80:83], v[96:99]
    v_mfma_f32_16x16x32_bf16 v[100:103], v[48:51], v[80:83], v[100:103]
    s_waitcnt lgkmcnt(12)
    v_mfma_f32_16x16x32_bf16 v[96:99], v[20:23], v[84:87], v[96:99]
    v_mfma_f32_16x16x32_bf16 v[100:103], v[52:55], v[84:87], v[100:103]
    s_waitcnt lgkmcnt(6)
    v_mfma_f32_16x16x32_bf16 v[96:99], v[24:27], v[88:91], v[96:99]
    v_mfma_f32_16x16x32_bf16 v[100:103], v[56:59], v[88:91], v[100:103]
    s_waitcnt lgkmcnt(0)
    v_mfma_f32_16x16x32_bf16 v[96:99], v[28:31], v[92:95], v[96:99]
    v_mfma_f32_16x16x32_bf16 v[100:103], v[60:63], v[92:95], v[100:103]
    s_nop 6
    v_cvt_pk_bf16_f32 v96, v96, v97
    v_cvt_pk_bf16_f32 v97, v98, v99
    v_cvt_pk_bf16_f32 v98, v100, v101
    v_cvt_pk_bf16_f32 v99, v102, v103
    s_cmp_eq_u32 s89, 1
    s_cbranch_scc1 K1_HA1
    s_waitcnt vmcnt(0)
    v_readfirstlane_b32 s98, v175
    s_nop 1
    s_cmp_ge_u32 s98, 8
    s_cbranch_scc1 K1_WH1_OK
    s_mov_b32 s99, 0x10000
K1_WH1_SPIN:
    s_sleep 2
    buffer_load_dword v175, v173, s[76:79], s67 offen sc1
    s_waitcnt vmcnt(0)
    v_readfirstlane_b32 s98, v175
    s_nop 1
    s_cmp_ge_u32 s98, 8
    s_cbranch_scc1 K1_WH1_OK
    s_sub_u32 s99, s99, 1
    s_cmp_lg_u32 s99, 0
    s_cbranch_scc1 K1_WH1_SPIN
K1_WH1_OK:
    s_add_u32 s24, s59, 0x0
    buffer_load_dwordx4 a[0:3], v160, s[76:79], s24 offen offset:0 sc1
    buffer_load_dwordx4 a[4:7], v160, s[76:79], s24 offen offset:1024 sc1
    s_add_u32 s24, s59, 0x20000
    buffer_load_dwordx4 a[8:11], v160, s[76:79], s24 offen offset:0 sc1
    buffer_load_dwordx4 a[12:15], v160, s[76:79], s24 offen offset:1024 sc1
    s_add_u32 s24, s59, 0xa0000
    buffer_load_dwordx4 a[16:19], v160, s[76:79], s24 offen offset:0 sc1
    buffer_load_dwordx4 a[20:23], v160, s[76:79], s24 offen offset:1024 sc1
    s_add_u32 s24, s59, 0xc0000
    buffer_load_dwordx4 a[24:27], v160, s[76:79], s24 offen offset:0 sc1
    buffer_load_dwordx4 a[28:31], v160, s[76:79], s24 offen offset:1024 sc1
K1_HA1:
    buffer_store_dwordx4 v[96:99], v160, s[76:79], s88 offen sc1
    s_nop 7
    s_nop 1
K3_START:
    s_cmp_lt_u32 s30, 4
    s_cbranch_scc1 K3_NP
    s_setprio 1
K3_NP:
    s_xor_b32 s87, s56, 1
    s_lshl_b32 s87, s87, 16
    s_add_u32 s87, s87, 0x0
    s_add_u32 s84, s87, s71
    s_xor_b32 s87, s56, 2
    s_lshl_b32 s87, s87, 16
    s_add_u32 s87, s87, 0x800
    s_add_u32 s85, s87, s71
    s_xor_b32 s87, s56, 3
    s_lshl_b32 s87, s87, 16
    s_add_u32 s87, s87, 0x1000
    s_add_u32 s86, s87, s71
    s_mov_b32 s90, 0x3f80
    s_mov_b32 s91, 0x3f800000
    s_lshl_b32 s87, s29, 2
    s_add_u32 s87, s87, s56
    s_lshl_b32 s87, s87, 7
    s_add_u32 s93, s87, 0x1e01400
    s_mov_b32 s92, 0x1e00000
    ds_read_b64_tr_b16 v[64:65], v163 offset:0
    ds_read_b64_tr_b16 v[66:67], v163 offset:4096
    ds_read_b64_tr_b16 v[68:69], v164 offset:0
    ds_read_b64_tr_b16 v[70:71], v164 offset:4096
    ds_read_b64_tr_b16 v[72:73], v165 offset:0
    ds_read_b64_tr_b16 v[74:75], v165 offset:4096
    ds_read_b64_tr_b16 v[76:77], v166 offset:0
    ds_read_b64_tr_b16 v[78:79], v166 offset:4096
    ds_read_b64_tr_b16 v[80:81], v167 offset:0
    ds_read_b64_tr_b16 v[82:83], v167 offset:4096
    ds_read_b64_tr_b16 v[84:85], v168 offset:0
    ds_read_b64_tr_b16 v[86:87], v168 offset:4096
    ds_read_b64_tr_b16 v[88:89], v169 offset:0
    ds_read_b64_tr_b16 v[90:91], v169 offset:4096
    ds_read_b64_tr_b16 v[92:93], v170 offset:0
    ds_read_b64_tr_b16 v[94:95], v170 offset:4096
    s_waitcnt vmcnt(7)
    s_waitcnt lgkmcnt(14)
    v_mfma_f32_16x16x32_bf16 v[0:3], v[64:67], a[0:3], 0
    s_add_u32 s24, s59, 0xe0000
    buffer_load_dwordx4 a[32:35], v160, s[76:79], s24 offen offset:0 sc1
    v_mfma_f32_16x16x32_bf16 v[32:35], v[64:67], a[4:7], 0
    s_waitcnt lgkmcnt(12)
    v_mfma_f32_16x16x32_bf16 v[4:7], v[68:71], a[0:3], 0
    ds_read_b64_tr_b16 v[96:97], v163 offset:8192
    buffer_load_dwordx4 a[36:39], v160, s[76:79], s24 offen offset:1024 sc1
    v_mfma_f32_16x16x32_bf16 v[36:39], v[68:71], a[4:7], 0
    ds_read_b64_tr_b16 v[98:99], v163 offset:12288
    s_waitcnt lgkmcnt(12)
    v_mfma_f32_16x16x32_bf16 v[8:11], v[72:75], a[0:3], 0
    ds_read_b64_tr_b16 v[100:101], v164 offset:8192
    v_mfma_f32_16x16x32_bf16 v[40:43], v[72:75], a[4:7], 0
    ds_read_b64_tr_b16 v[102:103], v164 offset:12288
    s_waitcnt lgkmcnt(12)
    v_mfma_f32_16x16x32_bf16 v[12:15], v[76:79], a[0:3], 0
    ds_read_b64_tr_b16 v[104:105], v165 offset:8192
    s_add_u32 s24, s59, 0x100000
    buffer_load_dwordx4 a[40:43], v160, s[76:79], s24 offen offset:0 sc1
    v_mfma_f32_16x16x32_bf16 v[44:47], v[76:79], a[4:7], 0
    ds_read_b64_tr_b16 v[106:107], v165 offset:12288
    s_waitcnt lgkmcnt(12)
    v_mfma_f32_16x16x32_bf16 v[16:19], v[80:83], a[0:3], 0
    ds_read_b64_tr_b16 v[108:109], v166 offset:8192
    v_mfma_f32_16x16x32_bf16 v[48:51], v[80:83], a[4:7], 0
    ds_read_b64_tr_b16 v[110:111], v166 offset:12288
    s_waitcnt lgkmcnt(12)
    v_mfma_f32_16x16x32_bf16 v[20:23], v[84:87], a[0:3], 0
    ds_read_b64_tr_b16 v[112:113], v167 offset:8192
    buffer_load_dwordx4 a[44:47], v160, s[76:79], s24 offen offset:1024 sc1
    v_mfma_f32_16x16x32_bf16 v[52:55], v[84:87], a[4:7], 0
    ds_read_b64_tr_b16 v[114:115], v167 offset:12288
    s_waitcnt lgkmcnt(12)
    v_mfma_f32_16x16x32_bf16 v[24:27], v[88:91], a[0:3], 0
    ds_read_b64_tr_b16 v[116:117], v168 offset:8192
    v_mfma_f32_16x16x32_bf16 v[56:59], v[88:91], a[4:7], 0
    ds_read_b64_tr_b16 v[118:119], v168 offset:12288
    s_waitcnt lgkmcnt(12)
    v_mfma_f32_16x16x32_bf16 v[28:31], v[92:95], a[0:3], 0
    ds_read_b64_tr_b16 v[120:121], v169 offset:8192
    v_mfma_f32_16x16x32_bf16 v[60:63], v[92:95], a[4:7], 0
    ds_read_b64_tr_b16 v[122:123], v169 offset:12288
    s_waitcnt vmcnt(9)
    s_waitcnt lgkmcnt(12)
    v_mfma_f32_16x16x32_bf16 v[0:3], v[96:99], a[8:11], v[0:3]
    ds_read_b64_tr_b16 v[124:125], v170 offset:8192
    s_add_u32 s24, s59, 0x180000
    buffer_load_dwordx4 a[48:51], v160, s[76:79], s24 offen offset:0 sc1
    v_mfma_f32_16x16x32_bf16 v[32:35], v[96:99], a[12:15], v[32:35]
    ds_read_b64_tr_b16 v[126:127], v170 offset:12288
    s_waitcnt lgkmcnt(12)
    v_mfma_f32_16x16x32_bf16 v[4:7], v[100:103], a[8:11], v[4:7]
    buffer_load_dwordx4 a[52:55], v160, s[76:79], s24 offen offset:1024 sc1
    v_mfma_f32_16x16x32_bf16 v[36:39], v[100:103], a[12:15], v[36:39]
    s_waitcnt lgkmcnt(0)
    s_barrier
    v_mfma_f32_16x16x32_bf16 v[8:11], v[104:107], a[8:11], v[8:11]
    ds_read_b64_tr_b16 v[64:65], v163 offset:16384
    ds_read_b64_tr_b16 v[66:67], v163 offset:20480
    v_mfma_f32_16x16x32_bf16 v[40:43], v[104:107], a[12:15], v[40:43]
    ds_read_b64_tr_b16 v[68:69], v164 offset:16384
    ds_read_b64_tr_b16 v[70:71], v164 offset:20480
    v_mfma_f32_16x16x32_bf16 v[12:15], v[108:111], a[8:11], v[12:15]
    ds_read_b64_tr_b16 v[72:73], v165 offset:16384
    s_add_u32 s24, s59, 0x1a0000
    buffer_load_dwordx4 a[56:59], v160, s[76:79], s24 offen offset:0 sc1
    v_mfma_f32_16x16x32_bf16 v[44:47], v[108:111], a[12:15], v[44:47]
    ds_read_b64_tr_b16 v[74:75], v165 offset:20480
    v_mfma_f32_16x16x32_bf16 v[16:19], v[112:115], a[8:11], v[16:19]
    ds_read_b64_tr_b16 v[76:77], v166 offset:16384
    s_add_u32 s23, s62, 0x0
    s_add_u32 m0, s65, 0
    s_nop 0
    buffer_load_dwordx4 v161, s[40:43], s23 offen lds
    v_mfma_f32_16x16x32_bf16 v[48:51], v[112:115], a[12:15], v[48:51]
    ds_read_b64_tr_b16 v[78:79], v166 offset:20480
    v_mfma_f32_16x16x32_bf16 v[20:23], v[116:119], a[8:11], v[20:23]
    ds_read_b64_tr_b16 v[80:81], v167 offset:16384
    buffer_load_dwordx4 a[60:63], v160, s[76:79], s24 offen offset:1024 sc1
    v_mfma_f32_16x16x32_bf16 v[52:55], v[116:119], a[12:15], v[52:55]
    ds_read_b64_tr_b16 v[82:83], v167 offset:20480
    v_mfma_f32_16x16x32_bf16 v[24:27], v[120:123], a[8:11], v[24:27]
    ds_read_b64_tr_b16 v[84:85], v168 offset:16384
    s_add_u32 m0, s65, 1024
    s_nop 0
    buffer_load_dwordx4 v162, s[40:43], s23 offen lds
    v_mfma_f32_16x16x32_bf16 v[56:59], v[120:123], a[12:15], v[56:59]
    ds_read_b64_tr_b16 v[86:87], v168 offset:20480
    v_mfma_f32_16x16x32_bf16 v[28:31], v[124:127], a[8:11], v[28:31]
    ds_read_b64_tr_b16 v[88:89], v169 offset:16384
    v_mfma_f32_16x16x32_bf16 v[60:63], v[124:127], a[12:15], v[60:63]
    ds_read_b64_tr_b16 v[90:91], v169 offset:20480
    s_waitcnt vmcnt(13)
    s_waitcnt lgkmcnt(12)
    v_mfma_f32_16x16x32_bf16 v[0:3], v[64:67], a[16:19], v[0:3]
    ds_read_b64_tr_b16 v[92:93], v170 offset:16384
    s_add_u32 s24, s60, 0x0
    buffer_load_dwordx4 a[0:3], v160, s[76:79], s24 offen offset:0 sc1
    v_mfma_f32_16x16x32_bf16 v[32:35], v[64:67], a[20:23], v[32:35]
    ds_read_b64_tr_b16 v[94:95], v170 offset:20480
    s_waitcnt lgkmcnt(12)
    v_mfma_f32_16x16x32_bf16 v[4:7], v[68:71], a[16:19], v[4:7]
    ds_read_b64_tr_b16 v[96:97], v163 offset:24576
    buffer_load_dwordx4 a[4:7], v160, s[76:79], s24 offen offset:1024 sc1
    v_mfma_f32_16x16x32_bf16 v[36:39], v[68:71], a[20:23], v[36:39]
    ds_read_b64_tr_b16 v[98:99], v163 offset:28672
    s_waitcnt lgkmcnt(12)
    v_mfma_f32_16x16x32_bf16 v[8:11], v[72:75], a[16:19], v[8:11]
    ds_read_b64_tr_b16 v[100:101], v164 offset:24576
    v_mfma_f32_16x16x32_bf16 v[40:43], v[72:75], a[20:23], v[40:43]
    ds_read_b64_tr_b16 v[102:103], v164 offset:28672
    s_waitcnt lgkmcnt(12)
    v_mfma_f32_16x16x32_bf16 v[12:15], v[76:79], a[16:19], v[12:15]
    ds_read_b64_tr_b16 v[104:105], v165 offset:24576
    s_add_u32 s24, s60, 0x20000
    buffer_load_dwordx4 a[8:11], v160, s[76:79], s24 offen offset:0 sc1
    v_mfma_f32_16x16x32_bf16 v[44:47], v[76:79], a[20:23], v[44:47]
    ds_read_b64_tr_b16 v[106:107], v165 offset:28672
    s_waitcnt lgkmcnt(12)
    v_mfma_f32_16x16x32_bf16 v[16:19], v[80:83], a[16:19], v[16:19]
    ds_read_b64_tr_b16 v[108:109], v166 offset:24576
    v_mfma_f32_16x16x32_bf16 v[48:51], v[80:83], a[20:23], v[48:51]
    ds_read_b64_tr_b16 v[110:111], v166 offset:28672
    s_waitcnt lgkmcnt(12)
    v_mfma_f32_16x16x32_bf16 v[20:23], v[84:87], a[16:19], v[20:23]
    ds_read_b64_tr_b16 v[112:113], v167 offset:24576
    buffer_load_dwordx4 a[12:15], v160, s[76:79], s24 offen offset:1024 sc1
    v_mfma_f32_16x16x32_bf16 v[52:55], v[84:87], a[20:23], v[52:55]
    ds_read_b64_tr_b16 v[114:115], v167 offset:28672
    s_waitcnt lgkmcnt(12)
    v_mfma_f32_16x16x32_bf16 v[24:27], v[88:91], a[16:19], v[24:27]
    ds_read_b64_tr_b16 v[116:117], v168 offset:24576
    v_mfma_f32_16x16x32_bf16 v[56:59], v[88:91], a[20:23], v[56:59]
    ds_read_b64_tr_b16 v[118:119], v168 offset:28672
    s_waitcnt lgkmcnt(12)
    v_mfma_f32_16x16x32_bf16 v[28:31], v[92:95], a[16:19], v[28:31]
    ds_read_b64_tr_b16 v[120:121], v169 offset:24576
    v_mfma_f32_16x16x32_bf16 v[60:63], v[92:95], a[20:23], v[60:63]
    ds_read_b64_tr_b16 v[122:123], v169 offset:28672
    s_waitcnt vmcnt(15)
    s_waitcnt lgkmcnt(12)
    v_mfma_f32_16x16x32_bf16 v[0:3], v[96:99], a[24:27], v[0:3]
    ds_read_b64_tr_b16 v[124:125], v170 offset:24576
    s_add_u32 s24, s60, 0xa0000
    buffer_load_dwordx4 a[16:19], v160, s[76:79], s24 offen offset:0 sc1
    v_mfma_f32_16x16x32_bf16 v[32:35], v[96:99], a[28:31], v[32:35]
    ds_read_b64_tr_b16 v[126:127], v170 offset:28672
    s_waitcnt lgkmcnt(12)
    v_mfma_f32_16x16x32_bf16 v[4:7], v[100:103], a[24:27], v[4:7]
    buffer_load_dwordx4 a[20:23], v160, s[76:79], s24 offen offset:1024 sc1
    v_mfma_f32_16x16x32_bf16 v[36:39], v[100:103], a[28:31], v[36:39]
    s_waitcnt lgkmcnt(0)
    s_barrier
    v_mfma_f32_16x16x32_bf16 v[8:11], v[104:107], a[24:27], v[8:11]
    ds_read_b64_tr_b16 v[64:65], v163 offset:32768
    ds_read_b64_tr_b16 v[66:67], v163 offset:36864
    v_mfma_f32_16x16x32_bf16 v[40:43], v[104:107], a[28:31], v[40:43]
    ds_read_b64_tr_b16 v[68:69], v164 offset:32768
    ds_read_b64_tr_b16 v[70:71], v164 offset:36864
    v_mfma_f32_16x16x32_bf16 v[12:15], v[108:111], a[24:27], v[12:15]
    ds_read_b64_tr_b16 v[72:73], v165 offset:32768
    v_mfma_f32_16x16x32_bf16 v[44:47], v[108:111], a[28:31], v[44:47]
    ds_read_b64_tr_b16 v[74:75], v165 offset:36864
    v_mfma_f32_16x16x32_bf16 v[16:19], v[112:115], a[24:27], v[16:19]
    ds_read_b64_tr_b16 v[76:77], v166 offset:32768
    s_add_u32 s23, s62, 0x50000
    s_add_u32 m0, s65, 16384
    s_nop 0
    buffer_load_dwordx4 v161, s[40:43], s23 offen lds
    v_mfma_f32_16x16x32_bf16 v[48:51], v[112:115], a[28:31], v[48:51]
    ds_read_b64_tr_b16 v[78:79], v166 offset:36864
    v_mfma_f32_16x16x32_bf16 v[20:23], v[116:119], a[24:27], v[20:23]
    ds_read_b64_tr_b16 v[80:81], v167 offset:32768
    v_mfma_f32_16x16x32_bf16 v[52:55], v[116:119], a[28:31], v[52:55]
    ds_read_b64_tr_b16 v[82:83], v167 offset:36864
    v_mfma_f32_16x16x32_bf16 v[24:27], v[120:123], a[24:27], v[24:27]
    ds_read_b64_tr_b16 v[84:85], v168 offset:32768
    s_add_u32 m0, s65, 17408
    s_nop 0
    buffer_load_dwordx4 v162, s[40:43], s23 offen lds
    v_mfma_f32_16x16x32_bf16 v[56:59], v[120:123], a[28:31], v[56:59]
    ds_read_b64_tr_b16 v[86:87], v168 offset:36864
    v_mfma_f32_16x16x32_bf16 v[28:31], v[124:127], a[24:27], v[28:31]
    ds_read_b64_tr_b16 v[88:89], v169 offset:32768
    v_mfma_f32_16x16x32_bf16 v[60:63], v[124:127], a[28:31], v[60:63]
    ds_read_b64_tr_b16 v[90:91], v169 offset:36864
    s_waitcnt vmcnt(16)
    s_waitcnt lgkmcnt(12)
    v_mfma_f32_16x16x32_bf16 v[0:3], v[64:67], a[32:35], v[0:3]
    ds_read_b64_tr_b16 v[92:93], v170 offset:32768
    s_add_u32 s24, s60, 0xc0000
    buffer_load_dwordx4 a[24:27], v160, s[76:79], s24 offen offset:0 sc1
    v_mfma_f32_16x16x32_bf16 v[32:35], v[64:67], a[36:39], v[32:35]
    ds_read_b64_tr_b16 v[94:95], v170 offset:36864
    s_waitcnt lgkmcnt(12)
    v_mfma_f32_16x16x32_bf16 v[4:7], v[68:71], a[32:35], v[4:7]
    ds_read_b64_tr_b16 v[96:97], v163 offset:40960
    buffer_load_dwordx4 a[28:31], v160, s[76:79], s24 offen offset:1024 sc1
    v_mfma_f32_16x16x32_bf16 v[36:39], v[68:71], a[36:39], v[36:39]
    ds_read_b64_tr_b16 v[98:99], v163 offset:45056
    s_waitcnt lgkmcnt(12)
    v_mfma_f32_16x16x32_bf16 v[8:11], v[72:75], a[32:35], v[8:11]
    ds_read_b64_tr_b16 v[100:101], v164 offset:40960
    v_mfma_f32_16x16x32_bf16 v[40:43], v[72:75], a[36:39], v[40:43]
    ds_read_b64_tr_b16 v[102:103], v164 offset:45056
    s_waitcnt lgkmcnt(12)
    v_mfma_f32_16x16x32_bf16 v[12:15], v[76:79], a[32:35], v[12:15]
    ds_read_b64_tr_b16 v[104:105], v165 offset:40960
    v_mfma_f32_16x16x32_bf16 v[44:47], v[76:79], a[36:39], v[44:47]
    ds_read_b64_tr_b16 v[106:107], v165 offset:45056
    s_waitcnt lgkmcnt(12)
    v_mfma_f32_16x16x32_bf16 v[16:19], v[80:83], a[32:35], v[16:19]
    ds_read_b64_tr_b16 v[108:109], v166 offset:40960
    v_mfma_f32_16x16x32_bf16 v[48:51], v[80:83], a[36:39], v[48:51]
    ds_read_b64_tr_b16 v[110:111], v166 offset:45056
    s_waitcnt lgkmcnt(12)
    v_mfma_f32_16x16x32_bf16 v[20:23], v[84:87], a[32:35], v[20:23]
    ds_read_b64_tr_b16 v[112:113], v167 offset:40960
    v_mfma_f32_16x16x32_bf16 v[52:55], v[84:87], a[36:39], v[52:55]
    ds_read_b64_tr_b16 v[114:115], v167 offset:45056
    s_waitcnt lgkmcnt(12)
    v_mfma_f32_16x16x32_bf16 v[24:27], v[88:91], a[32:35], v[24:27]
    ds_read_b64_tr_b16 v[116:117], v168 offset:40960
    v_mfma_f32_16x16x32_bf16 v[56:59], v[88:91], a[36:39], v[56:59]
    ds_read_b64_tr_b16 v[118:119], v168 offset:45056
    s_waitcnt lgkmcnt(12)
    v_mfma_f32_16x16x32_bf16 v[28:31], v[92:95], a[32:35], v[28:31]
    ds_read_b64_tr_b16 v[120:121], v169 offset:40960
    v_mfma_f32_16x16x32_bf16 v[60:63], v[92:95], a[36:39], v[60:63]
    ds_read_b64_tr_b16 v[122:123], v169 offset:45056
    s_waitcnt vmcnt(16)
    s_waitcnt lgkmcnt(12)
    v_mfma_f32_16x16x32_bf16 v[0:3], v[96:99], a[40:43], v[0:3]
    ds_read_b64_tr_b16 v[124:125], v170 offset:40960
    s_add_u32 s24, s60, 0xe0000
    buffer_load_dwordx4 a[32:35], v160, s[76:79], s24 offen offset:0 sc1
    v_mfma_f32_16x16x32_bf16 v[32:35], v[96:99], a[44:47], v[32:35]
    ds_read_b64_tr_b16 v[126:127], v170 offset:45056
    s_waitcnt lgkmcnt(12)
    v_mfma_f32_16x16x32_bf16 v[4:7], v[100:103], a[40:43], v[4:7]
    buffer_load_dwordx4 a[36:39], v160, s[76:79], s24 offen offset:1024 sc1
    v_mfma_f32_16x16x32_bf16 v[36:39], v[100:103], a[44:47], v[36:39]
    s_waitcnt lgkmcnt(0)
    s_barrier
    v_mfma_f32_16x16x32_bf16 v[8:11], v[104:107], a[40:43], v[8:11]
    ds_read_b64_tr_b16 v[64:65], v163 offset:49152
    ds_read_b64_tr_b16 v[66:67], v163 offset:53248
    v_mfma_f32_16x16x32_bf16 v[40:43], v[104:107], a[44:47], v[40:43]
    ds_read_b64_tr_b16 v[68:69], v164 offset:49152
    ds_read_b64_tr_b16 v[70:71], v164 offset:53248
    v_mfma_f32_16x16x32_bf16 v[12:15], v[108:111], a[40:43], v[12:15]
    ds_read_b64_tr_b16 v[72:73], v165 offset:49152
    v_mfma_f32_16x16x32_bf16 v[44:47], v[108:111], a[44:47], v[44:47]
    ds_read_b64_tr_b16 v[74:75], v165 offset:53248
    v_mfma_f32_16x16x32_bf16 v[16:19], v[112:115], a[40:43], v[16:19]
    ds_read_b64_tr_b16 v[76:77], v166 offset:49152
    s_add_u32 s23, s62, 0x70000
    s_add_u32 m0, s65, 32768
    s_nop 0
    buffer_load_dwordx4 v161, s[40:43], s23 offen lds
    v_mfma_f32_16x16x32_bf16 v[48:51], v[112:115], a[44:47], v[48:51]
    ds_read_b64_tr_b16 v[78:79], v166 offset:53248
    v_mfma_f32_16x16x32_bf16 v[20:23], v[116:119], a[40:43], v[20:23]
    ds_read_b64_tr_b16 v[80:81], v167 offset:49152
    v_mfma_f32_16x16x32_bf16 v[52:55], v[116:119], a[44:47], v[52:55]
    ds_read_b64_tr_b16 v[82:83], v167 offset:53248
    v_mfma_f32_16x16x32_bf16 v[24:27], v[120:123], a[40:43], v[24:27]
    ds_read_b64_tr_b16 v[84:85], v168 offset:49152
    s_add_u32 m0, s65, 33792
    s_nop 0
    buffer_load_dwordx4 v162, s[40:43], s23 offen lds
    v_mfma_f32_16x16x32_bf16 v[56:59], v[120:123], a[44:47], v[56:59]
    ds_read_b64_tr_b16 v[86:87], v168 offset:53248
    v_and_b32 v128, 0x70, v160
    v_lshrrev_b32 v128, 2, v128
    v_and_b32 v129, 0x380, v160
    v_add_u32 v128, v129, v128
    buffer_load_dword v179, v128, s[76:79], s92 offen sc1
    v_mfma_f32_16x16x32_bf16 v[28:31], v[124:127], a[40:43], v[28:31]
    ds_read_b64_tr_b16 v[88:89], v169 offset:49152
    v_mfma_f32_16x16x32_bf16 v[60:63], v[124:127], a[44:47], v[60:63]
    ds_read_b64_tr_b16 v[90:91], v169 offset:53248
    s_waitcnt vmcnt(19)
    s_waitcnt lgkmcnt(12)
    v_mfma_f32_16x16x32_bf16 v[0:3], v[64:67], a[48:51], v[0:3]
    ds_read_b64_tr_b16 v[92:93], v170 offset:49152
    s_add_u32 s24, s60, 0x100000
    buffer_load_dwordx4 a[40:43], v160, s[76:79], s24 offen offset:0 sc1
    v_mfma_f32_16x16x32_bf16 v[32:35], v[64:67], a[52:55], v[32:35]
    ds_read_b64_tr_b16 v[94:95], v170 offset:53248
    s_waitcnt lgkmcnt(12)
    v_mfma_f32_16x16x32_bf16 v[4:7], v[68:71], a[48:51], v[4:7]
    ds_read_b64_tr_b16 v[96:97], v163 offset:57344
    buffer_load_dwordx4 a[44:47], v160, s[76:79], s24 offen offset:1024 sc1
    v_mfma_f32_16x16x32_bf16 v[36:39], v[68:71], a[52:55], v[36:39]
    ds_read_b64_tr_b16 v[98:99], v163 offset:61440
    s_waitcnt lgkmcnt(12)
    v_mfma_f32_16x16x32_bf16 v[8:11], v[72:75], a[48:51], v[8:11]
    ds_read_b64_tr_b16 v[100:101], v164 offset:57344
    v_mfma_f32_16x16x32_bf16 v[40:43], v[72:75], a[52:55], v[40:43]
    ds_read_b64_tr_b16 v[102:103], v164 offset:61440
    s_waitcnt lgkmcnt(12)
    v_mfma_f32_16x16x32_bf16 v[12:15], v[76:79], a[48:51], v[12:15]
    ds_read_b64_tr_b16 v[104:105], v165 offset:57344
    v_mfma_f32_16x16x32_bf16 v[44:47], v[76:79], a[52:55], v[44:47]
    ds_read_b64_tr_b16 v[106:107], v165 offset:61440
    s_waitcnt lgkmcnt(12)
    v_mfma_f32_16x16x32_bf16 v[16:19], v[80:83], a[48:51], v[16:19]
    ds_read_b64_tr_b16 v[108:109], v166 offset:57344
    v_mfma_f32_16x16x32_bf16 v[48:51], v[80:83], a[52:55], v[48:51]
    ds_read_b64_tr_b16 v[110:111], v166 offset:61440
    s_waitcnt lgkmcnt(12)
    v_mfma_f32_16x16x32_bf16 v[20:23], v[84:87], a[48:51], v[20:23]
    ds_read_b64_tr_b16 v[112:113], v167 offset:57344
    v_mfma_f32_16x16x32_bf16 v[52:55], v[84:87], a[52:55], v[52:55]
    ds_read_b64_tr_b16 v[114:115], v167 offset:61440
    s_waitcnt lgkmcnt(12)
    v_mfma_f32_16x16x32_bf16 v[24:27], v[88:91], a[48:51], v[24:27]
    ds_read_b64_tr_b16 v[116:117], v168 offset:57344
    v_mfma_f32_16x16x32_bf16 v[56:59], v[88:91], a[52:55], v[56:59]
    ds_read_b64_tr_b16 v[118:119], v168 offset:61440
    s_waitcnt lgkmcnt(12)
    v_mfma_f32_16x16x32_bf16 v[28:31], v[92:95], a[48:51], v[28:31]
    ds_read_b64_tr_b16 v[120:121], v169 offset:57344
    v_mfma_f32_16x16x32_bf16 v[60:63], v[92:95], a[52:55], v[60:63]
    ds_read_b64_tr_b16 v[122:123], v169 offset:61440
    s_waitcnt vmcnt(18)
    s_waitcnt lgkmcnt(12)
    v_mfma_f32_16x16x32_bf16 v[0:3], v[96:99], a[56:59], v[0:3]
    ds_read_b64_tr_b16 v[124:125], v170 offset:57344
    s_add_u32 s24, s60, 0x180000
    buffer_load_dwordx4 a[48:51], v160, s[76:79], s24 offen offset:0 sc1
    v_mfma_f32_16x16x32_bf16 v[32:35], v[96:99], a[60:63], v[32:35]
    ds_read_b64_tr_b16 v[126:127], v170 offset:61440
    s_waitcnt lgkmcnt(12)
    v_mfma_f32_16x16x32_bf16 v[4:7], v[100:103], a[56:59], v[4:7]
    buffer_load_dwordx4 a[52:55], v160, s[76:79], s24 offen offset:1024 sc1
    v_mfma_f32_16x16x32_bf16 v[36:39], v[100:103], a[60:63], v[36:39]
    s_waitcnt vmcnt(19) lgkmcnt(0)
    s_barrier
    v_mfma_f32_16x16x32_bf16 v[8:11], v[104:107], a[56:59], v[8:11]
    ds_read_b64_tr_b16 v[64:65], v163 offset:0
    ds_read_b64_tr_b16 v[66:67], v163 offset:4096
    v_mfma_f32_16x16x32_bf16 v[40:43], v[104:107], a[60:63], v[40:43]
    ds_read_b64_tr_b16 v[68:69], v164 offset:0
    ds_read_b64_tr_b16 v[70:71], v164 offset:4096
    v_mfma_f32_16x16x32_bf16 v[12:15], v[108:111], a[56:59], v[12:15]
    ds_read_b64_tr_b16 v[72:73], v165 offset:0
    v_mfma_f32_16x16x32_bf16 v[44:47], v[108:111], a[60:63], v[44:47]
    ds_read_b64_tr_b16 v[74:75], v165 offset:4096
    v_mfma_f32_16x16x32_bf16 v[16:19], v[112:115], a[56:59], v[16:19]
    ds_read_b64_tr_b16 v[76:77], v166 offset:0
    s_add_u32 s23, s62, 0xc0000
    s_add_u32 m0, s65, 49152
    s_nop 0
    buffer_load_dwordx4 v161, s[40:43], s23 offen lds
    v_mfma_f32_16x16x32_bf16 v[48:51], v[112:115], a[60:63], v[48:51]
    ds_read_b64_tr_b16 v[78:79], v166 offset:4096
    v_mfma_f32_16x16x32_bf16 v[20:23], v[116:119], a[56:59], v[20:23]
    ds_read_b64_tr_b16 v[80:81], v167 offset:0
    v_mfma_f32_16x16x32_bf16 v[52:55], v[116:119], a[60:63], v[52:55]
    ds_read_b64_tr_b16 v[82:83], v167 offset:4096
    v_mfma_f32_16x16x32_bf16 v[24:27], v[120:123], a[56:59], v[24:27]
    ds_read_b64_tr_b16 v[84:85], v168 offset:0
    s_add_u32 m0, s65, 50176
    s_nop 0
    buffer_load_dwordx4 v162, s[40:43], s23 offen lds
    v_mfma_f32_16x16x32_bf16 v[56:59], v[120:123], a[60:63], v[56:59]
    ds_read_b64_tr_b16 v[86:87], v168 offset:4096
    v_mfma_f32_16x16x32_bf16 v[28:31], v[124:127], a[56:59], v[28:31]
    ds_read_b64_tr_b16 v[88:89], v169 offset:0
    v_mfma_f32_16x16x32_bf16 v[60:63], v[124:127], a[60:63], v[60:63]
    ds_read_b64_tr_b16 v[90:91], v169 offset:4096
    s_waitcnt vmcnt(6)
    v_cmp_le_u32 vcc, 4, v179
    s_nop 1
    s_cmp_eq_u64 vcc, -1
    s_cbranch_scc1 K3_WH_OK
    s_mov_b32 s99, 0x10000
K3_WH_SPIN:
    s_sleep 2
    buffer_load_dword v179, v128, s[76:79], s92 offen sc1
    s_waitcnt vmcnt(0)
    v_cmp_le_u32 vcc, 4, v179
    s_nop 1
    s_cmp_eq_u64 vcc, -1
    s_cbranch_scc1 K3_WH_OK
    s_sub_u32 s99, s99, 1
    s_cmp_lg_u32 s99, 0
    s_cbranch_scc1 K3_WH_SPIN
K3_WH_OK:
    s_waitcnt lgkmcnt(12)
    v_mfma_f32_16x16x32_bf16 v[0:3], v[64:67], a[0:3], v[0:3]
    ds_read_b64_tr_b16 v[92:93], v170 offset:0
    s_add_u32 s24, s60, 0x1a0000
    buffer_load_dwordx4 a[56:59], v160, s[76:79], s24 offen offset:0 sc1
    buffer_load_dwordx4 v[128:131], v181, s[76:79], s72 offen offset:0 sc1
    buffer_load_dwordx4 v[132:135], v181, s[76:79], s72 offen offset:256 sc1
    v_mfma_f32_16x16x32_bf16 v[32:35], v[64:67], a[4:7], v[32:35]
    ds_read_b64_tr_b16 v[94:95], v170 offset:4096
    s_add_u32 s72, s72, 0x4000
    buffer_load_dwordx4 v[136:139], v181, s[76:79], s72 offen offset:0 sc1
    s_waitcnt lgkmcnt(12)
    v_mfma_f32_16x16x32_bf16 v[4:7], v[68:71], a[0:3], v[4:7]
    ds_read_b64_tr_b16 v[96:97], v163 offset:8192
    buffer_load_dwordx4 a[60:63], v160, s[76:79], s24 offen offset:1024 sc1
    buffer_load_dwordx4 v[140:143], v181, s[76:79], s72 offen offset:256 sc1
    s_add_u32 s72, s72, 0x4000
    v_mfma_f32_16x16x32_bf16 v[36:39], v[68:71], a[4:7], v[36:39]
    ds_read_b64_tr_b16 v[98:99], v163 offset:12288
    buffer_load_dwordx4 a[64:67], v182, s[76:79], s73 offen offset:0 sc1
    buffer_load_dwordx4 a[68:71], v182, s[76:79], s73 offen offset:64 sc1
    s_waitcnt lgkmcnt(12)
    v_mfma_f32_16x16x32_bf16 v[8:11], v[72:75], a[0:3], v[8:11]
    ds_read_b64_tr_b16 v[100:101], v164 offset:8192
    buffer_load_dword v171, v183, s[76:79], s74 offen offset:0 sc1
    buffer_load_dword v176, v183, s[76:79], s75 offen offset:0 sc1
    v_mfma_f32_16x16x32_bf16 v[40:43], v[72:75], a[4:7], v[40:43]
    ds_read_b64_tr_b16 v[102:103], v164 offset:12288
    buffer_load_dword v172, v183, s[76:79], s74 offen offset:64 sc1
    buffer_load_dword v179, v183, s[76:79], s75 offen offset:64 sc1
    s_waitcnt lgkmcnt(12)
    v_mfma_f32_16x16x32_bf16 v[12:15], v[76:79], a[0:3], v[12:15]
    ds_read_b64_tr_b16 v[104:105], v165 offset:8192
    v_mfma_f32_16x16x32_bf16 v[44:47], v[76:79], a[4:7], v[44:47]
    ds_read_b64_tr_b16 v[106:107], v165 offset:12288
    s_waitcnt lgkmcnt(12)
    v_mfma_f32_16x16x32_bf16 v[16:19], v[80:83], a[0:3], v[16:19]
    ds_read_b64_tr_b16 v[108:109], v166 offset:8192
    v_mfma_f32_16x16x32_bf16 v[48:51], v[80:83], a[4:7], v[48:51]
    ds_read_b64_tr_b16 v[110:111], v166 offset:12288
    s_waitcnt lgkmcnt(12)
    v_mfma_f32_16x16x32_bf16 v[20:23], v[84:87], a[0:3], v[20:23]
    ds_read_b64_tr_b16 v[112:113], v167 offset:8192
    v_mfma_f32_16x16x32_bf16 v[52:55], v[84:87], a[4:7], v[52:55]
    ds_read_b64_tr_b16 v[114:115], v167 offset:12288
    s_waitcnt lgkmcnt(12)
    v_mfma_f32_16x16x32_bf16 v[24:27], v[88:91], a[0:3], v[24:27]
    ds_read_b64_tr_b16 v[116:117], v168 offset:8192
    v_mfma_f32_16x16x32_bf16 v[56:59], v[88:91], a[4:7], v[56:59]
    ds_read_b64_tr_b16 v[118:119], v168 offset:12288
    s_waitcnt lgkmcnt(12)
    v_mfma_f32_16x16x32_bf16 v[28:31], v[92:95], a[0:3], v[28:31]
    ds_read_b64_tr_b16 v[120:121], v169 offset:8192
    v_mfma_f32_16x16x32_bf16 v[60:63], v[92:95], a[4:7], v[60:63]
    ds_read_b64_tr_b16 v[122:123], v169 offset:12288
    s_waitcnt lgkmcnt(12)
    v_mfma_f32_16x16x32_bf16 v[0:3], v[96:99], a[8:11], v[0:3]
    ds_read_b64_tr_b16 v[124:125], v170 offset:8192
    s_add_u32 s24, s59, 0x40000
    buffer_load_dwordx4 a[0:3], v160, s[76:79], s24 offen offset:0 sc1
    v_mfma_f32_16x16x32_bf16 v[32:35], v[96:99], a[12:15], v[32:35]
    ds_read_b64_tr_b16 v[126:127], v170 offset:12288
    s_waitcnt lgkmcnt(12)
    v_mfma_f32_16x16x32_bf16 v[4:7], v[100:103], a[8:11], v[4:7]
    buffer_load_dwordx4 a[4:7], v160, s[76:79], s24 offen offset:1024 sc1
    v_mfma_f32_16x16x32_bf16 v[36:39], v[100:103], a[12:15], v[36:39]
    s_waitcnt lgkmcnt(0)
    s_barrier
    v_mfma_f32_16x16x32_bf16 v[8:11], v[104:107], a[8:11], v[8:11]
    ds_read_b64_tr_b16 v[64:65], v163 offset:16384
    ds_read_b64_tr_b16 v[66:67], v163 offset:20480
    v_mfma_f32_16x16x32_bf16 v[40:43], v[104:107], a[12:15], v[40:43]
    ds_read_b64_tr_b16 v[68:69], v164 offset:16384
    ds_read_b64_tr_b16 v[70:71], v164 offset:20480
    v_mfma_f32_16x16x32_bf16 v[12:15], v[108:111], a[8:11], v[12:15]
    ds_read_b64_tr_b16 v[72:73], v165 offset:16384
    v_mfma_f32_16x16x32_bf16 v[44:47], v[108:111], a[12:15], v[44:47]
    ds_read_b64_tr_b16 v[74:75], v165 offset:20480
    v_mfma_f32_16x16x32_bf16 v[16:19], v[112:115], a[8:11], v[16:19]
    ds_read_b64_tr_b16 v[76:77], v166 offset:16384
    s_add_u32 s23, s61, 0x20000
    s_add_u32 m0, s65, 0
    s_nop 0
    buffer_load_dwordx4 v161, s[40:43], s23 offen lds
    v_mfma_f32_16x16x32_bf16 v[48:51], v[112:115], a[12:15], v[48:51]
    ds_read_b64_tr_b16 v[78:79], v166 offset:20480
    v_mfma_f32_16x16x32_bf16 v[20:23], v[116:119], a[8:11], v[20:23]
    ds_read_b64_tr_b16 v[80:81], v167 offset:16384
    v_mfma_f32_16x16x32_bf16 v[52:55], v[116:119], a[12:15], v[52:55]
    ds_read_b64_tr_b16 v[82:83], v167 offset:20480
    v_mfma_f32_16x16x32_bf16 v[24:27], v[120:123], a[8:11], v[24:27]
    ds_read_b64_tr_b16 v[84:85], v168 offset:16384
    s_add_u32 m0, s65, 1024
    s_nop 0
    buffer_load_dwordx4 v162, s[40:43], s23 offen lds
    v_mfma_f32_16x16x32_bf16 v[56:59], v[120:123], a[12:15], v[56:59]
    ds_read_b64_tr_b16 v[86:87], v168 offset:20480
    v_mfma_f32_16x16x32_bf16 v[28:31], v[124:127], a[8:11], v[28:31]
    ds_read_b64_tr_b16 v[88:89], v169 offset:16384
    v_mfma_f32_16x16x32_bf16 v[60:63], v[124:127], a[12:15], v[60:63]
    ds_read_b64_tr_b16 v[90:91], v169 offset:20480
    s_waitcnt lgkmcnt(12)
    v_mfma_f32_16x16x32_bf16 v[0:3], v[64:67], a[16:19], v[0:3]
    ds_read_b64_tr_b16 v[92:93], v170 offset:16384
    s_add_u32 s24, s59, 0x60000
    s_sub_u32 s24, s24, s33
    s_add_u32 s25, s24, 0x10000
    buffer_load_dwordx4 a[8:11], v160, s[76:79], s24 offen sc1
    v_mfma_f32_16x16x32_bf16 v[32:35], v[64:67], a[20:23], v[32:35]
    ds_read_b64_tr_b16 v[94:95], v170 offset:20480
    s_waitcnt lgkmcnt(12)
    v_mfma_f32_16x16x32_bf16 v[4:7], v[68:71], a[16:19], v[4:7]
    ds_read_b64_tr_b16 v[96:97], v163 offset:24576
    v_mfma_f32_16x16x32_bf16 v[36:39], v[68:71], a[20:23], v[36:39]
    ds_read_b64_tr_b16 v[98:99], v163 offset:28672
    s_waitcnt lgkmcnt(12)
    v_mfma_f32_16x16x32_bf16 v[8:11], v[72:75], a[16:19], v[8:11]
    ds_read_b64_tr_b16 v[100:101], v164 offset:24576
    buffer_load_dwordx4 a[12:15], v160, s[76:79], s25 offen sc1
    v_lshrrev_b32 v152, 3, v183
    v_and_b32 v153, 4, v183
    v_mfma_f32_16x16x32_bf16 v[40:43], v[72:75], a[20:23], v[40:43]
    ds_read_b64_tr_b16 v[102:103], v164 offset:28672
    v_lshlrev_b32 v153, 2, v153
    v_lshlrev_b32 v153, v153, s90
    s_waitcnt lgkmcnt(12)
    v_mfma_f32_16x16x32_bf16 v[12:15], v[76:79], a[16:19], v[12:15]
    ds_read_b64_tr_b16 v[104:105], v165 offset:24576
    v_cmp_eq_u32 vcc, 0, v152
    s_nop 1
    v_cndmask_b32 v144, 0, v153, vcc
    v_mfma_f32_16x16x32_bf16 v[44:47], v[76:79], a[20:23], v[44:47]
    ds_read_b64_tr_b16 v[106:107], v165 offset:28672
    v_cmp_eq_u32 vcc, 1, v152
    s_nop 1
    v_cndmask_b32 v145, 0, v153, vcc
    s_waitcnt lgkmcnt(12)
    v_mfma_f32_16x16x32_bf16 v[16:19], v[80:83], a[16:19], v[16:19]
    ds_read_b64_tr_b16 v[108:109], v166 offset:24576
    v_cmp_eq_u32 vcc, 4, v152
    s_nop 1
    v_cndmask_b32 v146, 0, v153, vcc
    v_mfma_f32_16x16x32_bf16 v[48:51], v[80:83], a[20:23], v[48:51]
    ds_read_b64_tr_b16 v[110:111], v166 offset:28672
    v_cmp_eq_u32 vcc, 5, v152
    s_nop 1
    v_cndmask_b32 v147, 0, v153, vcc
    s_waitcnt lgkmcnt(12)
    v_mfma_f32_16x16x32_bf16 v[20:23], v[84:87], a[16:19], v[20:23]
    ds_read_b64_tr_b16 v[112:113], v167 offset:24576
    v_cmp_eq_u32 vcc, 2, v152
    s_nop 1
    v_cndmask_b32 v148, 0, v153, vcc
    v_mfma_f32_16x16x32_bf16 v[52:55], v[84:87], a[20:23], v[52:55]
    ds_read_b64_tr_b16 v[114:115], v167 offset:28672
    v_cmp_eq_u32 vcc, 3, v152
    s_nop 1
    v_cndmask_b32 v149, 0, v153, vcc
    s_waitcnt lgkmcnt(12)
    v_mfma_f32_16x16x32_bf16 v[24:27], v[88:91], a[16:19], v[24:27]
    ds_read_b64_tr_b16 v[116:117], v168 offset:24576
    v_cmp_eq_u32 vcc, 6, v152
    s_nop 1
    v_cndmask_b32 v150, 0, v153, vcc
    v_mfma_f32_16x16x32_bf16 v[56:59], v[88:91], a[20:23], v[56:59]
    ds_read_b64_tr_b16 v[118:119], v168 offset:28672
    v_cmp_eq_u32 vcc, 7, v152
    s_nop 1
    v_cndmask_b32 v151, 0, v153, vcc
    s_waitcnt lgkmcnt(12)
    v_mfma_f32_16x16x32_bf16 v[28:31], v[92:95], a[16:19], v[28:31]
    ds_read_b64_tr_b16 v[120:121], v169 offset:24576
    v_mfma_f32_16x16x32_bf16 v[60:63], v[92:95], a[20:23], v[60:63]
    ds_read_b64_tr_b16 v[122:123], v169 offset:28672
    s_waitcnt lgkmcnt(12)
    v_mfma_f32_16x16x32_bf16 v[0:3], v[96:99], a[24:27], v[0:3]
    ds_read_b64_tr_b16 v[124:125], v170 offset:24576
    s_add_u32 s24, s59, 0x80000
    buffer_load_dwordx4 a[16:19], v160, s[76:79], s24 offen offset:0 sc1
    v_mfma_f32_16x16x32_bf16 v[32:35], v[96:99], a[28:31], v[32:35]
    ds_read_b64_tr_b16 v[126:127], v170 offset:28672
    s_waitcnt lgkmcnt(12)
    v_mfma_f32_16x16x32_bf16 v[4:7], v[100:103], a[24:27], v[4:7]
    v_mfma_f32_16x16x32_bf16 v[36:39], v[100:103], a[28:31], v[36:39]
    s_waitcnt lgkmcnt(0)
    s_barrier
    v_mfma_f32_16x16x32_bf16 v[8:11], v[104:107], a[24:27], v[8:11]
    ds_read_b64_tr_b16 v[64:65], v163 offset:32768
    ds_read_b64_tr_b16 v[66:67], v163 offset:36864
    buffer_load_dwordx4 a[20:23], v160, s[76:79], s24 offen offset:1024 sc1
    v_mfma_f32_16x16x32_bf16 v[40:43], v[104:107], a[28:31], v[40:43]
    ds_read_b64_tr_b16 v[68:69], v164 offset:32768
    ds_read_b64_tr_b16 v[70:71], v164 offset:36864
    v_mfma_f32_16x16x32_bf16 v[12:15], v[108:111], a[24:27], v[12:15]
    ds_read_b64_tr_b16 v[72:73], v165 offset:32768
    v_mfma_f32_16x16x32_bf16 v[44:47], v[108:111], a[28:31], v[44:47]
    ds_read_b64_tr_b16 v[74:75], v165 offset:36864
    v_mfma_f32_16x16x32_bf16 v[16:19], v[112:115], a[24:27], v[16:19]
    ds_read_b64_tr_b16 v[76:77], v166 offset:32768
    s_add_u32 s23, s61, 0x40000
    s_add_u32 s23, s23, s70
    s_add_u32 m0, s65, 16384
    s_nop 0
    buffer_load_dwordx4 v161, s[40:43], s23 offen lds
    v_mfma_f32_16x16x32_bf16 v[48:51], v[112:115], a[28:31], v[48:51]
    ds_read_b64_tr_b16 v[78:79], v166 offset:36864
    v_mfma_f32_16x16x32_bf16 v[20:23], v[116:119], a[24:27], v[20:23]
    ds_read_b64_tr_b16 v[80:81], v167 offset:32768
    v_mfma_f32_16x16x32_bf16 v[52:55], v[116:119], a[28:31], v[52:55]
    ds_read_b64_tr_b16 v[82:83], v167 offset:36864
    v_mfma_f32_16x16x32_bf16 v[24:27], v[120:123], a[24:27], v[24:27]
    ds_read_b64_tr_b16 v[84:85], v168 offset:32768
    s_add_u32 m0, s65, 17408
    s_nop 0
    buffer_load_dwordx4 v162, s[40:43], s23 offen lds
    v_mfma_f32_16x16x32_bf16 v[56:59], v[120:123], a[28:31], v[56:59]
    ds_read_b64_tr_b16 v[86:87], v168 offset:36864
    v_mfma_f32_16x16x32_bf16 v[28:31], v[124:127], a[24:27], v[28:31]
    ds_read_b64_tr_b16 v[88:89], v169 offset:32768
    v_mfma_f32_16x16x32_bf16 v[60:63], v[124:127], a[28:31], v[60:63]
    ds_read_b64_tr_b16 v[90:91], v169 offset:36864
    s_waitcnt lgkmcnt(12)
    v_mfma_f32_16x16x32_bf16 v[0:3], v[64:67], a[32:35], v[0:3]
    ds_read_b64_tr_b16 v[92:93], v170 offset:32768
    s_add_u32 s24, s59, 0x120000
    buffer_load_dwordx4 a[24:27], v160, s[76:79], s24 offen offset:0 sc1
    s_waitcnt vmcnt(11)
    v_accvgpr_read_b32 v152, a64
    v_accvgpr_read_b32 v153, a66
    v_accvgpr_read_b32 v154, a68
    v_accvgpr_read_b32 v155, a70
    v_max3_u32 v156, v128, v132, v136
    v_max3_u32 v152, v152, v153, v154
    v_max3_u32 v156, v156, v140, v155
    v_max_u32 v152, v152, v156
    v_cmp_eq_u32 vcc, -1, v152
    s_nop 1
    s_cmp_eq_u64 vcc, 0
    s_cbranch_scc1 K3_VK_OK
    s_mov_b32 s99, 0x10000
K3_VK_SPIN:
    s_sleep 2
    s_sub_u32 s72, s72, 0x8000
    buffer_load_dwordx4 v[128:131], v181, s[76:79], s72 offen offset:0 sc1
    buffer_load_dwordx4 v[132:135], v181, s[76:79], s72 offen offset:256 sc1
    s_add_u32 s72, s72, 0x4000
    buffer_load_dwordx4 v[136:139], v181, s[76:79], s72 offen offset:0 sc1
    buffer_load_dwordx4 v[140:143], v181, s[76:79], s72 offen offset:256 sc1
    s_add_u32 s72, s72, 0x4000
    buffer_load_dwordx4 a[64:67], v182, s[76:79], s73 offen offset:0 sc1
    buffer_load_dwordx4 a[68:71], v182, s[76:79], s73 offen offset:64 sc1
    s_waitcnt vmcnt(0)
    v_accvgpr_read_b32 v152, a64
    v_accvgpr_read_b32 v153, a66
    v_accvgpr_read_b32 v154, a68
    v_accvgpr_read_b32 v155, a70
    v_max3_u32 v156, v128, v132, v136
    v_max3_u32 v152, v152, v153, v154
    v_max3_u32 v156, v156, v140, v155
    v_max_u32 v152, v152, v156
    v_cmp_eq_u32 vcc, -1, v152
    s_nop 1
    s_cmp_eq_u64 vcc, 0
    s_cbranch_scc1 K3_VK_OK
    s_sub_u32 s99, s99, 1
    s_cmp_lg_u32 s99, 0
    s_cbranch_scc1 K3_VK_SPIN
K3_VK_OK:
    v_mfma_f32_16x16x32_bf16 v[32:35], v[64:67], a[36:39], v[32:35]
    ds_read_b64_tr_b16 v[94:95], v170 offset:36864
    v_mfma_f32_16x16x32_bf16 v[152:155], v[144:147], v[128:131], 0
    s_waitcnt lgkmcnt(12)
    v_mfma_f32_16x16x32_bf16 v[4:7], v[68:71], a[32:35], v[4:7]
    ds_read_b64_tr_b16 v[96:97], v163 offset:40960
    v_mfma_f32_16x16x32_bf16 v[152:155], v[148:151], v[132:135], v[152:155]
    v_mfma_f32_16x16x32_bf16 v[36:39], v[68:71], a[36:39], v[36:39]
    ds_read_b64_tr_b16 v[98:99], v163 offset:45056
    v_mfma_f32_16x16x32_bf16 v[152:155], v[144:147], v[136:139], v[152:155]
    s_waitcnt lgkmcnt(12)
    v_mfma_f32_16x16x32_bf16 v[8:11], v[72:75], a[32:35], v[8:11]
    ds_read_b64_tr_b16 v[100:101], v164 offset:40960
    buffer_load_dwordx4 a[28:31], v160, s[76:79], s24 offen offset:1024 sc1
    v_mfma_f32_16x16x32_bf16 v[152:155], v[148:151], v[140:143], v[152:155]
    v_mfma_f32_16x16x32_bf16 v[40:43], v[72:75], a[36:39], v[40:43]
    ds_read_b64_tr_b16 v[102:103], v164 offset:45056
    s_waitcnt lgkmcnt(12)
    v_mfma_f32_16x16x32_bf16 v[12:15], v[76:79], a[32:35], v[12:15]
    ds_read_b64_tr_b16 v[104:105], v165 offset:40960
    v_mfma_f32_16x16x32_bf16 v[44:47], v[76:79], a[36:39], v[44:47]
    ds_read_b64_tr_b16 v[106:107], v165 offset:45056
    s_nop 0
    v_cvt_pk_bf16_f32 v152, v152, v153
    v_cvt_pk_bf16_f32 v153, v154, v155
    s_waitcnt lgkmcnt(12)
    v_mfma_f32_16x16x32_bf16 v[16:19], v[80:83], a[32:35], v[16:19]
    ds_read_b64_tr_b16 v[108:109], v166 offset:40960
    ds_write_b64 v180, v[152:153]
    v_mfma_f32_16x16x32_bf16 v[48:51], v[80:83], a[36:39], v[48:51]
    ds_read_b64_tr_b16 v[110:111], v166 offset:45056
    s_waitcnt lgkmcnt(13)
    v_mfma_f32_16x16x32_bf16 v[20:23], v[84:87], a[32:35], v[20:23]
    ds_read_b64_tr_b16 v[112:113], v167 offset:40960
    v_mfma_f32_16x16x32_bf16 v[52:55], v[84:87], a[36:39], v[52:55]
    ds_read_b64_tr_b16 v[114:115], v167 offset:45056
    s_waitcnt lgkmcnt(13)
    v_mfma_f32_16x16x32_bf16 v[24:27], v[88:91], a[32:35], v[24:27]
    ds_read_b64_tr_b16 v[116:117], v168 offset:40960
    v_mfma_f32_16x16x32_bf16 v[56:59], v[88:91], a[36:39], v[56:59]
    ds_read_b64_tr_b16 v[118:119], v168 offset:45056
    s_waitcnt lgkmcnt(13)
    v_mfma_f32_16x16x32_bf16 v[28:31], v[92:95], a[32:35], v[28:31]
    ds_read_b64_tr_b16 v[120:121], v169 offset:40960
    v_mfma_f32_16x16x32_bf16 v[60:63], v[92:95], a[36:39], v[60:63]
    ds_read_b64_tr_b16 v[122:123], v169 offset:45056
    s_waitcnt lgkmcnt(13)
    v_mfma_f32_16x16x32_bf16 v[0:3], v[96:99], a[40:43], v[0:3]
    ds_read_b64_tr_b16 v[124:125], v170 offset:40960
    s_add_u32 s24, s59, 0x140000
    s_sub_u32 s24, s24, s33
    s_add_u32 s25, s24, 0x10000
    buffer_load_dwordx4 a[32:35], v160, s[76:79], s24 offen sc1
    v_mfma_f32_16x16x32_bf16 v[32:35], v[96:99], a[44:47], v[32:35]
    ds_read_b64_tr_b16 v[126:127], v170 offset:45056
    s_waitcnt lgkmcnt(13)
    v_mfma_f32_16x16x32_bf16 v[4:7], v[100:103], a[40:43], v[4:7]
    v_mfma_f32_16x16x32_bf16 v[36:39], v[100:103], a[44:47], v[36:39]
    s_waitcnt lgkmcnt(0)
    s_barrier
    v_mfma_f32_16x16x32_bf16 v[8:11], v[104:107], a[40:43], v[8:11]
    ds_read_b64_tr_b16 v[64:65], v163 offset:49152
    ds_read_b64_tr_b16 v[66:67], v163 offset:53248
    buffer_load_dwordx4 a[36:39], v160, s[76:79], s25 offen sc1
    ds_read_b128 v[128:131], v178 offset:0
    ds_read_b128 v[132:135], v178 offset:1024
    v_mfma_f32_16x16x32_bf16 v[40:43], v[104:107], a[44:47], v[40:43]
    ds_read_b64_tr_b16 v[68:69], v164 offset:49152
    ds_read_b64_tr_b16 v[70:71], v164 offset:53248
    ds_read_b128 v[136:139], v178 offset:2048
    ds_read_b128 v[140:143], v178 offset:3072
    v_mfma_f32_16x16x32_bf16 v[12:15], v[108:111], a[40:43], v[12:15]
    ds_read_b64_tr_b16 v[72:73], v165 offset:49152
    ds_read_b128 v[144:147], v177 offset:0
    ds_read_b128 v[148:151], v177 offset:1024
    v_mfma_f32_16x16x32_bf16 v[44:47], v[108:111], a[44:47], v[44:47]
    ds_read_b64_tr_b16 v[74:75], v165 offset:53248
    s_nop 0
    s_nop 0
    v_mfma_f32_16x16x32_bf16 v[16:19], v[112:115], a[40:43], v[16:19]
    ds_read_b64_tr_b16 v[76:77], v166 offset:49152
    s_add_u32 s23, s61, 0xa0000
    s_add_u32 m0, s65, 32768
    s_nop 0
    buffer_load_dwordx4 v161, s[40:43], s23 offen lds
    s_nop 0
    s_waitcnt lgkmcnt(2)
    v_mfma_f32_16x16x32_bf16 v[48:51], v[112:115], a[44:47], v[48:51]
    ds_read_b64_tr_b16 v[78:79], v166 offset:53248
    v_mfma_f32_16x16x32_bf16 v[180:183], a[64:67], v[144:147], 0
    v_mfma_f32_16x16x32_bf16 v[152:155], v[128:131], v[144:147], 0
    v_mfma_f32_16x16x32_bf16 v[20:23], v[116:119], a[40:43], v[20:23]
    ds_read_b64_tr_b16 v[80:81], v167 offset:49152
    v_mfma_f32_16x16x32_bf16 v[156:159], v[136:139], v[144:147], 0
    v_mfma_f32_16x16x32_bf16 v[180:183], a[68:71], v[148:151], v[180:183]
    v_mfma_f32_16x16x32_bf16 v[52:55], v[116:119], a[44:47], v[52:55]
    ds_read_b64_tr_b16 v[82:83], v167 offset:53248
    v_mfma_f32_16x16x32_bf16 v[152:155], v[132:135], v[148:151], v[152:155]
    v_mfma_f32_16x16x32_bf16 v[156:159], v[140:143], v[148:151], v[156:159]
    v_mfma_f32_16x16x32_bf16 v[24:27], v[120:123], a[40:43], v[24:27]
    ds_read_b64_tr_b16 v[84:85], v168 offset:49152
    s_add_u32 m0, s65, 33792
    s_nop 0
    buffer_load_dwordx4 v162, s[40:43], s23 offen lds
    s_nop 0
    s_nop 0
    v_mfma_f32_16x16x32_bf16 v[56:59], v[120:123], a[44:47], v[56:59]
    ds_read_b64_tr_b16 v[86:87], v168 offset:53248
    s_nop 0
    v_add_f32 v180, v180, v181
    v_mfma_f32_16x16x32_bf16 v[28:31], v[124:127], a[40:43], v[28:31]
    ds_read_b64_tr_b16 v[88:89], v169 offset:49152
    v_add_f32 v182, v182, v183
    v_add_f32 v180, v180, v182
    v_mfma_f32_16x16x32_bf16 v[60:63], v[124:127], a[44:47], v[60:63]
    ds_read_b64_tr_b16 v[90:91], v169 offset:53248
    v_mov_b32 v181, v180
    s_nop 1
    v_permlane16_swap_b32 v180, v181
    v_mfma_f32_16x16x32_bf16 v[0:3], v[64:67], a[48:51], v[0:3]
    ds_read_b64_tr_b16 v[92:93], v170 offset:49152
    s_add_u32 s24, s59, 0x160000
    buffer_load_dwordx4 a[40:43], v160, s[76:79], s24 offen offset:0 sc1
    v_add_f32 v180, v180, v181
    v_add_f32 v180, 0x358637bd, v180
    v_mfma_f32_16x16x32_bf16 v[32:35], v[64:67], a[52:55], v[32:35]
    ds_read_b64_tr_b16 v[94:95], v170 offset:53248
    v_rcp_f32 v180, v180
    s_nop 0
    v_mul_f32 v180, v180, v176
    v_mfma_f32_16x16x32_bf16 v[4:7], v[68:71], a[48:51], v[4:7]
    ds_read_b64_tr_b16 v[96:97], v163 offset:57344
    v_mul_f32 v152, v152, v180
    v_mul_f32 v153, v153, v180
    v_mfma_f32_16x16x32_bf16 v[36:39], v[68:71], a[52:55], v[36:39]
    ds_read_b64_tr_b16 v[98:99], v163 offset:61440
    v_mul_f32 v154, v154, v180
    v_mul_f32 v155, v155, v180
    s_waitcnt lgkmcnt(12)
    v_mfma_f32_16x16x32_bf16 v[8:11], v[72:75], a[48:51], v[8:11]
    ds_read_b64_tr_b16 v[100:101], v164 offset:57344
    buffer_load_dwordx4 a[44:47], v160, s[76:79], s24 offen offset:1024 sc1
    v_mul_f32 v156, v156, v180
    v_mul_f32 v157, v157, v180
    v_mfma_f32_16x16x32_bf16 v[40:43], v[72:75], a[52:55], v[40:43]
    ds_read_b64_tr_b16 v[102:103], v164 offset:61440
    v_mul_f32 v158, v158, v180
    v_mul_f32 v159, v159, v180
    s_waitcnt lgkmcnt(12)
    v_mfma_f32_16x16x32_bf16 v[12:15], v[76:79], a[48:51], v[12:15]
    ds_read_b64_tr_b16 v[104:105], v165 offset:57344
    v_cvt_pk_bf16_f32 v152, v152, v153
    v_cvt_pk_bf16_f32 v153, v154, v155
    v_mfma_f32_16x16x32_bf16 v[44:47], v[76:79], a[52:55], v[44:47]
    ds_read_b64_tr_b16 v[106:107], v165 offset:61440
    v_cvt_pk_bf16_f32 v154, v156, v157
    v_cvt_pk_bf16_f32 v155, v158, v159
    s_waitcnt lgkmcnt(12)
    v_mfma_f32_16x16x32_bf16 v[16:19], v[80:83], a[48:51], v[16:19]
    ds_read_b64_tr_b16 v[108:109], v166 offset:57344
    s_add_u32 s23, s64, 0x0
    s_add_u32 m0, s65, 65536
    s_nop 0
    buffer_load_dwordx4 v161, s[44:47], s23 offen lds
    buffer_store_dwordx4 v[152:155], v160, s[76:79], s35 offen offset:0 sc1
    v_sub_f32 v171, 1.0, v171
    v_mfma_f32_16x16x32_bf16 v[48:51], v[80:83], a[52:55], v[48:51]
    ds_read_b64_tr_b16 v[110:111], v166 offset:61440
    ds_read_b128 v[144:147], v177 offset:2048
    ds_read_b128 v[148:151], v177 offset:3072
    s_waitcnt lgkmcnt(14)
    v_mfma_f32_16x16x32_bf16 v[20:23], v[84:87], a[48:51], v[20:23]
    ds_read_b64_tr_b16 v[112:113], v167 offset:57344
    s_nop 0
    s_nop 0
    v_mfma_f32_16x16x32_bf16 v[52:55], v[84:87], a[52:55], v[52:55]
    ds_read_b64_tr_b16 v[114:115], v167 offset:61440
    s_nop 0
    s_waitcnt lgkmcnt(2)
    v_mfma_f32_16x16x32_bf16 v[24:27], v[88:91], a[48:51], v[24:27]
    ds_read_b64_tr_b16 v[116:117], v168 offset:57344
    s_add_u32 m0, s65, 66560
    s_nop 0
    buffer_load_dwordx4 v162, s[44:47], s23 offen lds
    v_mfma_f32_16x16x32_bf16 v[180:183], a[64:67], v[144:147], 0
    v_mfma_f32_16x16x32_bf16 v[152:155], v[128:131], v[144:147], 0
    v_mfma_f32_16x16x32_bf16 v[56:59], v[88:91], a[52:55], v[56:59]
    ds_read_b64_tr_b16 v[118:119], v168 offset:61440
    v_mfma_f32_16x16x32_bf16 v[156:159], v[136:139], v[144:147], 0
    v_mfma_f32_16x16x32_bf16 v[180:183], a[68:71], v[148:151], v[180:183]
    v_mfma_f32_16x16x32_bf16 v[28:31], v[92:95], a[48:51], v[28:31]
    ds_read_b64_tr_b16 v[120:121], v169 offset:57344
    v_mfma_f32_16x16x32_bf16 v[152:155], v[132:135], v[148:151], v[152:155]
    v_mfma_f32_16x16x32_bf16 v[156:159], v[140:143], v[148:151], v[156:159]
    v_mfma_f32_16x16x32_bf16 v[60:63], v[92:95], a[52:55], v[60:63]
    ds_read_b64_tr_b16 v[122:123], v169 offset:61440
    s_nop 0
    s_nop 0
    v_mfma_f32_16x16x32_bf16 v[0:3], v[96:99], a[56:59], v[0:3]
    ds_read_b64_tr_b16 v[124:125], v170 offset:57344
    s_add_u32 s24, s60, 0x40000
    buffer_load_dwordx4 a[48:51], v160, s[76:79], s24 offen offset:0 sc1
    s_nop 0
    v_add_f32 v180, v180, v181
    v_mfma_f32_16x16x32_bf16 v[32:35], v[96:99], a[60:63], v[32:35]
    ds_read_b64_tr_b16 v[126:127], v170 offset:61440
    v_add_f32 v182, v182, v183
    v_add_f32 v180, v180, v182
    v_mfma_f32_16x16x32_bf16 v[4:7], v[100:103], a[56:59], v[4:7]
    v_mov_b32 v181, v180
    s_nop 1
    v_permlane16_swap_b32 v180, v181
    v_mfma_f32_16x16x32_bf16 v[36:39], v[100:103], a[60:63], v[36:39]
    v_add_f32 v180, v180, v181
    v_add_f32 v180, 0x358637bd, v180
    s_waitcnt vmcnt(18) lgkmcnt(0)
    s_barrier
    v_mfma_f32_16x16x32_bf16 v[8:11], v[104:107], a[56:59], v[8:11]
    ds_read_b64_tr_b16 v[64:65], v163 offset:0
    ds_read_b64_tr_b16 v[66:67], v163 offset:4096
    buffer_load_dwordx4 a[52:55], v160, s[76:79], s24 offen offset:1024 sc1
    v_rcp_f32 v180, v180
    s_nop 0
    v_mul_f32 v180, v180, v179
    v_mfma_f32_16x16x32_bf16 v[40:43], v[104:107], a[60:63], v[40:43]
    ds_read_b64_tr_b16 v[68:69], v164 offset:0
    ds_read_b64_tr_b16 v[70:71], v164 offset:4096
    v_mul_f32 v152, v152, v180
    v_mul_f32 v153, v153, v180
    v_mfma_f32_16x16x32_bf16 v[12:15], v[108:111], a[56:59], v[12:15]
    ds_read_b64_tr_b16 v[72:73], v165 offset:0
    v_mul_f32 v154, v154, v180
    v_mul_f32 v155, v155, v180
    v_mfma_f32_16x16x32_bf16 v[44:47], v[108:111], a[60:63], v[44:47]
    ds_read_b64_tr_b16 v[74:75], v165 offset:4096
    v_mul_f32 v156, v156, v180
    v_mul_f32 v157, v157, v180
    v_mfma_f32_16x16x32_bf16 v[16:19], v[112:115], a[56:59], v[16:19]
    ds_read_b64_tr_b16 v[76:77], v166 offset:0
    s_add_u32 s23, s62, 0x20000
    s_add_u32 m0, s65, 49152
    s_nop 0
    buffer_load_dwordx4 v161, s[40:43], s23 offen lds
    v_mul_f32 v158, v158, v180
    v_mul_f32 v159, v159, v180
    v_mfma_f32_16x16x32_bf16 v[48:51], v[112:115], a[60:63], v[48:51]
    ds_read_b64_tr_b16 v[78:79], v166 offset:4096
    v_cvt_pk_bf16_f32 v152, v152, v153
    v_cvt_pk_bf16_f32 v153, v154, v155
    v_mfma_f32_16x16x32_bf16 v[20:23], v[116:119], a[56:59], v[20:23]
    ds_read_b64_tr_b16 v[80:81], v167 offset:0
    v_cvt_pk_bf16_f32 v154, v156, v157
    v_cvt_pk_bf16_f32 v155, v158, v159
    v_mfma_f32_16x16x32_bf16 v[52:55], v[116:119], a[60:63], v[52:55]
    ds_read_b64_tr_b16 v[82:83], v167 offset:4096
    buffer_store_dwordx4 v[152:155], v160, s[76:79], s35 offen offset:1024 sc1
    v_sub_f32 v172, 1.0, v172
    v_mfma_f32_16x16x32_bf16 v[24:27], v[120:123], a[56:59], v[24:27]
    ds_read_b64_tr_b16 v[84:85], v168 offset:0
    s_add_u32 m0, s65, 50176
    s_nop 0
    buffer_load_dwordx4 v162, s[40:43], s23 offen lds
    v_mfma_f32_16x16x32_bf16 v[56:59], v[120:123], a[60:63], v[56:59]
    ds_read_b64_tr_b16 v[86:87], v168 offset:4096
    v_mfma_f32_16x16x32_bf16 v[28:31], v[124:127], a[56:59], v[28:31]
    ds_read_b64_tr_b16 v[88:89], v169 offset:0
    v_mfma_f32_16x16x32_bf16 v[60:63], v[124:127], a[60:63], v[60:63]
    ds_read_b64_tr_b16 v[90:91], v169 offset:4096
    s_waitcnt lgkmcnt(12)
    v_mfma_f32_16x16x32_bf16 v[0:3], v[64:67], a[0:3], v[0:3]
    ds_read_b64_tr_b16 v[92:93], v170 offset:0
    s_add_u32 s24, s60, 0x60000
    s_sub_u32 s24, s24, s33
    s_add_u32 s25, s24, 0x10000
    buffer_load_dwordx4 v[128:131], v160, s[76:79], s24 offen sc1
    v_mfma_f32_16x16x32_bf16 v[32:35], v[64:67], a[4:7], v[32:35]
    ds_read_b64_tr_b16 v[94:95], v170 offset:4096
    s_waitcnt lgkmcnt(12)
    v_mfma_f32_16x16x32_bf16 v[4:7], v[68:71], a[0:3], v[4:7]
    ds_read_b64_tr_b16 v[96:97], v163 offset:8192
    v_mfma_f32_16x16x32_bf16 v[36:39], v[68:71], a[4:7], v[36:39]
    ds_read_b64_tr_b16 v[98:99], v163 offset:12288
    s_waitcnt lgkmcnt(12)
    v_mfma_f32_16x16x32_bf16 v[8:11], v[72:75], a[0:3], v[8:11]
    ds_read_b64_tr_b16 v[100:101], v164 offset:8192
    buffer_load_dwordx4 v[132:135], v160, s[76:79], s25 offen sc1
    v_mfma_f32_16x16x32_bf16 v[40:43], v[72:75], a[4:7], v[40:43]
    ds_read_b64_tr_b16 v[102:103], v164 offset:12288
    s_waitcnt lgkmcnt(12)
    v_mfma_f32_16x16x32_bf16 v[12:15], v[76:79], a[0:3], v[12:15]
    ds_read_b64_tr_b16 v[104:105], v165 offset:8192
    v_mfma_f32_16x16x32_bf16 v[44:47], v[76:79], a[4:7], v[44:47]
    ds_read_b64_tr_b16 v[106:107], v165 offset:12288
    s_waitcnt lgkmcnt(12)
    v_mfma_f32_16x16x32_bf16 v[16:19], v[80:83], a[0:3], v[16:19]
    ds_read_b64_tr_b16 v[108:109], v166 offset:8192
    s_add_u32 s23, s64, 0x20000
    s_add_u32 m0, s65, 81920
    s_nop 0
    buffer_load_dwordx4 v161, s[44:47], s23 offen lds
    v_mfma_f32_16x16x32_bf16 v[48:51], v[80:83], a[4:7], v[48:51]
    ds_read_b64_tr_b16 v[110:111], v166 offset:12288
    s_waitcnt lgkmcnt(12)
    v_mfma_f32_16x16x32_bf16 v[20:23], v[84:87], a[0:3], v[20:23]
    ds_read_b64_tr_b16 v[112:113], v167 offset:8192
    s_add_u32 s24, s60, 0x80000
    buffer_load_dwordx4 v[136:139], v160, s[76:79], s24 offen offset:0 sc1
    v_mfma_f32_16x16x32_bf16 v[52:55], v[84:87], a[4:7], v[52:55]
    ds_read_b64_tr_b16 v[114:115], v167 offset:12288
    s_waitcnt lgkmcnt(12)
    v_mfma_f32_16x16x32_bf16 v[24:27], v[88:91], a[0:3], v[24:27]
    ds_read_b64_tr_b16 v[116:117], v168 offset:8192
    s_add_u32 m0, s65, 82944
    s_nop 0
    buffer_load_dwordx4 v162, s[44:47], s23 offen lds
    v_mfma_f32_16x16x32_bf16 v[56:59], v[88:91], a[4:7], v[56:59]
    ds_read_b64_tr_b16 v[118:119], v168 offset:12288
    s_waitcnt lgkmcnt(12)
    v_mfma_f32_16x16x32_bf16 v[28:31], v[92:95], a[0:3], v[28:31]
    ds_read_b64_tr_b16 v[120:121], v169 offset:8192
    v_mfma_f32_16x16x32_bf16 v[60:63], v[92:95], a[4:7], v[60:63]
    ds_read_b64_tr_b16 v[122:123], v169 offset:12288
    s_waitcnt vmcnt(25)
    v_accvgpr_read_b32 v180, a10
    v_accvgpr_read_b32 v181, a11
    v_accvgpr_mov_b32 a10, a12
    v_accvgpr_mov_b32 a11, a13
    v_accvgpr_write_b32 a12, v180
    v_accvgpr_write_b32 a13, v181
    s_waitcnt lgkmcnt(12)
    v_mfma_f32_16x16x32_bf16 v[0:3], v[96:99], a[8:11], v[0:3]
    ds_read_b64_tr_b16 v[124:125], v170 offset:8192
    buffer_load_dwordx4 v[140:143], v160, s[76:79], s24 offen offset:1024 sc1
    v_mfma_f32_16x16x32_bf16 v[32:35], v[96:99], a[12:15], v[32:35]
    ds_read_b64_tr_b16 v[126:127], v170 offset:12288
    s_waitcnt lgkmcnt(12)
    v_mfma_f32_16x16x32_bf16 v[4:7], v[100:103], a[8:11], v[4:7]
    v_mfma_f32_16x16x32_bf16 v[36:39], v[100:103], a[12:15], v[36:39]
    s_waitcnt vmcnt(22) lgkmcnt(0)
    s_barrier
    v_mfma_f32_16x16x32_bf16 v[8:11], v[104:107], a[8:11], v[8:11]
    ds_read_b64_tr_b16 v[64:65], v163 offset:16384
    ds_read_b64_tr_b16 v[66:67], v163 offset:20480
    s_add_u32 s24, s60, 0x120000
    buffer_load_dwordx4 v[144:147], v160, s[76:79], s24 offen offset:0 sc1
    v_mfma_f32_16x16x32_bf16 v[40:43], v[104:107], a[12:15], v[40:43]
    ds_read_b64_tr_b16 v[68:69], v164 offset:16384
    ds_read_b64_tr_b16 v[70:71], v164 offset:20480
    v_mfma_f32_16x16x32_bf16 v[12:15], v[108:111], a[8:11], v[12:15]
    ds_read_b64_tr_b16 v[72:73], v165 offset:16384
    v_mfma_f32_16x16x32_bf16 v[44:47], v[108:111], a[12:15], v[44:47]
    ds_read_b64_tr_b16 v[74:75], v165 offset:20480
    v_mfma_f32_16x16x32_bf16 v[16:19], v[112:115], a[8:11], v[16:19]
    ds_read_b64_tr_b16 v[76:77], v166 offset:16384
    s_add_u32 s23, s62, 0x40000
    s_add_u32 s23, s23, s70
    s_add_u32 m0, s65, 0
    s_nop 0
    buffer_load_dwordx4 v161, s[40:43], s23 offen lds
    v_mfma_f32_16x16x32_bf16 v[48:51], v[112:115], a[12:15], v[48:51]
    ds_read_b64_tr_b16 v[78:79], v166 offset:20480
    v_mfma_f32_16x16x32_bf16 v[20:23], v[116:119], a[8:11], v[20:23]
    ds_read_b64_tr_b16 v[80:81], v167 offset:16384
    buffer_load_dwordx4 v[148:151], v160, s[76:79], s24 offen offset:1024 sc1
    v_mfma_f32_16x16x32_bf16 v[52:55], v[116:119], a[12:15], v[52:55]
    ds_read_b64_tr_b16 v[82:83], v167 offset:20480
    v_mfma_f32_16x16x32_bf16 v[24:27], v[120:123], a[8:11], v[24:27]
    ds_read_b64_tr_b16 v[84:85], v168 offset:16384
    s_add_u32 m0, s65, 1024
    s_nop 0
    buffer_load_dwordx4 v162, s[40:43], s23 offen lds
    v_mfma_f32_16x16x32_bf16 v[56:59], v[120:123], a[12:15], v[56:59]
    ds_read_b64_tr_b16 v[86:87], v168 offset:20480
    v_mfma_f32_16x16x32_bf16 v[28:31], v[124:127], a[8:11], v[28:31]
    ds_read_b64_tr_b16 v[88:89], v169 offset:16384
    v_mfma_f32_16x16x32_bf16 v[60:63], v[124:127], a[12:15], v[60:63]
    ds_read_b64_tr_b16 v[90:91], v169 offset:20480
    s_waitcnt lgkmcnt(12)
    v_mfma_f32_16x16x32_bf16 v[0:3], v[64:67], a[16:19], v[0:3]
    ds_read_b64_tr_b16 v[92:93], v170 offset:16384
    s_add_u32 s24, s60, 0x140000
    s_sub_u32 s24, s24, s33
    s_add_u32 s25, s24, 0x10000
    buffer_load_dwordx4 v[152:155], v160, s[76:79], s24 offen sc1
    v_mfma_f32_16x16x32_bf16 v[32:35], v[64:67], a[20:23], v[32:35]
    ds_read_b64_tr_b16 v[94:95], v170 offset:20480
    s_waitcnt lgkmcnt(12)
    v_mfma_f32_16x16x32_bf16 v[4:7], v[68:71], a[16:19], v[4:7]
    ds_read_b64_tr_b16 v[96:97], v163 offset:24576
    v_mfma_f32_16x16x32_bf16 v[36:39], v[68:71], a[20:23], v[36:39]
    ds_read_b64_tr_b16 v[98:99], v163 offset:28672
    s_waitcnt lgkmcnt(12)
    v_mfma_f32_16x16x32_bf16 v[8:11], v[72:75], a[16:19], v[8:11]
    ds_read_b64_tr_b16 v[100:101], v164 offset:24576
    buffer_load_dwordx4 v[156:159], v160, s[76:79], s25 offen sc1
    v_mfma_f32_16x16x32_bf16 v[40:43], v[72:75], a[20:23], v[40:43]
    ds_read_b64_tr_b16 v[102:103], v164 offset:28672
    s_waitcnt lgkmcnt(12)
    v_mfma_f32_16x16x32_bf16 v[12:15], v[76:79], a[16:19], v[12:15]
    ds_read_b64_tr_b16 v[104:105], v165 offset:24576
    v_mfma_f32_16x16x32_bf16 v[44:47], v[76:79], a[20:23], v[44:47]
    ds_read_b64_tr_b16 v[106:107], v165 offset:28672
    s_waitcnt lgkmcnt(12)
    v_mfma_f32_16x16x32_bf16 v[16:19], v[80:83], a[16:19], v[16:19]
    ds_read_b64_tr_b16 v[108:109], v166 offset:24576
    s_add_u32 s23, s64, 0x40000
    s_add_u32 m0, s65, 98304
    s_nop 0
    buffer_load_dwordx4 v161, s[44:47], s23 offen lds
    v_mfma_f32_16x16x32_bf16 v[48:51], v[80:83], a[20:23], v[48:51]
    ds_read_b64_tr_b16 v[110:111], v166 offset:28672
    s_waitcnt lgkmcnt(12)
    v_mfma_f32_16x16x32_bf16 v[20:23], v[84:87], a[16:19], v[20:23]
    ds_read_b64_tr_b16 v[112:113], v167 offset:24576
    s_add_u32 s24, s60, 0x160000
    buffer_load_dwordx4 a[64:67], v160, s[76:79], s24 offen offset:0 sc1
    v_mfma_f32_16x16x32_bf16 v[52:55], v[84:87], a[20:23], v[52:55]
    ds_read_b64_tr_b16 v[114:115], v167 offset:28672
    s_waitcnt lgkmcnt(12)
    v_mfma_f32_16x16x32_bf16 v[24:27], v[88:91], a[16:19], v[24:27]
    ds_read_b64_tr_b16 v[116:117], v168 offset:24576
    s_add_u32 m0, s65, 99328
    s_nop 0
    buffer_load_dwordx4 v162, s[44:47], s23 offen lds
    v_mfma_f32_16x16x32_bf16 v[56:59], v[88:91], a[20:23], v[56:59]
    ds_read_b64_tr_b16 v[118:119], v168 offset:28672
    s_waitcnt lgkmcnt(12)
    v_mfma_f32_16x16x32_bf16 v[28:31], v[92:95], a[16:19], v[28:31]
    ds_read_b64_tr_b16 v[120:121], v169 offset:24576
    v_mfma_f32_16x16x32_bf16 v[60:63], v[92:95], a[20:23], v[60:63]
    ds_read_b64_tr_b16 v[122:123], v169 offset:28672
    s_waitcnt vmcnt(29)
    s_waitcnt lgkmcnt(12)
    v_mfma_f32_16x16x32_bf16 v[0:3], v[96:99], a[24:27], v[0:3]
    ds_read_b64_tr_b16 v[124:125], v170 offset:24576
    buffer_load_dwordx4 a[68:71], v160, s[76:79], s24 offen offset:1024 sc1
    v_mfma_f32_16x16x32_bf16 v[32:35], v[96:99], a[28:31], v[32:35]
    ds_read_b64_tr_b16 v[126:127], v170 offset:28672
    s_waitcnt lgkmcnt(12)
    v_mfma_f32_16x16x32_bf16 v[4:7], v[100:103], a[24:27], v[4:7]
    v_mfma_f32_16x16x32_bf16 v[36:39], v[100:103], a[28:31], v[36:39]
    s_waitcnt vmcnt(26) lgkmcnt(0)
    s_barrier
    v_mfma_f32_16x16x32_bf16 v[8:11], v[104:107], a[24:27], v[8:11]
    ds_read_b64_tr_b16 v[64:65], v163 offset:32768
    ds_read_b64_tr_b16 v[66:67], v163 offset:36864
    s_add_u32 s24, s63, 0x0
    buffer_load_dwordx4 a[56:59], v160, s[76:79], s24 offen offset:0 sc1
    v_mfma_f32_16x16x32_bf16 v[40:43], v[104:107], a[28:31], v[40:43]
    ds_read_b64_tr_b16 v[68:69], v164 offset:32768
    ds_read_b64_tr_b16 v[70:71], v164 offset:36864
    v_mfma_f32_16x16x32_bf16 v[12:15], v[108:111], a[24:27], v[12:15]
    ds_read_b64_tr_b16 v[72:73], v165 offset:32768
    v_mfma_f32_16x16x32_bf16 v[44:47], v[108:111], a[28:31], v[44:47]
    ds_read_b64_tr_b16 v[74:75], v165 offset:36864
    v_mfma_f32_16x16x32_bf16 v[16:19], v[112:115], a[24:27], v[16:19]
    ds_read_b64_tr_b16 v[76:77], v166 offset:32768
    s_add_u32 s23, s62, 0xa0000
    s_add_u32 m0, s65, 16384
    s_nop 0
    buffer_load_dwordx4 v161, s[40:43], s23 offen lds
    v_mfma_f32_16x16x32_bf16 v[48:51], v[112:115], a[28:31], v[48:51]
    ds_read_b64_tr_b16 v[78:79], v166 offset:36864
    v_mfma_f32_16x16x32_bf16 v[20:23], v[116:119], a[24:27], v[20:23]
    ds_read_b64_tr_b16 v[80:81], v167 offset:32768
    buffer_load_dwordx4 a[60:63], v160, s[76:79], s24 offen offset:1024 sc1
    v_mfma_f32_16x16x32_bf16 v[52:55], v[116:119], a[28:31], v[52:55]
    ds_read_b64_tr_b16 v[82:83], v167 offset:36864
    v_mfma_f32_16x16x32_bf16 v[24:27], v[120:123], a[24:27], v[24:27]
    ds_read_b64_tr_b16 v[84:85], v168 offset:32768
    s_add_u32 m0, s65, 17408
    s_nop 0
    buffer_load_dwordx4 v162, s[40:43], s23 offen lds
    v_mfma_f32_16x16x32_bf16 v[56:59], v[120:123], a[28:31], v[56:59]
    ds_read_b64_tr_b16 v[86:87], v168 offset:36864
    v_mfma_f32_16x16x32_bf16 v[28:31], v[124:127], a[24:27], v[28:31]
    ds_read_b64_tr_b16 v[88:89], v169 offset:32768
    v_mfma_f32_16x16x32_bf16 v[60:63], v[124:127], a[28:31], v[60:63]
    ds_read_b64_tr_b16 v[90:91], v169 offset:36864
    v_accvgpr_read_b32 v180, a34
    v_accvgpr_read_b32 v181, a35
    v_accvgpr_mov_b32 a34, a36
    v_accvgpr_mov_b32 a35, a37
    v_accvgpr_write_b32 a36, v180
    v_accvgpr_write_b32 a37, v181
    s_waitcnt lgkmcnt(12)
    v_mfma_f32_16x16x32_bf16 v[0:3], v[64:67], a[32:35], v[0:3]
    ds_read_b64_tr_b16 v[92:93], v170 offset:32768
    s_add_u32 s24, s63, 0x200000
    buffer_load_dwordx4 a[0:3], v160, s[76:79], s24 offen offset:0 sc1
    v_mfma_f32_16x16x32_bf16 v[32:35], v[64:67], a[36:39], v[32:35]
    ds_read_b64_tr_b16 v[94:95], v170 offset:36864
    s_waitcnt lgkmcnt(12)
    v_mfma_f32_16x16x32_bf16 v[4:7], v[68:71], a[32:35], v[4:7]
    ds_read_b64_tr_b16 v[96:97], v163 offset:40960
    v_mfma_f32_16x16x32_bf16 v[36:39], v[68:71], a[36:39], v[36:39]
    ds_read_b64_tr_b16 v[98:99], v163 offset:45056
    s_waitcnt lgkmcnt(12)
    v_mfma_f32_16x16x32_bf16 v[8:11], v[72:75], a[32:35], v[8:11]
    ds_read_b64_tr_b16 v[100:101], v164 offset:40960
    buffer_load_dwordx4 a[4:7], v160, s[76:79], s24 offen offset:1024 sc1
    v_mfma_f32_16x16x32_bf16 v[40:43], v[72:75], a[36:39], v[40:43]
    ds_read_b64_tr_b16 v[102:103], v164 offset:45056
    s_waitcnt lgkmcnt(12)
    v_mfma_f32_16x16x32_bf16 v[12:15], v[76:79], a[32:35], v[12:15]
    ds_read_b64_tr_b16 v[104:105], v165 offset:40960
    v_mfma_f32_16x16x32_bf16 v[44:47], v[76:79], a[36:39], v[44:47]
    ds_read_b64_tr_b16 v[106:107], v165 offset:45056
    s_waitcnt lgkmcnt(12)
    v_mfma_f32_16x16x32_bf16 v[16:19], v[80:83], a[32:35], v[16:19]
    ds_read_b64_tr_b16 v[108:109], v166 offset:40960
    s_add_u32 s23, s64, 0x60000
    s_add_u32 m0, s65, 114688
    s_nop 0
    buffer_load_dwordx4 v161, s[44:47], s23 offen lds
    v_mfma_f32_16x16x32_bf16 v[48:51], v[80:83], a[36:39], v[48:51]
    ds_read_b64_tr_b16 v[110:111], v166 offset:45056
    s_waitcnt lgkmcnt(12)
    v_mfma_f32_16x16x32_bf16 v[20:23], v[84:87], a[32:35], v[20:23]
    ds_read_b64_tr_b16 v[112:113], v167 offset:40960
    s_add_u32 s24, s63, 0x400000
    buffer_load_dwordx4 a[8:11], v160, s[76:79], s24 offen offset:0 sc1
    v_mfma_f32_16x16x32_bf16 v[52:55], v[84:87], a[36:39], v[52:55]
    ds_read_b64_tr_b16 v[114:115], v167 offset:45056
    s_waitcnt lgkmcnt(12)
    v_mfma_f32_16x16x32_bf16 v[24:27], v[88:91], a[32:35], v[24:27]
    ds_read_b64_tr_b16 v[116:117], v168 offset:40960
    s_add_u32 m0, s65, 115712
    s_nop 0
    buffer_load_dwordx4 v162, s[44:47], s23 offen lds
    v_mfma_f32_16x16x32_bf16 v[56:59], v[88:91], a[36:39], v[56:59]
    ds_read_b64_tr_b16 v[118:119], v168 offset:45056
    s_waitcnt lgkmcnt(12)
    v_mfma_f32_16x16x32_bf16 v[28:31], v[92:95], a[32:35], v[28:31]
    ds_read_b64_tr_b16 v[120:121], v169 offset:40960
    v_mfma_f32_16x16x32_bf16 v[60:63], v[92:95], a[36:39], v[60:63]
    ds_read_b64_tr_b16 v[122:123], v169 offset:45056
    s_waitcnt vmcnt(33)
    s_waitcnt lgkmcnt(12)
    v_mfma_f32_16x16x32_bf16 v[0:3], v[96:99], a[40:43], v[0:3]
    ds_read_b64_tr_b16 v[124:125], v170 offset:40960
    buffer_load_dwordx4 a[12:15], v160, s[76:79], s24 offen offset:1024 sc1
    v_mfma_f32_16x16x32_bf16 v[32:35], v[96:99], a[44:47], v[32:35]
    ds_read_b64_tr_b16 v[126:127], v170 offset:45056
    s_waitcnt lgkmcnt(12)
    v_mfma_f32_16x16x32_bf16 v[4:7], v[100:103], a[40:43], v[4:7]
    v_mfma_f32_16x16x32_bf16 v[36:39], v[100:103], a[44:47], v[36:39]
    s_waitcnt vmcnt(26) lgkmcnt(0)
    s_barrier
    v_mfma_f32_16x16x32_bf16 v[8:11], v[104:107], a[40:43], v[8:11]
    ds_read_b64_tr_b16 v[64:65], v163 offset:49152
    ds_read_b64_tr_b16 v[66:67], v163 offset:53248
    s_add_u32 s24, s63, 0x600000
    buffer_load_dwordx4 a[16:19], v160, s[76:79], s24 offen offset:0 sc1
    v_mfma_f32_16x16x32_bf16 v[40:43], v[104:107], a[44:47], v[40:43]
    ds_read_b64_tr_b16 v[68:69], v164 offset:49152
    ds_read_b64_tr_b16 v[70:71], v164 offset:53248
    v_mfma_f32_16x16x32_bf16 v[12:15], v[108:111], a[40:43], v[12:15]
    ds_read_b64_tr_b16 v[72:73], v165 offset:49152
    v_mfma_f32_16x16x32_bf16 v[44:47], v[108:111], a[44:47], v[44:47]
    ds_read_b64_tr_b16 v[74:75], v165 offset:53248
    v_mfma_f32_16x16x32_bf16 v[16:19], v[112:115], a[40:43], v[16:19]
    ds_read_b64_tr_b16 v[76:77], v166 offset:49152
    v_mfma_f32_16x16x32_bf16 v[48:51], v[112:115], a[44:47], v[48:51]
    ds_read_b64_tr_b16 v[78:79], v166 offset:53248
    v_mfma_f32_16x16x32_bf16 v[20:23], v[116:119], a[40:43], v[20:23]
    ds_read_b64_tr_b16 v[80:81], v167 offset:49152
    buffer_load_dwordx4 a[20:23], v160, s[76:79], s24 offen offset:1024 sc1
    v_mfma_f32_16x16x32_bf16 v[52:55], v[116:119], a[44:47], v[52:55]
    ds_read_b64_tr_b16 v[82:83], v167 offset:53248
    v_mfma_f32_16x16x32_bf16 v[24:27], v[120:123], a[40:43], v[24:27]
    ds_read_b64_tr_b16 v[84:85], v168 offset:49152
    v_mfma_f32_16x16x32_bf16 v[56:59], v[120:123], a[44:47], v[56:59]
    ds_read_b64_tr_b16 v[86:87], v168 offset:53248
    v_mfma_f32_16x16x32_bf16 v[28:31], v[124:127], a[40:43], v[28:31]
    ds_read_b64_tr_b16 v[88:89], v169 offset:49152
    v_mfma_f32_16x16x32_bf16 v[60:63], v[124:127], a[44:47], v[60:63]
    ds_read_b64_tr_b16 v[90:91], v169 offset:53248
    s_waitcnt lgkmcnt(12)
    v_mfma_f32_16x16x32_bf16 v[0:3], v[64:67], a[48:51], v[0:3]
    ds_read_b64_tr_b16 v[92:93], v170 offset:49152
    s_add_u32 s24, s63, 0x800000
    buffer_load_dwordx4 a[24:27], v160, s[76:79], s24 offen offset:0 sc1
    v_mfma_f32_16x16x32_bf16 v[32:35], v[64:67], a[52:55], v[32:35]
    ds_read_b64_tr_b16 v[94:95], v170 offset:53248
    s_waitcnt lgkmcnt(12)
    v_mfma_f32_16x16x32_bf16 v[4:7], v[68:71], a[48:51], v[4:7]
    ds_read_b64_tr_b16 v[96:97], v163 offset:57344
    v_mfma_f32_16x16x32_bf16 v[36:39], v[68:71], a[52:55], v[36:39]
    ds_read_b64_tr_b16 v[98:99], v163 offset:61440
    s_waitcnt lgkmcnt(12)
    v_mfma_f32_16x16x32_bf16 v[8:11], v[72:75], a[48:51], v[8:11]
    ds_read_b64_tr_b16 v[100:101], v164 offset:57344
    buffer_load_dwordx4 a[28:31], v160, s[76:79], s24 offen offset:1024 sc1
    v_mfma_f32_16x16x32_bf16 v[40:43], v[72:75], a[52:55], v[40:43]
    ds_read_b64_tr_b16 v[102:103], v164 offset:61440
    s_waitcnt lgkmcnt(12)
    v_mfma_f32_16x16x32_bf16 v[12:15], v[76:79], a[48:51], v[12:15]
    ds_read_b64_tr_b16 v[104:105], v165 offset:57344
    v_mfma_f32_16x16x32_bf16 v[44:47], v[76:79], a[52:55], v[44:47]
    ds_read_b64_tr_b16 v[106:107], v165 offset:61440
    s_waitcnt lgkmcnt(12)
    v_mfma_f32_16x16x32_bf16 v[16:19], v[80:83], a[48:51], v[16:19]
    ds_read_b64_tr_b16 v[108:109], v166 offset:57344
    v_mfma_f32_16x16x32_bf16 v[48:51], v[80:83], a[52:55], v[48:51]
    ds_read_b64_tr_b16 v[110:111], v166 offset:61440
    s_waitcnt lgkmcnt(12)
    v_mfma_f32_16x16x32_bf16 v[20:23], v[84:87], a[48:51], v[20:23]
    ds_read_b64_tr_b16 v[112:113], v167 offset:57344
    s_add_u32 s24, s63, 0xa00000
    buffer_load_dwordx4 a[32:35], v160, s[76:79], s24 offen offset:0 sc1
    v_mfma_f32_16x16x32_bf16 v[52:55], v[84:87], a[52:55], v[52:55]
    ds_read_b64_tr_b16 v[114:115], v167 offset:61440
    s_waitcnt lgkmcnt(12)
    v_mfma_f32_16x16x32_bf16 v[24:27], v[88:91], a[48:51], v[24:27]
    ds_read_b64_tr_b16 v[116:117], v168 offset:57344
    v_mfma_f32_16x16x32_bf16 v[56:59], v[88:91], a[52:55], v[56:59]
    ds_read_b64_tr_b16 v[118:119], v168 offset:61440
    s_waitcnt lgkmcnt(12)
    v_mfma_f32_16x16x32_bf16 v[28:31], v[92:95], a[48:51], v[28:31]
    ds_read_b64_tr_b16 v[120:121], v169 offset:57344
    v_mfma_f32_16x16x32_bf16 v[60:63], v[92:95], a[52:55], v[60:63]
    ds_read_b64_tr_b16 v[122:123], v169 offset:61440
    s_waitcnt vmcnt(29)
    v_swap_b32 v130, v132
    v_swap_b32 v131, v133
    s_waitcnt lgkmcnt(12)
    s_nop 0
    v_mfma_f32_16x16x32_bf16 v[0:3], v[96:99], v[128:131], v[0:3]
    ds_read_b64_tr_b16 v[124:125], v170 offset:57344
    buffer_load_dwordx4 a[36:39], v160, s[76:79], s24 offen offset:1024 sc1
    v_mfma_f32_16x16x32_bf16 v[32:35], v[96:99], v[132:135], v[32:35]
    ds_read_b64_tr_b16 v[126:127], v170 offset:61440
    s_waitcnt lgkmcnt(12)
    v_mfma_f32_16x16x32_bf16 v[4:7], v[100:103], v[128:131], v[4:7]
    v_mfma_f32_16x16x32_bf16 v[36:39], v[100:103], v[132:135], v[36:39]
    s_waitcnt vmcnt(7) lgkmcnt(0)
    s_barrier
    v_mfma_f32_16x16x32_bf16 v[8:11], v[104:107], v[128:131], v[8:11]
    ds_read_b64_tr_b16 v[64:65], v165 offset:0
    ds_read_b64_tr_b16 v[66:67], v165 offset:4096
    s_add_u32 s24, s63, 0xc00000
    buffer_load_dwordx4 a[40:43], v160, s[76:79], s24 offen offset:0 sc1
    v_mfma_f32_16x16x32_bf16 v[40:43], v[104:107], v[132:135], v[40:43]
    ds_read_b64_tr_b16 v[68:69], v166 offset:0
    ds_read_b64_tr_b16 v[70:71], v166 offset:4096
    v_mfma_f32_16x16x32_bf16 v[12:15], v[108:111], v[128:131], v[12:15]
    ds_read_b64_tr_b16 v[72:73], v165 offset:8192
    v_mfma_f32_16x16x32_bf16 v[44:47], v[108:111], v[132:135], v[44:47]
    ds_read_b64_tr_b16 v[74:75], v165 offset:12288
    v_mfma_f32_16x16x32_bf16 v[16:19], v[112:115], v[128:131], v[16:19]
    ds_read_b64_tr_b16 v[76:77], v166 offset:8192
    v_mfma_f32_16x16x32_bf16 v[48:51], v[112:115], v[132:135], v[48:51]
    ds_read_b64_tr_b16 v[78:79], v166 offset:12288
    v_mfma_f32_16x16x32_bf16 v[20:23], v[116:119], v[128:131], v[20:23]
    ds_read_b64_tr_b16 v[80:81], v165 offset:16384
    buffer_load_dwordx4 a[44:47], v160, s[76:79], s24 offen offset:1024 sc1
    v_mfma_f32_16x16x32_bf16 v[52:55], v[116:119], v[132:135], v[52:55]
    ds_read_b64_tr_b16 v[82:83], v165 offset:20480
    v_mfma_f32_16x16x32_bf16 v[24:27], v[120:123], v[128:131], v[24:27]
    ds_read_b64_tr_b16 v[84:85], v166 offset:16384
    v_mfma_f32_16x16x32_bf16 v[56:59], v[120:123], v[132:135], v[56:59]
    ds_read_b64_tr_b16 v[86:87], v166 offset:20480
    v_mfma_f32_16x16x32_bf16 v[28:31], v[124:127], v[128:131], v[28:31]
    ds_read_b64_tr_b16 v[88:89], v165 offset:24576
    v_mfma_f32_16x16x32_bf16 v[60:63], v[124:127], v[132:135], v[60:63]
    ds_read_b64_tr_b16 v[90:91], v165 offset:28672
    s_waitcnt lgkmcnt(12)
    v_mfma_f32_16x16x32_bf16 v[8:11], v[64:67], v[136:139], v[8:11]
    ds_read_b64_tr_b16 v[92:93], v166 offset:24576
    s_add_u32 s24, s63, 0xe00000
    buffer_load_dwordx4 a[48:51], v160, s[76:79], s24 offen offset:0 sc1
    v_mfma_f32_16x16x32_bf16 v[40:43], v[64:67], v[140:143], v[40:43]
    ds_read_b64_tr_b16 v[94:95], v166 offset:28672
    s_waitcnt lgkmcnt(12)
    v_mfma_f32_16x16x32_bf16 v[12:15], v[68:71], v[136:139], v[12:15]
    v_add_u32 v165, 0x10000, v165
    ds_read_b64_tr_b16 v[96:97], v165 offset:0
    ds_read_b64_tr_b16 v[98:99], v165 offset:4096
    buffer_load_dwordx4 a[52:55], v160, s[76:79], s24 offen offset:1024 sc1
    v_mfma_f32_16x16x32_bf16 v[44:47], v[68:71], v[140:143], v[44:47]
    s_waitcnt lgkmcnt(12)
    v_mfma_f32_16x16x32_bf16 v[8:11], v[72:75], v[144:147], v[8:11]
    v_add_u32 v166, 0x10000, v166
    ds_read_b64_tr_b16 v[100:101], v166 offset:0
    ds_read_b64_tr_b16 v[102:103], v166 offset:4096
    v_mfma_f32_16x16x32_bf16 v[40:43], v[72:75], v[148:151], v[40:43]
    s_waitcnt lgkmcnt(12)
    v_mfma_f32_16x16x32_bf16 v[12:15], v[76:79], v[144:147], v[12:15]
    ds_read_b64_tr_b16 v[104:105], v165 offset:8192
    v_mfma_f32_16x16x32_bf16 v[44:47], v[76:79], v[148:151], v[44:47]
    ds_read_b64_tr_b16 v[106:107], v165 offset:12288
    v_swap_b32 v154, v156
    v_swap_b32 v155, v157
    s_waitcnt lgkmcnt(12)
    s_nop 0
    v_mfma_f32_16x16x32_bf16 v[8:11], v[80:83], v[152:155], v[8:11]
    ds_read_b64_tr_b16 v[108:109], v166 offset:8192
    v_mfma_f32_16x16x32_bf16 v[40:43], v[80:83], v[156:159], v[40:43]
    ds_read_b64_tr_b16 v[110:111], v166 offset:12288
    s_waitcnt lgkmcnt(12)
    v_mfma_f32_16x16x32_bf16 v[12:15], v[84:87], v[152:155], v[12:15]
    ds_read_b64_tr_b16 v[112:113], v165 offset:16384
    v_mfma_f32_16x16x32_bf16 v[44:47], v[84:87], v[156:159], v[44:47]
    ds_read_b64_tr_b16 v[114:115], v165 offset:20480
    s_waitcnt lgkmcnt(12)
    v_mfma_f32_16x16x32_bf16 v[8:11], v[88:91], a[64:67], v[8:11]
    ds_read_b64_tr_b16 v[116:117], v166 offset:16384
    v_mfma_f32_16x16x32_bf16 v[40:43], v[88:91], a[68:71], v[40:43]
    ds_read_b64_tr_b16 v[118:119], v166 offset:20480
    s_waitcnt lgkmcnt(12)
    v_mfma_f32_16x16x32_bf16 v[12:15], v[92:95], a[64:67], v[12:15]
    ds_read_b64_tr_b16 v[120:121], v165 offset:24576
    s_nop 1
    v_mul_f32 v8, v8, v171
    v_mul_f32 v9, v9, v171
    v_mul_f32 v10, v10, v171
    v_mul_f32 v11, v11, v171
    v_mfma_f32_16x16x32_bf16 v[44:47], v[92:95], a[68:71], v[44:47]
    ds_read_b64_tr_b16 v[122:123], v165 offset:28672
    v_mul_f32 v40, v40, v172
    v_mul_f32 v41, v41, v172
    v_mul_f32 v42, v42, v172
    v_mul_f32 v43, v43, v172
    v_accvgpr_read_b32 v180, a56
    v_accvgpr_read_b32 v181, a60
    v_max_u32 v180, v180, v181
    v_cmp_eq_u32 vcc, -1, v180
    s_nop 1
    s_cmp_eq_u64 vcc, 0
    s_cbranch_scc1 K3_VO28_OK
    s_mov_b32 s99, 0x10000
K3_VO28_SPIN:
    s_sleep 2
    s_add_u32 s96, s63, 0x0
    buffer_load_dwordx4 a[56:59], v160, s[76:79], s96 offen offset:0 sc1
    buffer_load_dwordx4 a[60:63], v160, s[76:79], s96 offen offset:1024 sc1
    s_waitcnt vmcnt(0)
    v_accvgpr_read_b32 v180, a56
    v_accvgpr_read_b32 v181, a60
    v_max_u32 v180, v180, v181
    v_cmp_eq_u32 vcc, -1, v180
    s_nop 1
    s_cmp_eq_u64 vcc, 0
    s_cbranch_scc1 K3_VO28_OK
    s_sub_u32 s99, s99, 1
    s_cmp_lg_u32 s99, 0
    s_cbranch_scc1 K3_VO28_SPIN
K3_VO28_OK:
    s_waitcnt lgkmcnt(12)
    v_mfma_f32_16x16x32_bf16 v[8:11], v[96:99], a[56:59], v[8:11]
    ds_read_b64_tr_b16 v[124:125], v166 offset:24576
    v_mul_f32 v12, v12, v171
    v_mul_f32 v13, v13, v171
    v_mul_f32 v14, v14, v171
    v_mul_f32 v15, v15, v171
    v_mfma_f32_16x16x32_bf16 v[40:43], v[96:99], a[60:63], v[40:43]
    ds_read_b64_tr_b16 v[126:127], v166 offset:28672
    v_mul_f32 v44, v44, v172
    v_mul_f32 v45, v45, v172
    v_mul_f32 v46, v46, v172
    v_mul_f32 v47, v47, v172
    s_waitcnt lgkmcnt(12)
    v_mfma_f32_16x16x32_bf16 v[12:15], v[100:103], a[56:59], v[12:15]
    ds_read_b64_tr_b16 v[64:65], v165 offset:32768
    v_mfma_f32_16x16x32_bf16 v[44:47], v[100:103], a[60:63], v[44:47]
    ds_read_b64_tr_b16 v[66:67], v165 offset:36864
    v_accvgpr_read_b32 v180, a0
    v_accvgpr_read_b32 v181, a4
    v_max_u32 v180, v180, v181
    v_cmp_eq_u32 vcc, -1, v180
    s_nop 1
    s_cmp_eq_u64 vcc, 0
    s_cbranch_scc1 K3_VO29_OK
    s_mov_b32 s99, 0x10000
K3_VO29_SPIN:
    s_sleep 2
    s_add_u32 s96, s63, 0x200000
    buffer_load_dwordx4 a[0:3], v160, s[76:79], s96 offen offset:0 sc1
    buffer_load_dwordx4 a[4:7], v160, s[76:79], s96 offen offset:1024 sc1
    s_waitcnt vmcnt(0)
    v_accvgpr_read_b32 v180, a0
    v_accvgpr_read_b32 v181, a4
    v_max_u32 v180, v180, v181
    v_cmp_eq_u32 vcc, -1, v180
    s_nop 1
    s_cmp_eq_u64 vcc, 0
    s_cbranch_scc1 K3_VO29_OK
    s_sub_u32 s99, s99, 1
    s_cmp_lg_u32 s99, 0
    s_cbranch_scc1 K3_VO29_SPIN
K3_VO29_OK:
    s_waitcnt lgkmcnt(12)
    v_mfma_f32_16x16x32_bf16 v[8:11], v[104:107], a[0:3], v[8:11]
    ds_read_b64_tr_b16 v[68:69], v166 offset:32768
    v_mfma_f32_16x16x32_bf16 v[40:43], v[104:107], a[4:7], v[40:43]
    ds_read_b64_tr_b16 v[70:71], v166 offset:36864
    s_waitcnt lgkmcnt(12)
    v_mfma_f32_16x16x32_bf16 v[12:15], v[108:111], a[0:3], v[12:15]
    ds_read_b64_tr_b16 v[72:73], v165 offset:40960
    v_mfma_f32_16x16x32_bf16 v[44:47], v[108:111], a[4:7], v[44:47]
    ds_read_b64_tr_b16 v[74:75], v165 offset:45056
    s_waitcnt vmcnt(10)
    v_accvgpr_read_b32 v180, a8
    v_accvgpr_read_b32 v181, a12
    v_max_u32 v180, v180, v181
    v_cmp_eq_u32 vcc, -1, v180
    s_nop 1
    s_cmp_eq_u64 vcc, 0
    s_cbranch_scc1 K3_VO30_OK
    s_mov_b32 s99, 0x10000
K3_VO30_SPIN:
    s_sleep 2
    s_add_u32 s96, s63, 0x400000
    buffer_load_dwordx4 a[8:11], v160, s[76:79], s96 offen offset:0 sc1
    buffer_load_dwordx4 a[12:15], v160, s[76:79], s96 offen offset:1024 sc1
    s_waitcnt vmcnt(0)
    v_accvgpr_read_b32 v180, a8
    v_accvgpr_read_b32 v181, a12
    v_max_u32 v180, v180, v181
    v_cmp_eq_u32 vcc, -1, v180
    s_nop 1
    s_cmp_eq_u64 vcc, 0
    s_cbranch_scc1 K3_VO30_OK
    s_sub_u32 s99, s99, 1
    s_cmp_lg_u32 s99, 0
    s_cbranch_scc1 K3_VO30_SPIN
K3_VO30_OK:
    s_waitcnt lgkmcnt(12)
    v_mfma_f32_16x16x32_bf16 v[8:11], v[112:115], a[8:11], v[8:11]
    ds_read_b64_tr_b16 v[76:77], v166 offset:40960
    v_mfma_f32_16x16x32_bf16 v[40:43], v[112:115], a[12:15], v[40:43]
    ds_read_b64_tr_b16 v[78:79], v166 offset:45056
    s_waitcnt lgkmcnt(12)
    v_mfma_f32_16x16x32_bf16 v[12:15], v[116:119], a[8:11], v[12:15]
    ds_read_b64_tr_b16 v[80:81], v165 offset:49152
    v_mfma_f32_16x16x32_bf16 v[44:47], v[116:119], a[12:15], v[44:47]
    ds_read_b64_tr_b16 v[82:83], v165 offset:53248
    s_waitcnt vmcnt(8)
    v_accvgpr_read_b32 v180, a16
    v_accvgpr_read_b32 v181, a20
    v_max_u32 v180, v180, v181
    v_cmp_eq_u32 vcc, -1, v180
    s_nop 1
    s_cmp_eq_u64 vcc, 0
    s_cbranch_scc1 K3_VO31_OK
    s_mov_b32 s99, 0x10000
K3_VO31_SPIN:
    s_sleep 2
    s_add_u32 s96, s63, 0x600000
    buffer_load_dwordx4 a[16:19], v160, s[76:79], s96 offen offset:0 sc1
    buffer_load_dwordx4 a[20:23], v160, s[76:79], s96 offen offset:1024 sc1
    s_waitcnt vmcnt(0)
    v_accvgpr_read_b32 v180, a16
    v_accvgpr_read_b32 v181, a20
    v_max_u32 v180, v180, v181
    v_cmp_eq_u32 vcc, -1, v180
    s_nop 1
    s_cmp_eq_u64 vcc, 0
    s_cbranch_scc1 K3_VO31_OK
    s_sub_u32 s99, s99, 1
    s_cmp_lg_u32 s99, 0
    s_cbranch_scc1 K3_VO31_SPIN
K3_VO31_OK:
    s_waitcnt lgkmcnt(12)
    v_mfma_f32_16x16x32_bf16 v[8:11], v[120:123], a[16:19], v[8:11]
    ds_read_b64_tr_b16 v[84:85], v166 offset:49152
    v_mfma_f32_16x16x32_bf16 v[40:43], v[120:123], a[20:23], v[40:43]
    ds_read_b64_tr_b16 v[86:87], v166 offset:53248
    s_waitcnt lgkmcnt(12)
    v_mfma_f32_16x16x32_bf16 v[12:15], v[124:127], a[16:19], v[12:15]
    ds_read_b64_tr_b16 v[88:89], v165 offset:57344
    v_mfma_f32_16x16x32_bf16 v[44:47], v[124:127], a[20:23], v[44:47]
    ds_read_b64_tr_b16 v[90:91], v165 offset:61440
    s_waitcnt vmcnt(6)
    v_accvgpr_read_b32 v180, a24
    v_accvgpr_read_b32 v181, a28
    v_max_u32 v180, v180, v181
    v_cmp_eq_u32 vcc, -1, v180
    s_nop 1
    s_cmp_eq_u64 vcc, 0
    s_cbranch_scc1 K3_VO32_OK
    s_mov_b32 s99, 0x10000
K3_VO32_SPIN:
    s_sleep 2
    s_add_u32 s96, s63, 0x800000
    buffer_load_dwordx4 a[24:27], v160, s[76:79], s96 offen offset:0 sc1
    buffer_load_dwordx4 a[28:31], v160, s[76:79], s96 offen offset:1024 sc1
    s_waitcnt vmcnt(0)
    v_accvgpr_read_b32 v180, a24
    v_accvgpr_read_b32 v181, a28
    v_max_u32 v180, v180, v181
    v_cmp_eq_u32 vcc, -1, v180
    s_nop 1
    s_cmp_eq_u64 vcc, 0
    s_cbranch_scc1 K3_VO32_OK
    s_sub_u32 s99, s99, 1
    s_cmp_lg_u32 s99, 0
    s_cbranch_scc1 K3_VO32_SPIN
K3_VO32_OK:
    s_waitcnt lgkmcnt(12)
    v_mfma_f32_16x16x32_bf16 v[8:11], v[64:67], a[24:27], v[8:11]
    ds_read_b64_tr_b16 v[92:93], v166 offset:57344
    v_mfma_f32_16x16x32_bf16 v[40:43], v[64:67], a[28:31], v[40:43]
    ds_read_b64_tr_b16 v[94:95], v166 offset:61440
    s_waitcnt lgkmcnt(12)
    v_mfma_f32_16x16x32_bf16 v[12:15], v[68:71], a[24:27], v[12:15]
    ds_read_b64_tr_b16 v[96:97], v167 offset:0
    v_mfma_f32_16x16x32_bf16 v[44:47], v[68:71], a[28:31], v[44:47]
    ds_read_b64_tr_b16 v[98:99], v167 offset:4096
    s_waitcnt vmcnt(4)
    v_accvgpr_read_b32 v180, a32
    v_accvgpr_read_b32 v181, a36
    v_max_u32 v180, v180, v181
    v_cmp_eq_u32 vcc, -1, v180
    s_nop 1
    s_cmp_eq_u64 vcc, 0
    s_cbranch_scc1 K3_VO33_OK
    s_mov_b32 s99, 0x10000
K3_VO33_SPIN:
    s_sleep 2
    s_add_u32 s96, s63, 0xa00000
    buffer_load_dwordx4 a[32:35], v160, s[76:79], s96 offen offset:0 sc1
    buffer_load_dwordx4 a[36:39], v160, s[76:79], s96 offen offset:1024 sc1
    s_waitcnt vmcnt(0)
    v_accvgpr_read_b32 v180, a32
    v_accvgpr_read_b32 v181, a36
    v_max_u32 v180, v180, v181
    v_cmp_eq_u32 vcc, -1, v180
    s_nop 1
    s_cmp_eq_u64 vcc, 0
    s_cbranch_scc1 K3_VO33_OK
    s_sub_u32 s99, s99, 1
    s_cmp_lg_u32 s99, 0
    s_cbranch_scc1 K3_VO33_SPIN
K3_VO33_OK:
    s_waitcnt lgkmcnt(12)
    v_mfma_f32_16x16x32_bf16 v[8:11], v[72:75], a[32:35], v[8:11]
    ds_read_b64_tr_b16 v[100:101], v168 offset:0
    v_mfma_f32_16x16x32_bf16 v[40:43], v[72:75], a[36:39], v[40:43]
    ds_read_b64_tr_b16 v[102:103], v168 offset:4096
    s_waitcnt lgkmcnt(12)
    v_mfma_f32_16x16x32_bf16 v[12:15], v[76:79], a[32:35], v[12:15]
    ds_read_b64_tr_b16 v[104:105], v167 offset:8192
    v_mfma_f32_16x16x32_bf16 v[44:47], v[76:79], a[36:39], v[44:47]
    ds_read_b64_tr_b16 v[106:107], v167 offset:12288
    s_waitcnt vmcnt(2)
    v_accvgpr_read_b32 v180, a40
    v_accvgpr_read_b32 v181, a44
    v_max_u32 v180, v180, v181
    v_cmp_eq_u32 vcc, -1, v180
    s_nop 1
    s_cmp_eq_u64 vcc, 0
    s_cbranch_scc1 K3_VO34_OK
    s_mov_b32 s99, 0x10000
K3_VO34_SPIN:
    s_sleep 2
    s_add_u32 s96, s63, 0xc00000
    buffer_load_dwordx4 a[40:43], v160, s[76:79], s96 offen offset:0 sc1
    buffer_load_dwordx4 a[44:47], v160, s[76:79], s96 offen offset:1024 sc1
    s_waitcnt vmcnt(0)
    v_accvgpr_read_b32 v180, a40
    v_accvgpr_read_b32 v181, a44
    v_max_u32 v180, v180, v181
    v_cmp_eq_u32 vcc, -1, v180
    s_nop 1
    s_cmp_eq_u64 vcc, 0
    s_cbranch_scc1 K3_VO34_OK
    s_sub_u32 s99, s99, 1
    s_cmp_lg_u32 s99, 0
    s_cbranch_scc1 K3_VO34_SPIN
K3_VO34_OK:
    s_waitcnt lgkmcnt(12)
    v_mfma_f32_16x16x32_bf16 v[8:11], v[80:83], a[40:43], v[8:11]
    ds_read_b64_tr_b16 v[108:109], v168 offset:8192
    v_mfma_f32_16x16x32_bf16 v[40:43], v[80:83], a[44:47], v[40:43]
    ds_read_b64_tr_b16 v[110:111], v168 offset:12288
    s_waitcnt lgkmcnt(12)
    v_mfma_f32_16x16x32_bf16 v[12:15], v[84:87], a[40:43], v[12:15]
    ds_read_b64_tr_b16 v[112:113], v167 offset:16384
    v_mfma_f32_16x16x32_bf16 v[44:47], v[84:87], a[44:47], v[44:47]
    ds_read_b64_tr_b16 v[114:115], v167 offset:20480
    s_waitcnt vmcnt(0)
    v_accvgpr_read_b32 v180, a48
    v_accvgpr_read_b32 v181, a52
    v_max_u32 v180, v180, v181
    v_cmp_eq_u32 vcc, -1, v180
    s_nop 1
    s_cmp_eq_u64 vcc, 0
    s_cbranch_scc1 K3_VO35_OK
    s_mov_b32 s99, 0x10000
K3_VO35_SPIN:
    s_sleep 2
    s_add_u32 s96, s63, 0xe00000
    buffer_load_dwordx4 a[48:51], v160, s[76:79], s96 offen offset:0 sc1
    buffer_load_dwordx4 a[52:55], v160, s[76:79], s96 offen offset:1024 sc1
    s_waitcnt vmcnt(0)
    v_accvgpr_read_b32 v180, a48
    v_accvgpr_read_b32 v181, a52
    v_max_u32 v180, v180, v181
    v_cmp_eq_u32 vcc, -1, v180
    s_nop 1
    s_cmp_eq_u64 vcc, 0
    s_cbranch_scc1 K3_VO35_OK
    s_sub_u32 s99, s99, 1
    s_cmp_lg_u32 s99, 0
    s_cbranch_scc1 K3_VO35_SPIN
K3_VO35_OK:
    s_waitcnt lgkmcnt(12)
    v_mfma_f32_16x16x32_bf16 v[8:11], v[88:91], a[48:51], v[8:11]
    ds_read_b64_tr_b16 v[116:117], v168 offset:16384
    v_mfma_f32_16x16x32_bf16 v[40:43], v[88:91], a[52:55], v[40:43]
    ds_read_b64_tr_b16 v[118:119], v168 offset:20480
    s_waitcnt lgkmcnt(12)
    v_mfma_f32_16x16x32_bf16 v[12:15], v[92:95], a[48:51], v[12:15]
    ds_read_b64_tr_b16 v[120:121], v167 offset:24576
    v_mfma_f32_16x16x32_bf16 v[44:47], v[92:95], a[52:55], v[44:47]
    ds_read_b64_tr_b16 v[122:123], v167 offset:28672
    s_waitcnt lgkmcnt(12)
    v_mfma_f32_16x16x32_bf16 v[16:19], v[96:99], v[136:139], v[16:19]
    ds_read_b64_tr_b16 v[124:125], v168 offset:24576
    v_mfma_f32_16x16x32_bf16 v[48:51], v[96:99], v[140:143], v[48:51]
    ds_read_b64_tr_b16 v[126:127], v168 offset:28672
    s_waitcnt lgkmcnt(12)
    v_mfma_f32_16x16x32_bf16 v[20:23], v[100:103], v[136:139], v[20:23]
    v_add_u32 v167, 0x10000, v167
    ds_read_b64_tr_b16 v[64:65], v167 offset:0
    ds_read_b64_tr_b16 v[66:67], v167 offset:4096
    v_mfma_f32_16x16x32_bf16 v[52:55], v[100:103], v[140:143], v[52:55]
    s_waitcnt lgkmcnt(12)
    v_mfma_f32_16x16x32_bf16 v[16:19], v[104:107], v[144:147], v[16:19]
    v_add_u32 v168, 0x10000, v168
    ds_read_b64_tr_b16 v[68:69], v168 offset:0
    ds_read_b64_tr_b16 v[70:71], v168 offset:4096
    v_cvt_pk_bf16_f32 v8, v8, v9
    v_cvt_pk_bf16_f32 v9, v10, v11
    v_mfma_f32_16x16x32_bf16 v[48:51], v[104:107], v[148:151], v[48:51]
    v_cvt_pk_bf16_f32 v10, v12, v13
    v_cvt_pk_bf16_f32 v11, v14, v15
    s_waitcnt lgkmcnt(12)
    v_mfma_f32_16x16x32_bf16 v[20:23], v[108:111], v[144:147], v[20:23]
    ds_read_b64_tr_b16 v[72:73], v167 offset:8192
    buffer_store_dwordx4 v[8:11], v160, s[76:79], s84 offen offset:0 sc1
    v_cvt_pk_bf16_f32 v40, v40, v41
    v_mfma_f32_16x16x32_bf16 v[52:55], v[108:111], v[148:151], v[52:55]
    ds_read_b64_tr_b16 v[74:75], v167 offset:12288
    v_cvt_pk_bf16_f32 v41, v42, v43
    v_cvt_pk_bf16_f32 v42, v44, v45
    s_waitcnt lgkmcnt(12)
    v_mfma_f32_16x16x32_bf16 v[16:19], v[112:115], v[152:155], v[16:19]
    ds_read_b64_tr_b16 v[76:77], v168 offset:8192
    v_cvt_pk_bf16_f32 v43, v46, v47
    buffer_store_dwordx4 v[40:43], v160, s[76:79], s84 offen offset:1024 sc1
    v_mfma_f32_16x16x32_bf16 v[48:51], v[112:115], v[156:159], v[48:51]
    ds_read_b64_tr_b16 v[78:79], v168 offset:12288
    s_waitcnt lgkmcnt(12)
    v_mfma_f32_16x16x32_bf16 v[20:23], v[116:119], v[152:155], v[20:23]
    ds_read_b64_tr_b16 v[80:81], v167 offset:16384
    v_mfma_f32_16x16x32_bf16 v[52:55], v[116:119], v[156:159], v[52:55]
    ds_read_b64_tr_b16 v[82:83], v167 offset:20480
    s_waitcnt lgkmcnt(12)
    v_mfma_f32_16x16x32_bf16 v[16:19], v[120:123], a[64:67], v[16:19]
    ds_read_b64_tr_b16 v[84:85], v168 offset:16384
    v_mfma_f32_16x16x32_bf16 v[48:51], v[120:123], a[68:71], v[48:51]
    ds_read_b64_tr_b16 v[86:87], v168 offset:20480
    s_waitcnt lgkmcnt(12)
    v_mfma_f32_16x16x32_bf16 v[20:23], v[124:127], a[64:67], v[20:23]
    ds_read_b64_tr_b16 v[88:89], v167 offset:24576
    s_nop 1
    v_mul_f32 v16, v16, v171
    v_mul_f32 v17, v17, v171
    v_mul_f32 v18, v18, v171
    v_mul_f32 v19, v19, v171
    v_mfma_f32_16x16x32_bf16 v[52:55], v[124:127], a[68:71], v[52:55]
    ds_read_b64_tr_b16 v[90:91], v167 offset:28672
    v_mul_f32 v48, v48, v172
    v_mul_f32 v49, v49, v172
    v_mul_f32 v50, v50, v172
    v_mul_f32 v51, v51, v172
    s_waitcnt lgkmcnt(12)
    v_mfma_f32_16x16x32_bf16 v[16:19], v[64:67], a[56:59], v[16:19]
    ds_read_b64_tr_b16 v[92:93], v168 offset:24576
    v_mul_f32 v20, v20, v171
    v_mul_f32 v21, v21, v171
    v_mul_f32 v22, v22, v171
    v_mul_f32 v23, v23, v171
    v_mfma_f32_16x16x32_bf16 v[48:51], v[64:67], a[60:63], v[48:51]
    ds_read_b64_tr_b16 v[94:95], v168 offset:28672
    v_mul_f32 v52, v52, v172
    v_mul_f32 v53, v53, v172
    v_mul_f32 v54, v54, v172
    v_mul_f32 v55, v55, v172
    s_waitcnt lgkmcnt(12)
    v_mfma_f32_16x16x32_bf16 v[20:23], v[68:71], a[56:59], v[20:23]
    ds_read_b64_tr_b16 v[96:97], v167 offset:32768
    v_mfma_f32_16x16x32_bf16 v[52:55], v[68:71], a[60:63], v[52:55]
    ds_read_b64_tr_b16 v[98:99], v167 offset:36864
    s_waitcnt lgkmcnt(12)
    v_mfma_f32_16x16x32_bf16 v[16:19], v[72:75], a[0:3], v[16:19]
    ds_read_b64_tr_b16 v[100:101], v168 offset:32768
    v_mfma_f32_16x16x32_bf16 v[48:51], v[72:75], a[4:7], v[48:51]
    ds_read_b64_tr_b16 v[102:103], v168 offset:36864
    s_waitcnt lgkmcnt(12)
    v_mfma_f32_16x16x32_bf16 v[20:23], v[76:79], a[0:3], v[20:23]
    ds_read_b64_tr_b16 v[104:105], v167 offset:40960
    v_mfma_f32_16x16x32_bf16 v[52:55], v[76:79], a[4:7], v[52:55]
    ds_read_b64_tr_b16 v[106:107], v167 offset:45056
    s_waitcnt lgkmcnt(12)
    v_mfma_f32_16x16x32_bf16 v[16:19], v[80:83], a[8:11], v[16:19]
    ds_read_b64_tr_b16 v[108:109], v168 offset:40960
    v_mfma_f32_16x16x32_bf16 v[48:51], v[80:83], a[12:15], v[48:51]
    ds_read_b64_tr_b16 v[110:111], v168 offset:45056
    s_waitcnt lgkmcnt(12)
    v_mfma_f32_16x16x32_bf16 v[20:23], v[84:87], a[8:11], v[20:23]
    ds_read_b64_tr_b16 v[112:113], v167 offset:49152
    v_mfma_f32_16x16x32_bf16 v[52:55], v[84:87], a[12:15], v[52:55]
    ds_read_b64_tr_b16 v[114:115], v167 offset:53248
    s_waitcnt lgkmcnt(12)
    v_mfma_f32_16x16x32_bf16 v[16:19], v[88:91], a[16:19], v[16:19]
    ds_read_b64_tr_b16 v[116:117], v168 offset:49152
    v_mfma_f32_16x16x32_bf16 v[48:51], v[88:91], a[20:23], v[48:51]
    ds_read_b64_tr_b16 v[118:119], v168 offset:53248
    s_waitcnt lgkmcnt(12)
    v_mfma_f32_16x16x32_bf16 v[20:23], v[92:95], a[16:19], v[20:23]
    ds_read_b64_tr_b16 v[120:121], v167 offset:57344
    v_mfma_f32_16x16x32_bf16 v[52:55], v[92:95], a[20:23], v[52:55]
    ds_read_b64_tr_b16 v[122:123], v167 offset:61440
    s_waitcnt lgkmcnt(12)
    v_mfma_f32_16x16x32_bf16 v[16:19], v[96:99], a[24:27], v[16:19]
    ds_read_b64_tr_b16 v[124:125], v168 offset:57344
    v_mfma_f32_16x16x32_bf16 v[48:51], v[96:99], a[28:31], v[48:51]
    ds_read_b64_tr_b16 v[126:127], v168 offset:61440
    s_waitcnt lgkmcnt(12)
    v_mfma_f32_16x16x32_bf16 v[20:23], v[100:103], a[24:27], v[20:23]
    ds_read_b64_tr_b16 v[64:65], v169 offset:0
    v_mfma_f32_16x16x32_bf16 v[52:55], v[100:103], a[28:31], v[52:55]
    ds_read_b64_tr_b16 v[66:67], v169 offset:4096
    s_waitcnt lgkmcnt(12)
    v_mfma_f32_16x16x32_bf16 v[16:19], v[104:107], a[32:35], v[16:19]
    ds_read_b64_tr_b16 v[68:69], v170 offset:0
    v_mfma_f32_16x16x32_bf16 v[48:51], v[104:107], a[36:39], v[48:51]
    ds_read_b64_tr_b16 v[70:71], v170 offset:4096
    s_waitcnt lgkmcnt(12)
    v_mfma_f32_16x16x32_bf16 v[20:23], v[108:111], a[32:35], v[20:23]
    ds_read_b64_tr_b16 v[72:73], v169 offset:8192
    v_mfma_f32_16x16x32_bf16 v[52:55], v[108:111], a[36:39], v[52:55]
    ds_read_b64_tr_b16 v[74:75], v169 offset:12288
    s_waitcnt lgkmcnt(12)
    v_mfma_f32_16x16x32_bf16 v[16:19], v[112:115], a[40:43], v[16:19]
    ds_read_b64_tr_b16 v[76:77], v170 offset:8192
    v_mfma_f32_16x16x32_bf16 v[48:51], v[112:115], a[44:47], v[48:51]
    ds_read_b64_tr_b16 v[78:79], v170 offset:12288
    s_waitcnt lgkmcnt(12)
    v_mfma_f32_16x16x32_bf16 v[20:23], v[116:119], a[40:43], v[20:23]
    ds_read_b64_tr_b16 v[80:81], v169 offset:16384
    v_mfma_f32_16x16x32_bf16 v[52:55], v[116:119], a[44:47], v[52:55]
    ds_read_b64_tr_b16 v[82:83], v169 offset:20480
    s_waitcnt lgkmcnt(12)
    v_mfma_f32_16x16x32_bf16 v[16:19], v[120:123], a[48:51], v[16:19]
    ds_read_b64_tr_b16 v[84:85], v170 offset:16384
    v_mfma_f32_16x16x32_bf16 v[48:51], v[120:123], a[52:55], v[48:51]
    ds_read_b64_tr_b16 v[86:87], v170 offset:20480
    s_waitcnt lgkmcnt(12)
    v_mfma_f32_16x16x32_bf16 v[20:23], v[124:127], a[48:51], v[20:23]
    ds_read_b64_tr_b16 v[88:89], v169 offset:24576
    v_mfma_f32_16x16x32_bf16 v[52:55], v[124:127], a[52:55], v[52:55]
    ds_read_b64_tr_b16 v[90:91], v169 offset:28672
    s_waitcnt lgkmcnt(12)
    v_mfma_f32_16x16x32_bf16 v[24:27], v[64:67], v[136:139], v[24:27]
    ds_read_b64_tr_b16 v[92:93], v170 offset:24576
    v_mfma_f32_16x16x32_bf16 v[56:59], v[64:67], v[140:143], v[56:59]
    ds_read_b64_tr_b16 v[94:95], v170 offset:28672
    s_waitcnt lgkmcnt(12)
    v_mfma_f32_16x16x32_bf16 v[28:31], v[68:71], v[136:139], v[28:31]
    v_add_u32 v169, 0x10000, v169
    ds_read_b64_tr_b16 v[96:97], v169 offset:0
    ds_read_b64_tr_b16 v[98:99], v169 offset:4096
    v_mfma_f32_16x16x32_bf16 v[60:63], v[68:71], v[140:143], v[60:63]
    s_waitcnt lgkmcnt(12)
    v_mfma_f32_16x16x32_bf16 v[24:27], v[72:75], v[144:147], v[24:27]
    v_add_u32 v170, 0x10000, v170
    ds_read_b64_tr_b16 v[100:101], v170 offset:0
    ds_read_b64_tr_b16 v[102:103], v170 offset:4096
    v_cvt_pk_bf16_f32 v16, v16, v17
    v_cvt_pk_bf16_f32 v17, v18, v19
    v_mfma_f32_16x16x32_bf16 v[56:59], v[72:75], v[148:151], v[56:59]
    v_cvt_pk_bf16_f32 v18, v20, v21
    v_cvt_pk_bf16_f32 v19, v22, v23
    s_waitcnt lgkmcnt(12)
    v_mfma_f32_16x16x32_bf16 v[28:31], v[76:79], v[144:147], v[28:31]
    ds_read_b64_tr_b16 v[104:105], v169 offset:8192
    buffer_store_dwordx4 v[16:19], v160, s[76:79], s85 offen offset:0 sc1
    v_cvt_pk_bf16_f32 v48, v48, v49
    v_mfma_f32_16x16x32_bf16 v[60:63], v[76:79], v[148:151], v[60:63]
    ds_read_b64_tr_b16 v[106:107], v169 offset:12288
    v_cvt_pk_bf16_f32 v49, v50, v51
    v_cvt_pk_bf16_f32 v50, v52, v53
    s_waitcnt lgkmcnt(12)
    v_mfma_f32_16x16x32_bf16 v[24:27], v[80:83], v[152:155], v[24:27]
    ds_read_b64_tr_b16 v[108:109], v170 offset:8192
    v_cvt_pk_bf16_f32 v51, v54, v55
    buffer_store_dwordx4 v[48:51], v160, s[76:79], s85 offen offset:1024 sc1
    v_mfma_f32_16x16x32_bf16 v[56:59], v[80:83], v[156:159], v[56:59]
    ds_read_b64_tr_b16 v[110:111], v170 offset:12288
    s_waitcnt lgkmcnt(12)
    v_mfma_f32_16x16x32_bf16 v[28:31], v[84:87], v[152:155], v[28:31]
    ds_read_b64_tr_b16 v[112:113], v169 offset:16384
    v_mfma_f32_16x16x32_bf16 v[60:63], v[84:87], v[156:159], v[60:63]
    ds_read_b64_tr_b16 v[114:115], v169 offset:20480
    s_waitcnt lgkmcnt(12)
    v_mfma_f32_16x16x32_bf16 v[24:27], v[88:91], a[64:67], v[24:27]
    ds_read_b64_tr_b16 v[116:117], v170 offset:16384
    v_mfma_f32_16x16x32_bf16 v[56:59], v[88:91], a[68:71], v[56:59]
    ds_read_b64_tr_b16 v[118:119], v170 offset:20480
    s_waitcnt lgkmcnt(12)
    v_mfma_f32_16x16x32_bf16 v[28:31], v[92:95], a[64:67], v[28:31]
    ds_read_b64_tr_b16 v[120:121], v169 offset:24576
    s_nop 1
    v_mul_f32 v24, v24, v171
    v_mul_f32 v25, v25, v171
    v_mul_f32 v26, v26, v171
    v_mul_f32 v27, v27, v171
    v_mfma_f32_16x16x32_bf16 v[60:63], v[92:95], a[68:71], v[60:63]
    ds_read_b64_tr_b16 v[122:123], v169 offset:28672
    v_mul_f32 v56, v56, v172
    v_mul_f32 v57, v57, v172
    v_mul_f32 v58, v58, v172
    v_mul_f32 v59, v59, v172
    s_waitcnt lgkmcnt(12)
    v_mfma_f32_16x16x32_bf16 v[24:27], v[96:99], a[56:59], v[24:27]
    ds_read_b64_tr_b16 v[124:125], v170 offset:24576
    v_mul_f32 v28, v28, v171
    v_mul_f32 v29, v29, v171
    v_mul_f32 v30, v30, v171
    v_mul_f32 v31, v31, v171
    v_mfma_f32_16x16x32_bf16 v[56:59], v[96:99], a[60:63], v[56:59]
    ds_read_b64_tr_b16 v[126:127], v170 offset:28672
    v_mul_f32 v60, v60, v172
    v_mul_f32 v61, v61, v172
    v_mul_f32 v62, v62, v172
    v_mul_f32 v63, v63, v172
    s_waitcnt lgkmcnt(12)
    v_mfma_f32_16x16x32_bf16 v[28:31], v[100:103], a[56:59], v[28:31]
    ds_read_b64_tr_b16 v[64:65], v169 offset:32768
    v_mfma_f32_16x16x32_bf16 v[60:63], v[100:103], a[60:63], v[60:63]
    ds_read_b64_tr_b16 v[66:67], v169 offset:36864
    s_waitcnt lgkmcnt(12)
    v_mfma_f32_16x16x32_bf16 v[24:27], v[104:107], a[0:3], v[24:27]
    ds_read_b64_tr_b16 v[68:69], v170 offset:32768
    v_mfma_f32_16x16x32_bf16 v[56:59], v[104:107], a[4:7], v[56:59]
    ds_read_b64_tr_b16 v[70:71], v170 offset:36864
    s_waitcnt lgkmcnt(12)
    v_mfma_f32_16x16x32_bf16 v[28:31], v[108:111], a[0:3], v[28:31]
    ds_read_b64_tr_b16 v[72:73], v169 offset:40960
    v_mfma_f32_16x16x32_bf16 v[60:63], v[108:111], a[4:7], v[60:63]
    ds_read_b64_tr_b16 v[74:75], v169 offset:45056
    s_setprio 3
    s_waitcnt lgkmcnt(12)
    v_mfma_f32_16x16x32_bf16 v[24:27], v[112:115], a[8:11], v[24:27]
    ds_read_b64_tr_b16 v[76:77], v170 offset:40960
    v_mfma_f32_16x16x32_bf16 v[56:59], v[112:115], a[12:15], v[56:59]
    ds_read_b64_tr_b16 v[78:79], v170 offset:45056
    s_waitcnt lgkmcnt(12)
    v_mfma_f32_16x16x32_bf16 v[28:31], v[116:119], a[8:11], v[28:31]
    ds_read_b64_tr_b16 v[80:81], v169 offset:49152
    v_mfma_f32_16x16x32_bf16 v[60:63], v[116:119], a[12:15], v[60:63]
    ds_read_b64_tr_b16 v[82:83], v169 offset:53248
    s_waitcnt lgkmcnt(12)
    v_mfma_f32_16x16x32_bf16 v[24:27], v[120:123], a[16:19], v[24:27]
    ds_read_b64_tr_b16 v[84:85], v170 offset:49152
    v_mfma_f32_16x16x32_bf16 v[56:59], v[120:123], a[20:23], v[56:59]
    ds_read_b64_tr_b16 v[86:87], v170 offset:53248
    s_waitcnt lgkmcnt(12)
    v_mfma_f32_16x16x32_bf16 v[28:31], v[124:127], a[16:19], v[28:31]
    ds_read_b64_tr_b16 v[88:89], v169 offset:57344
    v_mfma_f32_16x16x32_bf16 v[60:63], v[124:127], a[20:23], v[60:63]
    ds_read_b64_tr_b16 v[90:91], v169 offset:61440
    s_waitcnt lgkmcnt(12)
    v_mfma_f32_16x16x32_bf16 v[24:27], v[64:67], a[24:27], v[24:27]
    ds_read_b64_tr_b16 v[92:93], v170 offset:57344
    v_mfma_f32_16x16x32_bf16 v[56:59], v[64:67], a[28:31], v[56:59]
    ds_read_b64_tr_b16 v[94:95], v170 offset:61440
    s_waitcnt lgkmcnt(12)
    v_mfma_f32_16x16x32_bf16 v[28:31], v[68:71], a[24:27], v[28:31]
    ds_read_b64_tr_b16 v[96:97], v163 offset:0
    v_mfma_f32_16x16x32_bf16 v[60:63], v[68:71], a[28:31], v[60:63]
    ds_read_b64_tr_b16 v[98:99], v163 offset:4096
    s_waitcnt lgkmcnt(12)
    v_mfma_f32_16x16x32_bf16 v[24:27], v[72:75], a[32:35], v[24:27]
    ds_read_b64_tr_b16 v[100:101], v164 offset:0
    v_mfma_f32_16x16x32_bf16 v[56:59], v[72:75], a[36:39], v[56:59]
    ds_read_b64_tr_b16 v[102:103], v164 offset:4096
    s_waitcnt lgkmcnt(12)
    v_mfma_f32_16x16x32_bf16 v[28:31], v[76:79], a[32:35], v[28:31]
    ds_read_b64_tr_b16 v[104:105], v163 offset:8192
    v_mfma_f32_16x16x32_bf16 v[60:63], v[76:79], a[36:39], v[60:63]
    ds_read_b64_tr_b16 v[106:107], v163 offset:12288
    s_waitcnt lgkmcnt(12)
    v_mfma_f32_16x16x32_bf16 v[24:27], v[80:83], a[40:43], v[24:27]
    ds_read_b64_tr_b16 v[108:109], v164 offset:8192
    v_mfma_f32_16x16x32_bf16 v[56:59], v[80:83], a[44:47], v[56:59]
    ds_read_b64_tr_b16 v[110:111], v164 offset:12288
    s_waitcnt lgkmcnt(12)
    v_mfma_f32_16x16x32_bf16 v[28:31], v[84:87], a[40:43], v[28:31]
    ds_read_b64_tr_b16 v[112:113], v163 offset:16384
    s_lshl_b32 s87, s56, 16
    s_add_u32 s23, s87, s71
    v_mfma_f32_16x16x32_bf16 v[60:63], v[84:87], a[44:47], v[60:63]
    ds_read_b64_tr_b16 v[114:115], v163 offset:20480
    s_add_u32 s24, s23, 0x800
    s_add_u32 s25, s23, 0x1000
    s_waitcnt lgkmcnt(12)
    v_mfma_f32_16x16x32_bf16 v[24:27], v[88:91], a[48:51], v[24:27]
    ds_read_b64_tr_b16 v[116:117], v164 offset:16384
    buffer_load_dwordx4 v[12:15], v160, s[76:79], s23 offen offset:0 sc1
    buffer_load_dwordx4 v[44:47], v160, s[76:79], s23 offen offset:1024 sc1
    v_mfma_f32_16x16x32_bf16 v[56:59], v[88:91], a[52:55], v[56:59]
    ds_read_b64_tr_b16 v[118:119], v164 offset:20480
    buffer_load_dwordx4 v[20:23], v160, s[76:79], s24 offen offset:0 sc1
    buffer_load_dwordx4 v[52:55], v160, s[76:79], s24 offen offset:1024 sc1
    s_waitcnt lgkmcnt(12)
    v_mfma_f32_16x16x32_bf16 v[28:31], v[92:95], a[48:51], v[28:31]
    ds_read_b64_tr_b16 v[120:121], v163 offset:24576
    v_mfma_f32_16x16x32_bf16 v[60:63], v[92:95], a[52:55], v[60:63]
    ds_read_b64_tr_b16 v[122:123], v163 offset:28672
    s_setprio 2
    s_waitcnt lgkmcnt(12)
    v_mfma_f32_16x16x32_bf16 v[0:3], v[96:99], v[136:139], v[0:3]
    ds_read_b64_tr_b16 v[124:125], v164 offset:24576
    v_mfma_f32_16x16x32_bf16 v[32:35], v[96:99], v[140:143], v[32:35]
    ds_read_b64_tr_b16 v[126:127], v164 offset:28672
    s_waitcnt lgkmcnt(12)
    v_mfma_f32_16x16x32_bf16 v[4:7], v[100:103], v[136:139], v[4:7]
    v_add_u32 v163, 0x10000, v163
    ds_read_b64_tr_b16 v[64:65], v163 offset:0
    ds_read_b64_tr_b16 v[66:67], v163 offset:4096
    v_mfma_f32_16x16x32_bf16 v[36:39], v[100:103], v[140:143], v[36:39]
    s_waitcnt lgkmcnt(12)
    v_mfma_f32_16x16x32_bf16 v[0:3], v[104:107], v[144:147], v[0:3]
    v_add_u32 v164, 0x10000, v164
    ds_read_b64_tr_b16 v[68:69], v164 offset:0
    ds_read_b64_tr_b16 v[70:71], v164 offset:4096
    v_cvt_pk_bf16_f32 v24, v24, v25
    v_cvt_pk_bf16_f32 v25, v26, v27
    v_mfma_f32_16x16x32_bf16 v[32:35], v[104:107], v[148:151], v[32:35]
    v_cvt_pk_bf16_f32 v26, v28, v29
    v_cvt_pk_bf16_f32 v27, v30, v31
    s_waitcnt lgkmcnt(12)
    v_mfma_f32_16x16x32_bf16 v[4:7], v[108:111], v[144:147], v[4:7]
    ds_read_b64_tr_b16 v[72:73], v163 offset:8192
    buffer_store_dwordx4 v[24:27], v160, s[76:79], s86 offen offset:0 sc1
    v_cvt_pk_bf16_f32 v56, v56, v57
    v_mfma_f32_16x16x32_bf16 v[36:39], v[108:111], v[148:151], v[36:39]
    ds_read_b64_tr_b16 v[74:75], v163 offset:12288
    v_cvt_pk_bf16_f32 v57, v58, v59
    v_cvt_pk_bf16_f32 v58, v60, v61
    s_waitcnt lgkmcnt(12)
    v_mfma_f32_16x16x32_bf16 v[0:3], v[112:115], v[152:155], v[0:3]
    ds_read_b64_tr_b16 v[76:77], v164 offset:8192
    v_cvt_pk_bf16_f32 v59, v62, v63
    buffer_store_dwordx4 v[56:59], v160, s[76:79], s86 offen offset:1024 sc1
    v_mfma_f32_16x16x32_bf16 v[32:35], v[112:115], v[156:159], v[32:35]
    ds_read_b64_tr_b16 v[78:79], v164 offset:12288
    s_waitcnt lgkmcnt(12)
    v_mfma_f32_16x16x32_bf16 v[4:7], v[116:119], v[152:155], v[4:7]
    ds_read_b64_tr_b16 v[80:81], v163 offset:16384
    v_mfma_f32_16x16x32_bf16 v[36:39], v[116:119], v[156:159], v[36:39]
    ds_read_b64_tr_b16 v[82:83], v163 offset:20480
    s_waitcnt lgkmcnt(12)
    v_mfma_f32_16x16x32_bf16 v[0:3], v[120:123], a[64:67], v[0:3]
    ds_read_b64_tr_b16 v[84:85], v164 offset:16384
    v_mfma_f32_16x16x32_bf16 v[32:35], v[120:123], a[68:71], v[32:35]
    ds_read_b64_tr_b16 v[86:87], v164 offset:20480
    s_waitcnt lgkmcnt(12)
    v_mfma_f32_16x16x32_bf16 v[4:7], v[124:127], a[64:67], v[4:7]
    ds_read_b64_tr_b16 v[88:89], v163 offset:24576
    s_nop 1
    v_mul_f32 v0, v0, v171
    v_mul_f32 v1, v1, v171
    v_mul_f32 v2, v2, v171
    v_mul_f32 v3, v3, v171
    v_mfma_f32_16x16x32_bf16 v[36:39], v[124:127], a[68:71], v[36:39]
    ds_read_b64_tr_b16 v[90:91], v163 offset:28672
    v_mul_f32 v32, v32, v172
    v_mul_f32 v33, v33, v172
    v_mul_f32 v34, v34, v172
    v_mul_f32 v35, v35, v172
    s_setprio 1
    s_waitcnt lgkmcnt(12)
    v_mfma_f32_16x16x32_bf16 v[0:3], v[64:67], a[56:59], v[0:3]
    ds_read_b64_tr_b16 v[92:93], v164 offset:24576
    v_mul_f32 v4, v4, v171
    v_mul_f32 v5, v5, v171
    v_mul_f32 v6, v6, v171
    v_mul_f32 v7, v7, v171
    v_mfma_f32_16x16x32_bf16 v[32:35], v[64:67], a[60:63], v[32:35]
    ds_read_b64_tr_b16 v[94:95], v164 offset:28672
    v_mul_f32 v36, v36, v172
    v_mul_f32 v37, v37, v172
    v_mul_f32 v38, v38, v172
    v_mul_f32 v39, v39, v172
    s_waitcnt lgkmcnt(12)
    v_mfma_f32_16x16x32_bf16 v[4:7], v[68:71], a[56:59], v[4:7]
    ds_read_b64_tr_b16 v[96:97], v163 offset:32768
    v_mfma_f32_16x16x32_bf16 v[36:39], v[68:71], a[60:63], v[36:39]
    ds_read_b64_tr_b16 v[98:99], v163 offset:36864
    s_waitcnt lgkmcnt(12)
    v_mfma_f32_16x16x32_bf16 v[0:3], v[72:75], a[0:3], v[0:3]
    ds_read_b64_tr_b16 v[100:101], v164 offset:32768
    v_mfma_f32_16x16x32_bf16 v[32:35], v[72:75], a[4:7], v[32:35]
    ds_read_b64_tr_b16 v[102:103], v164 offset:36864
    s_waitcnt lgkmcnt(12)
    v_mfma_f32_16x16x32_bf16 v[4:7], v[76:79], a[0:3], v[4:7]
    ds_read_b64_tr_b16 v[104:105], v163 offset:40960
    v_mfma_f32_16x16x32_bf16 v[36:39], v[76:79], a[4:7], v[36:39]
    ds_read_b64_tr_b16 v[106:107], v163 offset:45056
    s_waitcnt lgkmcnt(12)
    v_mfma_f32_16x16x32_bf16 v[0:3], v[80:83], a[8:11], v[0:3]
    ds_read_b64_tr_b16 v[108:109], v164 offset:40960
    v_mfma_f32_16x16x32_bf16 v[32:35], v[80:83], a[12:15], v[32:35]
    ds_read_b64_tr_b16 v[110:111], v164 offset:45056
    s_waitcnt lgkmcnt(12)
    v_mfma_f32_16x16x32_bf16 v[4:7], v[84:87], a[8:11], v[4:7]
    ds_read_b64_tr_b16 v[112:113], v163 offset:49152
    v_mfma_f32_16x16x32_bf16 v[36:39], v[84:87], a[12:15], v[36:39]
    ds_read_b64_tr_b16 v[114:115], v163 offset:53248
    s_waitcnt lgkmcnt(12)
    v_mfma_f32_16x16x32_bf16 v[0:3], v[88:91], a[16:19], v[0:3]
    ds_read_b64_tr_b16 v[116:117], v164 offset:49152
    v_mfma_f32_16x16x32_bf16 v[32:35], v[88:91], a[20:23], v[32:35]
    ds_read_b64_tr_b16 v[118:119], v164 offset:53248
    s_waitcnt lgkmcnt(12)
    v_mfma_f32_16x16x32_bf16 v[4:7], v[92:95], a[16:19], v[4:7]
    ds_read_b64_tr_b16 v[120:121], v163 offset:57344
    v_mfma_f32_16x16x32_bf16 v[36:39], v[92:95], a[20:23], v[36:39]
    ds_read_b64_tr_b16 v[122:123], v163 offset:61440
    s_setprio 0
    s_waitcnt lgkmcnt(12)
    v_mfma_f32_16x16x32_bf16 v[0:3], v[96:99], a[24:27], v[0:3]
    ds_read_b64_tr_b16 v[124:125], v164 offset:57344
    v_mfma_f32_16x16x32_bf16 v[32:35], v[96:99], a[28:31], v[32:35]
    ds_read_b64_tr_b16 v[126:127], v164 offset:61440
    s_waitcnt lgkmcnt(12)
    v_mfma_f32_16x16x32_bf16 v[4:7], v[100:103], a[24:27], v[4:7]
    buffer_load_dwordx4 v[8:11], v160, s[76:79], s25 offen offset:0 sc1
    buffer_load_dwordx4 v[40:43], v160, s[76:79], s25 offen offset:1024 sc1
    v_mfma_f32_16x16x32_bf16 v[36:39], v[100:103], a[28:31], v[36:39]
    s_waitcnt lgkmcnt(10)
    v_mfma_f32_16x16x32_bf16 v[0:3], v[104:107], a[32:35], v[0:3]
    v_mfma_f32_16x16x32_bf16 v[32:35], v[104:107], a[36:39], v[32:35]
    s_waitcnt lgkmcnt(8)
    v_mfma_f32_16x16x32_bf16 v[4:7], v[108:111], a[32:35], v[4:7]
    v_mfma_f32_16x16x32_bf16 v[36:39], v[108:111], a[36:39], v[36:39]
    s_waitcnt lgkmcnt(6)
    v_mfma_f32_16x16x32_bf16 v[0:3], v[112:115], a[40:43], v[0:3]
    v_mfma_f32_16x16x32_bf16 v[32:35], v[112:115], a[44:47], v[32:35]
    s_waitcnt lgkmcnt(4)
    v_mfma_f32_16x16x32_bf16 v[4:7], v[116:119], a[40:43], v[4:7]
    v_mfma_f32_16x16x32_bf16 v[36:39], v[116:119], a[44:47], v[36:39]
    s_waitcnt lgkmcnt(2)
    v_mfma_f32_16x16x32_bf16 v[0:3], v[120:123], a[48:51], v[0:3]
    v_mfma_f32_16x16x32_bf16 v[32:35], v[120:123], a[52:55], v[32:35]
    s_waitcnt lgkmcnt(0)
    v_mfma_f32_16x16x32_bf16 v[4:7], v[124:127], a[48:51], v[4:7]
    v_mfma_f32_16x16x32_bf16 v[36:39], v[124:127], a[52:55], v[36:39]
    s_lshl_b32 s87, s58, 15
    s_lshl_b32 s88, s57, 8
    s_add_u32 s87, s87, s88
    s_lshl_b32 s88, s56, 6
    s_add_u32 s87, s87, s88
    v_and_b32 v128, 0xf0, v160
    v_lshlrev_b32 v128, 7, v128
    v_bfe_u32 v129, v160, 8, 1
    v_lshl_add_u32 v128, v129, 5, v128
    v_lshrrev_b32 v129, 9, v160
    v_lshl_add_u32 v128, v129, 4, v128
    v_mov_b32 v175, 0
    s_waitcnt vmcnt(4)
    v_max3_u32 v130, v12, v13, v14
    v_max3_u32 v131, v15, v44, v45
    v_max3_u32 v130, v46, v47, v130
    v_max3_u32 v131, v20, v21, v131
    v_max3_u32 v130, v22, v23, v130
    v_max3_u32 v131, v52, v53, v131
    v_max3_u32 v130, v54, v55, v130
    v_max_u32 v130, v130, v131
    v_cmp_eq_u32 vcc, -1, v130
    s_nop 1
    s_cmp_eq_u64 vcc, 0
    s_cbranch_scc1 K3_W1_OK
    s_mov_b32 s99, 0x10000
K3_W1_SPIN:
    s_sleep 2
    buffer_load_dwordx4 v[12:15], v160, s[76:79], s23 offen offset:0 sc1
    buffer_load_dwordx4 v[44:47], v160, s[76:79], s23 offen offset:1024 sc1
    buffer_load_dwordx4 v[20:23], v160, s[76:79], s24 offen offset:0 sc1
    buffer_load_dwordx4 v[52:55], v160, s[76:79], s24 offen offset:1024 sc1
    s_waitcnt vmcnt(0)
    v_max3_u32 v130, v12, v13, v14
    v_max3_u32 v131, v15, v44, v45
    v_max3_u32 v130, v46, v47, v130
    v_max3_u32 v131, v20, v21, v131
    v_max3_u32 v130, v22, v23, v130
    v_max3_u32 v131, v52, v53, v131
    v_max3_u32 v130, v54, v55, v130
    v_max_u32 v130, v130, v131
    v_cmp_eq_u32 vcc, -1, v130
    s_nop 1
    s_cmp_eq_u64 vcc, 0
    s_cbranch_scc1 K3_W1_OK
    s_sub_u32 s99, s99, 1
    s_cmp_lg_u32 s99, 0
    s_cbranch_scc1 K3_W1_SPIN
K3_W1_OK:
    v_dot2_f32_bf16 v0, v12, s90, v0
    v_dot2_f32_bf16 v1, v12, s91, v1
    v_dot2_f32_bf16 v2, v13, s90, v2
    v_dot2_f32_bf16 v3, v13, s91, v3
    v_dot2_f32_bf16 v4, v14, s90, v4
    v_dot2_f32_bf16 v5, v14, s91, v5
    v_dot2_f32_bf16 v6, v15, s90, v6
    v_dot2_f32_bf16 v7, v15, s91, v7
    v_dot2_f32_bf16 v32, v44, s90, v32
    v_dot2_f32_bf16 v33, v44, s91, v33
    v_dot2_f32_bf16 v34, v45, s90, v34
    v_dot2_f32_bf16 v35, v45, s91, v35
    v_dot2_f32_bf16 v36, v46, s90, v36
    v_dot2_f32_bf16 v37, v46, s91, v37
    v_dot2_f32_bf16 v38, v47, s90, v38
    v_dot2_f32_bf16 v39, v47, s91, v39
    v_dot2_f32_bf16 v0, v20, s90, v0
    v_dot2_f32_bf16 v1, v20, s91, v1
    v_dot2_f32_bf16 v2, v21, s90, v2
    v_dot2_f32_bf16 v3, v21, s91, v3
    v_dot2_f32_bf16 v4, v22, s90, v4
    v_dot2_f32_bf16 v5, v22, s91, v5
    v_dot2_f32_bf16 v6, v23, s90, v6
    v_dot2_f32_bf16 v7, v23, s91, v7
    v_dot2_f32_bf16 v32, v52, s90, v32
    v_dot2_f32_bf16 v33, v52, s91, v33
    v_dot2_f32_bf16 v34, v53, s90, v34
    v_dot2_f32_bf16 v35, v53, s91, v35
    v_dot2_f32_bf16 v36, v54, s90, v36
    v_dot2_f32_bf16 v37, v54, s91, v37
    v_dot2_f32_bf16 v38, v55, s90, v38
    v_dot2_f32_bf16 v39, v55, s91, v39
    s_waitcnt vmcnt(0)
    v_max3_u32 v130, v8, v9, v10
    v_max3_u32 v131, v11, v40, v41
    v_max3_u32 v130, v42, v43, v130
    v_max_u32 v130, v130, v131
    v_cmp_eq_u32 vcc, -1, v130
    s_nop 1
    s_cmp_eq_u64 vcc, 0
    s_cbranch_scc1 K3_W2_OK
    s_mov_b32 s99, 0x10000
K3_W2_SPIN:
    s_sleep 2
    buffer_load_dwordx4 v[8:11], v160, s[76:79], s25 offen offset:0 sc1
    buffer_load_dwordx4 v[40:43], v160, s[76:79], s25 offen offset:1024 sc1
    s_waitcnt vmcnt(0)
    v_max3_u32 v130, v8, v9, v10
    v_max3_u32 v131, v11, v40, v41
    v_max3_u32 v130, v42, v43, v130
    v_max_u32 v130, v130, v131
    v_cmp_eq_u32 vcc, -1, v130
    s_nop 1
    s_cmp_eq_u64 vcc, 0
    s_cbranch_scc1 K3_W2_OK
    s_sub_u32 s99, s99, 1
    s_cmp_lg_u32 s99, 0
    s_cbranch_scc1 K3_W2_SPIN
K3_W2_OK:
    v_dot2_f32_bf16 v0, v8, s90, v0
    v_dot2_f32_bf16 v1, v8, s91, v1
    v_dot2_f32_bf16 v2, v9, s90, v2
    v_dot2_f32_bf16 v3, v9, s91, v3
    v_dot2_f32_bf16 v4, v10, s90, v4
    v_dot2_f32_bf16 v5, v10, s91, v5
    v_dot2_f32_bf16 v6, v11, s90, v6
    v_dot2_f32_bf16 v7, v11, s91, v7
    v_dot2_f32_bf16 v32, v40, s90, v32
    v_dot2_f32_bf16 v33, v40, s91, v33
    v_dot2_f32_bf16 v34, v41, s90, v34
    v_dot2_f32_bf16 v35, v41, s91, v35
    v_dot2_f32_bf16 v36, v42, s90, v36
    v_dot2_f32_bf16 v37, v42, s91, v37
    v_dot2_f32_bf16 v38, v43, s90, v38
    v_dot2_f32_bf16 v39, v43, s91, v39
    s_nop 3
    v_cvt_pk_bf16_f32 v16, v0, v1
    v_cvt_pk_bf16_f32 v18, v4, v5
    v_cvt_pk_bf16_f32 v17, v2, v3
    v_cvt_pk_bf16_f32 v19, v6, v7
    s_nop 0
    v_permlane16_swap_b32 v16, v18
    v_permlane16_swap_b32 v17, v19
    buffer_store_dwordx4 v[16:19], v128, s[48:51], s87 offen
    s_add_u32 s87, s87, 0x8000
    v_cvt_pk_bf16_f32 v48, v32, v33
    v_cvt_pk_bf16_f32 v50, v36, v37
    v_cvt_pk_bf16_f32 v49, v34, v35
    v_cvt_pk_bf16_f32 v51, v38, v39
    s_nop 0
    v_permlane16_swap_b32 v48, v50
    v_permlane16_swap_b32 v49, v51
    buffer_store_dwordx4 v[48:51], v128, s[48:51], s87 offen
    s_add_u32 s87, s87, 0x8000
K1_END:
    s_endpgm
.section .rodata,"a"
.p2align 6
.amdhsa_kernel fk_kernel
  .amdhsa_next_free_vgpr 256
  .amdhsa_next_free_sgpr 102
  .amdhsa_accum_offset 184
  .amdhsa_group_segment_fixed_size 0
  .amdhsa_kernarg_size 96
  .amdhsa_user_sgpr_count 2
  .amdhsa_user_sgpr_kernarg_segment_ptr 1
  .amdhsa_system_sgpr_workgroup_id_x 1
  .amdhsa_float_denorm_mode_32 3
.end_amdhsa_kernel
```
